```python
import torch

def _softmax(x, axis=-1):
    return torch.softmax(x, dim=axis)
def _gelu(x):
    return torch.nn.functional.gelu(x, approximate="tanh")
def _silu(x):
    return torch.nn.functional.silu(x)
def _sigmoid(x):
    return torch.sigmoid(x)
def _layernorm(x, axis=-1, eps=1e-5):
    m = x.mean(dim=axis, keepdim=True)
    v = x.var(dim=axis, keepdim=True, unbiased=False)
    return (x - m) / torch.sqrt(v + eps)
def _scatter_add(tgt, idx, src, axis=0):
    return tgt.clone().index_add_(axis, idx, src)
def _segment_sum(src, seg, n):
    out = torch.zeros((n,) + src.shape[1:], dtype=src.dtype)
    return out.index_add_(0, seg, src)
def _pad(x, pw):
    flat = tuple(v for pair in reversed(pw) for v in pair)
    return torch.nn.functional.pad(x, flat)

kernel_name = 'sequential_preLN__linear_attn_block__mixer_token_mlp__prompt'

def setup_inputs():

    _w = (lambda a: (lambda t: t.to(torch.bfloat16) if t.is_floating_point() else t)(torch.as_tensor(a)))
    def _A_setup():
        B, S, D = 1, 2048, 576
        return {
            "x": _w((lambda *s: torch.randn(*s, dtype=torch.bfloat16) * 0.05)(B, S, D)),
            "wqkv": _w((lambda *s: torch.randn(*s, dtype=torch.bfloat16) * 0.05)(D, 3 * D)),
            "wo": _w((lambda *s: torch.randn(*s, dtype=torch.bfloat16) * 0.05)(D, D)),
        }
    _A_in = _A_setup()

    def _B_setup():
        B, S, D, F = 1, 2048, 576, 4608
        return {
            "x": _w((lambda *s: torch.randn(*s, dtype=torch.bfloat16) * 0.05)(B, S, D)),
            "w1": _w((lambda *s: torch.randn(*s, dtype=torch.bfloat16) * 0.2)(S, F) * (S ** -0.5)),
            "b1": _w((lambda *s: torch.randn(*s, dtype=torch.bfloat16) * 3.2)(F) * 0.02),
            "w2": _w((lambda *s: torch.randn(*s, dtype=torch.bfloat16) * 0.2)(F, S) * (F ** -0.5)),
            "b2": _w((lambda *s: torch.randn(*s, dtype=torch.bfloat16) * 0.4)(S) * 0.02),
        }
    _B_in = _B_setup()

    return {
        "A_x": _A_in["x"],
        "A_wqkv": _A_in["wqkv"],
        "A_wo": _A_in["wo"],
        "B_x": _B_in["x"],
        "B_w1": _B_in["w1"],
        "B_b1": _B_in["b1"],
        "B_w2": _B_in["w2"],
        "B_b2": _B_in["b2"],
    }

def reference(A_x, A_wqkv, A_wo, B_x, B_w1, B_b1, B_w2, B_b2):
    def _A_ref(x, wqkv, wo):
        B, S, D = x.shape
        H = 32; Dh = D // H
        qkv = (lambda x, *d: x.permute(*d))((x @ wqkv).reshape(B, S, 3, H, Dh), 2, 0, 3, 1, 4)
        q, k, v = qkv[0], qkv[1], qkv[2]
        phi = lambda t: torch.where(t > 0, t + 1, torch.exp(t)) + 1e-6
        pq, pk = phi(q), phi(k)
        kv = torch.einsum("bhsd,bhse->bhde", pk, v)
        z = torch.einsum("bhsd->bhd", pk)
        num = torch.einsum("bhqd,bhde->bhqe", pq, kv)
        den = torch.einsum("bhqd,bhd->bhq", pq, z)[..., None] + 1e-6
        o = num / den
        return (lambda x, *d: x.permute(*d))(o, 0, 2, 1, 3).reshape(B, S, D) @ wo

    def _B_ref(x, w1, b1, w2, b2):
        B, S, D = x.shape
        h = _layernorm(x, axis=-1)
        u = torch.einsum("bsd,sf->bdf", h, w1) + b1
        u = _gelu(u)
        y = torch.einsum("bdf,fs->bds", u, w2) + b2
        return (lambda x, *d: x.permute(*d))(y, 0, 2, 1)

    x = A_x
    h = x + _A_ref(_layernorm(x, axis=-1), A_wqkv, A_wo)
    h2 = h + _B_ref(_layernorm(h, axis=-1), B_w1, B_b1, B_w2, B_b2)
    return h2
```

```asm
; @launch grid=(256,1,1) block=(512,1,1) lds=162368
.amdgcn_target "amdgcn-amd-amdhsa--gfx950"
.text
  .globl sequential_preLN__linear_attn_block__mixer_token_mlp__prompt_kernel
  .p2align 8
  .type sequential_preLN__linear_attn_block__mixer_token_mlp__prompt_kernel,@function
sequential_preLN__linear_attn_block__mixer_token_mlp__prompt_kernel:
  s_cmp_ge_u32 s2, 256
  s_cbranch_scc1 L_end_3001
  s_load_dwordx16 s[64:79], s[0:1], 0
  s_load_dwordx4 s[80:83], s[0:1], 64
  s_load_dwordx2 s[84:85], s[0:1], 80
  v_lshrrev_b32 v2, 6, v0
  s_and_b32 s62, s2, 7
  s_lshr_b32 s63, s2, 3
  v_readfirstlane_b32 s3, v2
  v_and_b32 v1, 63, v0
  s_cmp_eq_u32 s63, 31
  s_cbranch_scc1 L_svc_3004
  s_or_b32 s4, s2, 4
  s_sub_u32 s5, s2, 240
  s_cmp_lt_u32 s5, 8
  s_cselect_b32 s4, s4, 247
  s_cmp_lg_u32 s4, 247
  s_cbranch_scc1 L_idle1_3003
  s_lshr_b32 s37, s62, 1
  s_mul_i32 s24, s37, 22
  s_add_u32 s24, s24, s63
  s_lshr_b32 s25, s24, 2
  s_and_b32 s24, s24, 3
  s_and_b32 s26, s62, 1
  s_lshl2_add_u32 s26, s26, s24
  s_mul_i32 s24, s62, 33
  s_lshr_b32 s24, s24, 2
  s_sub_u32 s37, s63, 22
  s_add_u32 s24, s24, s37
  s_mul_i32 s37, s24, 21846
  s_lshr_b32 s37, s37, 16
  s_mul_i32 s38, s37, 3
  s_sub_u32 s24, s24, s38
  s_add_u32 s24, s24, 8
  s_cmp_lt_u32 s63, 22
  s_cselect_b32 s25, s25, s37
  s_cselect_b32 s26, s26, s24
  s_mul_i32 s28, s25, 94
  s_mov_b32 s33, 0
  s_mov_b32 s34, 0
  s_mov_b32 s32, 0
  s_and_b32 s27, s3, 3
  s_cmp_lt_u32 s3, 4
  s_cbranch_scc1 L_comp_3002
  s_mul_i32 s48, s26, 144
  s_add_u32 s48, s48, 1152
  s_andn2_b32 s48, s48, 63
  s_sub_u32 s37, s26, 8
  s_mul_i32 s37, s37, 384
  s_cmp_lt_u32 s26, 8
  s_cselect_b32 s48, s48, s37
  s_cselect_b32 s49, 960, 0
  s_mul_i32 s37, s27, 55296
  s_add_u32 s48, s48, s37
  v_bfe_u32 v2, v1, 2, 2
  v_mul_u32_u24 v2, 3456, v2
  v_lshrrev_b32 v6, 4, v1
  v_and_b32 v7, 3, v1
  v_lshl_add_u32 v2, v6, 6, v2
  v_lshl_add_u32 v7, v7, 4, s48
  v_mov_b32 v17, s49
  v_cmp_eq_u32 vcc, 3, v6
  v_cmp_le_u32 s[44:45], 2, v6
  v_cmp_le_u32 s[46:47], 1, v6
  v_add_u32 v2, v2, v7
  v_mov_b32 v5, 13440
  v_cndmask_b32 v3, 0, v17, vcc
  v_cndmask_b32 v4, v17, v5, s[44:45]
  v_cndmask_b32 v5, 0, v17, s[46:47]
  v_add_u32 v8, 1024, v2
  v_add_u32 v9, 256, v2
  v_add_u32 v10, 12928, v2
  v_add_u32 v8, v3, v8
  v_add_u32 v9, v4, v9
  v_add_u32 v10, v5, v10
  v_xor_b32 v11, 32, v8
  v_xor_b32 v12, 32, v9
  v_xor_b32 v13, 32, v10
  s_mul_i32 s37, s27, 24
  s_lshr_b32 s38, s27, 1
  s_sub_u32 s38, s28, s38
  v_lshrrev_b32 v6, 3, v1
  v_add_u32 v6, s37, v6
  v_and_b32 v7, 7, v1
  v_add_u32 v2, 0, v6
  v_bfe_u32 v3, v2, 1, 3
  v_xor_b32 v3, v3, v7
  v_add_u32 v2, s38, v2
  v_min_u32 v2, 2047, v2
  v_mul_u32_u24 v2, 1152, v2
  v_lshl_add_u32 v14, v3, 4, v2
  v_add_u32 v2, 8, v6
  v_bfe_u32 v3, v2, 1, 3
  v_xor_b32 v3, v3, v7
  v_add_u32 v2, s38, v2
  v_min_u32 v2, 2047, v2
  v_mul_u32_u24 v2, 1152, v2
  v_lshl_add_u32 v15, v3, 4, v2
  v_subrev_u32 v15, 1024, v15
  v_add_u32 v2, 16, v6
  v_bfe_u32 v3, v2, 1, 3
  v_xor_b32 v3, v3, v7
  v_add_u32 v2, s38, v2
  v_min_u32 v2, 2047, v2
  v_mul_u32_u24 v2, 1152, v2
  v_lshl_add_u32 v16, v3, 4, v2
  v_subrev_u32 v16, 2048, v16
  s_mul_i32 s35, s27, 6144
  s_mul_i32 s36, s27, 3072
  s_add_u32 s36, s36, 24576
  s_mov_b32 s29, 0
  s_mov_b32 s31, 0
  s_mov_b32 s40, -1
  s_and_b32 s37, s27, 1
  s_cselect_b32 s41, 0x00ffffff, -1
  s_waitcnt lgkmcnt(0)
  s_mov_b32 s8, s64
  s_mov_b32 s9, s65
  s_mov_b32 s10, 2359296
  s_mov_b32 s11, 0x20000
  s_sub_u32 s12, s66, 1024
  s_subb_u32 s13, s67, 0
  s_mov_b32 s14, 1991680
  s_mov_b32 s15, 0x20000
L_pro_3012:
  s_add_u32 m0, s33, s36
  s_add_u32 s30, s29, 27648
  buffer_load_dwordx4 v14, s[8:11], s31 offen offset:0 lds
  buffer_load_dwordx4 v15, s[8:11], s31 offen offset:1024 lds
  s_mov_b64 exec, s[40:41]
  buffer_load_dwordx4 v16, s[8:11], s31 offen offset:2048 lds
  s_mov_b64 exec, -1
  s_add_u32 m0, s33, s35
  s_add_u32 s31, s31, 128
  buffer_load_dwordx4 v8, s[12:15], s29 offen offset:0 lds
  buffer_load_dwordx4 v9, s[12:15], s29 offen offset:1024 lds
  buffer_load_dwordx4 v10, s[12:15], s29 offen offset:2048 lds
  s_add_u32 m0, m0, 3072
  s_add_u32 s29, s29, 221184
  buffer_load_dwordx4 v11, s[12:15], s30 offen offset:0 lds
  buffer_load_dwordx4 v12, s[12:15], s30 offen offset:1024 lds
  buffer_load_dwordx4 v13, s[12:15], s30 offen offset:2048 lds
  s_add_u32 s33, s33, 36864
  s_cmp_lt_u32 s33, 110592
  s_cbranch_scc1 L_pro_3012
  s_add_u32 s16, s84, 0
  s_addc_u32 s17, s85, 0
  s_mov_b32 s18, 2359296
  s_mov_b32 s19, 0x20000
  s_add_u32 s20, s84, 0
  s_addc_u32 s21, s85, 0
  s_mov_b32 s22, 2359296
  s_mov_b32 s23, 0x20000
  v_mov_b32 v26, 0
L_ld_3013:
  s_waitcnt vmcnt(18)
  s_barrier
  s_add_u32 m0, s33, s36
  s_add_u32 s30, s29, 27648
  buffer_load_dwordx4 v14, s[8:11], s31 offen offset:0 lds
  buffer_load_dwordx4 v15, s[8:11], s31 offen offset:1024 lds
  s_mov_b64 exec, s[40:41]
  buffer_load_dwordx4 v16, s[8:11], s31 offen offset:2048 lds
  s_mov_b64 exec, -1
  s_add_u32 m0, s33, s35
  s_add_u32 s31, s31, 128
  buffer_load_dwordx4 v8, s[12:15], s29 offen offset:0 lds
  buffer_load_dwordx4 v9, s[12:15], s29 offen offset:1024 lds
  buffer_load_dwordx4 v10, s[12:15], s29 offen offset:2048 lds
  s_add_u32 m0, m0, 3072
  s_add_u32 s29, s29, 221184
  buffer_load_dwordx4 v11, s[12:15], s30 offen offset:0 lds
  buffer_load_dwordx4 v12, s[12:15], s30 offen offset:1024 lds
  buffer_load_dwordx4 v13, s[12:15], s30 offen offset:2048 lds
  s_add_u32 s33, s33, 36864
  s_cmp_eq_u32 s33, 147456
  s_cselect_b32 s33, 0, s33
  s_add_u32 s34, s34, 1
  s_cmp_lt_u32 s34, 6
  s_cbranch_scc1 L_ld_3013
L_p1t:
  s_mov_b32 s52, s82
  s_mov_b32 s53, s83
  s_mov_b32 s54, 256
  s_mov_b32 s55, 0x20000
  v_and_b32 v27, 7, v1
  v_lshlrev_b32 v27, 3, v27
  buffer_load_dword v27, v27, s[52:55], 0 offen sc1
  s_mov_b32 s61, s26
  s_cmp_ge_u32 s63, 24
  s_cbranch_scc1 L_hlp_3014
  s_waitcnt vmcnt(19)
  s_barrier
  s_mul_i32 s24, s62, 24
  s_add_u32 s24, s24, s63
  s_mul_i32 s25, s24, 21846
  s_lshr_b32 s25, s25, 16
  s_mul_i32 s37, s25, 3
  s_sub_u32 s26, s24, s37
  s_and_b32 s27, s3, 3
  s_mul_i32 s37, s26, 384
  v_bfe_u32 v2, v1, 2, 2
  v_mul_u32_u24 v2, 1152, v2
  v_lshrrev_b32 v6, 4, v1
  v_and_b32 v7, 3, v1
  v_cmp_le_u32 vcc, 2, v6
  v_lshl_add_u32 v7, v7, 4, s37
  v_lshl_add_u32 v2, v6, 6, v2
  v_add_u32 v2, v2, v7
  v_cndmask_b32 v3, 0, 1, vcc
  v_mul_u32_u24 v3, 4224, v3
  v_add_u32 v9, 1024, v2
  v_add_u32 v11, 3712, v2
  v_add_u32 v2, 256, v2
  v_add_u32 v10, v2, v3
  s_and_b32 s37, s27, 1
  s_lshl_b32 s37, s37, 5
  s_mul_i32 s35, s27, 6144
  s_mul_i32 s29, s27, 18432
  s_mov_b32 s33, 0
  v_xor_b32 v12, 32, v9
  v_xor_b32 v188, s37, v9
  v_xor_b32 v13, 32, v10
  v_xor_b32 v189, s37, v10
  v_xor_b32 v14, 32, v11
  v_xor_b32 v190, s37, v11
  s_sub_u32 s12, s68, 1024
  s_subb_u32 s13, s69, 0
  s_mov_b32 s14, 664576
  s_mov_b32 s15, 0x20000
  s_lshl_b32 s37, s27, 3
  v_lshrrev_b32 v2, 3, v1
  v_add_u32 v2, s37, v2
  v_bfe_u32 v3, v2, 1, 3
  v_and_b32 v4, 7, v1
  v_xor_b32 v3, v3, v4
  v_mul_u32_u24 v2, 1152, v2
  v_lshl_add_u32 v8, v3, 4, v2
  s_mul_i32 s31, s25, 36864
  s_add_u32 s16, s84, 0
  s_addc_u32 s17, s85, 0
  s_mov_b32 s18, 2359296
  s_mov_b32 s19, 0x20000
  s_sub_u32 s8, s64, 1024
  s_subb_u32 s9, s65, 0
  s_mov_b32 s10, 2360320
  s_mov_b32 s11, 0x20000
  s_mul_i32 s37, s63, 27648
  s_mul_i32 s38, s27, 6912
  s_add_u32 s37, s37, s38
  s_add_u32 s37, s37, 1024
  v_lshl_add_u32 v2, v1, 7, s37
  v_cmp_gt_u32 vcc, 54, v1
  s_nop 1
  v_cndmask_b32 v2, -1, v2, vcc
  buffer_load_dword v250, v2, s[12:15], 0 offen
  s_getpc_b64 s[52:53]
L_pc_3016:
  s_sub_u32 s52, s52, L_pc_3016-sequential_preLN__linear_attn_block__mixer_token_mlp__prompt_kernel
  s_subb_u32 s53, s53, 0
  s_mov_b32 s54, L_cend-sequential_preLN__linear_attn_block__mixer_token_mlp__prompt_kernel
  s_mov_b32 s55, 0x20000
  s_mov_b32 s56, L_p1t-sequential_preLN__linear_attn_block__mixer_token_mlp__prompt_kernel
  s_cmp_eq_u32 s3, 5
  s_cselect_b32 s56, L_p1e-sequential_preLN__linear_attn_block__mixer_token_mlp__prompt_kernel, s56
  s_cmp_eq_u32 s3, 6
  s_cselect_b32 s56, L_p1e+8192-sequential_preLN__linear_attn_block__mixer_token_mlp__prompt_kernel, s56
  s_cmp_eq_u32 s3, 7
  s_cselect_b32 s56, L_p1e+16384-sequential_preLN__linear_attn_block__mixer_token_mlp__prompt_kernel, s56
  v_lshl_add_u32 v249, v1, 7, s56
  buffer_load_dword v250, v249, s[52:55], 0 offen
  s_waitcnt vmcnt(12)
  s_barrier
  s_waitcnt vmcnt(3)
  s_barrier
  s_mul_i32 s37, s27, 3072
  s_add_u32 m0, s37, 126976
  s_mul_i32 s37, s27, 9216
  s_add_u32 s37, s37, s31
  buffer_load_dwordx4 v188, s[8:11], s37 offen offset:0 lds
  buffer_load_dwordx4 v189, s[8:11], s37 offen offset:1024 lds
  buffer_load_dwordx4 v190, s[8:11], s37 offen offset:2048 lds
  v_lshrrev_b32 v6, 4, v1
  v_and_b32 v7, 15, v1
  v_lshrrev_b32 v2, 3, v7
  v_sub_u32 v2, v6, v2
  v_bfe_u32 v3, v7, 1, 2
  v_lshl_add_u32 v2, v2, 2, v3
  v_and_b32 v4, 1, v7
  v_lshlrev_b32 v4, 4, v4
  v_mov_b32 v5, 0x3f80
  v_lshlrev_b32 v4, v4, v5
  v_cmp_eq_u32 s[40:41], 0, v2
  v_cmp_eq_u32 s[42:43], 1, v2
  v_cmp_eq_u32 s[48:49], 2, v2
  v_cmp_eq_u32 s[50:51], 3, v2
  v_cndmask_b32 v148, 0, v4, s[40:41]
  v_cndmask_b32 v149, 0, v4, s[42:43]
  v_cndmask_b32 v150, 0, v4, s[48:49]
  v_cndmask_b32 v151, 0, v4, s[50:51]
  v_cmp_eq_u32 s[40:41], 8, v2
  v_cmp_eq_u32 s[42:43], 9, v2
  v_cmp_eq_u32 s[48:49], 10, v2
  v_cmp_eq_u32 s[50:51], 11, v2
  v_cndmask_b32 v152, 0, v4, s[40:41]
  v_cndmask_b32 v153, 0, v4, s[42:43]
  v_cndmask_b32 v154, 0, v4, s[48:49]
  v_cndmask_b32 v155, 0, v4, s[50:51]
  v_lshrrev_b32 v6, 4, v1
  v_and_b32 v7, 15, v1
  v_lshrrev_b32 v2, 1, v7
  v_lshlrev_b32 v2, 4, v2
  v_lshl_add_u32 v5, v7, 7, v2
  s_mul_i32 s37, s27, 288
  s_add_u32 s37, s37, 3984
  v_lshl_add_u32 v4, v6, 3, s37
  s_movk_i32 s38, 127
  s_add_u32 s20, s84, 12386304
  s_addc_u32 s21, s85, 0
  s_mov_b32 s22, 51200
  s_mov_b32 s23, 0x20000
  s_mul_i32 s34, s27, 12288
  s_add_u32 s34, s34, 6144
  v_lshl_add_u32 v15, v1, 4, s34
  v_and_b32 v2, 7, v7
  v_lshl_add_u32 v2, v6, 3, v2
  v_lshl_add_u32 v16, v2, 4, s34
  v_and_b32 v2, 1, v6
  v_cmp_eq_u32 vcc, 1, v2
  v_and_b32 v3, 3, v7
  v_add_u32 v3, 16, v3
  v_lshrrev_b32 v2, 1, v6
  v_cndmask_b32 v3, v7, v3, vcc
  v_mad_u32_u24 v2, v2, 20, v3
  v_lshl_add_u32 v26, v2, 3, s34
  s_movk_i32 s36, 3072
  v_add_u32 v2, 0, v4
  v_lshrrev_b32 v3, 7, v2
  v_bitop3_b32 v2, v2, s38, v5 bitop3:0x6a
  v_lshl_add_u32 v18, v3, 12, v2
  s_add_u32 s34, s37, 32
  v_mov_b32 v2, s34
  v_lshrrev_b32 v3, 7, v2
  v_bitop3_b32 v2, v2, s38, v5 bitop3:0x6a
  v_lshl_add_u32 v19, v3, 12, v2
  v_add_u32 v2, 40, v4
  v_lshrrev_b32 v3, 7, v2
  v_bitop3_b32 v2, v2, s38, v5 bitop3:0x6a
  v_lshl_add_u32 v20, v3, 12, v2
  v_add_u32 v2, 72, v4
  v_lshrrev_b32 v3, 7, v2
  v_bitop3_b32 v2, v2, s38, v5 bitop3:0x6a
  v_lshl_add_u32 v21, v3, 12, v2
  s_add_u32 s34, s37, 104
  v_mov_b32 v2, s34
  v_lshrrev_b32 v3, 7, v2
  v_bitop3_b32 v2, v2, s38, v5 bitop3:0x6a
  v_lshl_add_u32 v22, v3, 12, v2
  v_add_u32 v2, 112, v4
  v_lshrrev_b32 v3, 7, v2
  v_bitop3_b32 v2, v2, s38, v5 bitop3:0x6a
  v_lshl_add_u32 v23, v3, 12, v2
  s_mov_b32 s40, 0xffff
  s_mov_b32 s41, 0x0
  s_mov_b32 s42, 0xffff0000
  s_mov_b32 s43, 0x0
  s_mov_b32 s48, 0x0
  s_mov_b32 s49, 0xffff
  s_mov_b32 s50, 0x0
  s_mov_b32 s51, 0xffff0000
  s_mov_b32 s58, 0x358637bd
  v_lshlrev_b32 v2, 4, v6
  v_xor_b32 v24, v2, v5
  v_add_u32 v24, 122880, v24
  v_xor_b32 v25, 64, v24
  v_mul_u32_u24 v2, 3072, v6
  v_bfe_u32 v3, v1, 2, 2
  v_lshl_add_u32 v17, v3, 6, v2
  v_and_b32 v5, 1, v6
  v_lshlrev_b32 v5, 5, v5
  v_and_b32 v4, 3, v1
  s_mul_i32 s37, s27, 96
  v_lshl_add_u32 v4, v4, 3, s37
  s_movk_i32 s38, 63
  v_add_u32 v2, 0, v4
  v_lshrrev_b32 v3, 6, v2
  v_bitop3_b32 v2, v2, s38, v5 bitop3:0x6a
  v_lshl_add_u32 v2, v3, 8, v2
  v_add_u32 v184, v2, v17
  v_add_u32 v2, 32, v4
  v_lshrrev_b32 v3, 6, v2
  v_bitop3_b32 v2, v2, s38, v5 bitop3:0x6a
  v_lshl_add_u32 v2, v3, 8, v2
  v_add_u32 v185, v2, v17
  v_add_u32 v2, 64, v4
  v_lshrrev_b32 v3, 6, v2
  v_bitop3_b32 v2, v2, s38, v5 bitop3:0x6a
  v_lshl_add_u32 v2, v3, 8, v2
  v_add_u32 v186, v2, v17
  s_mul_i32 s37, s27, 6144
  s_add_u32 s37, s37, 98304
  v_lshl_add_u32 v17, v1, 4, s37
  s_cmp_ge_u32 s61, 8
  s_cselect_b32 s60, 2, 4
  s_mul_i32 s60, s60, 24576
  s_waitcnt vmcnt(5)
  s_branch L_b1_3015
L_hlp_3014:
  s_waitcnt vmcnt(19)
  s_barrier
  s_waitcnt vmcnt(10)
  s_barrier
  s_waitcnt vmcnt(1)
  s_barrier
  s_waitcnt vmcnt(0)
  s_mov_b32 s56, s72
  s_mov_b32 s57, s73
  s_mov_b32 s58, 18874368
  s_mov_b32 s59, 0x20000
  s_sub_u32 s60, s2, 192
  s_lshl2_add_u32 s60, s60, s27
  s_mul_i32 s60, s60, 8192
  s_add_u32 s60, s60, 4063232
  v_lshl_add_u32 v249, v1, 7, s60
  buffer_load_dword v250, v249, s[56:59], 0 offen
L_b1_3015:
  v_cmp_ne_u32 vcc, 1, v27
  s_cbranch_vccz L_fl_3017
  s_mov_b32 s52, s82
  s_mov_b32 s53, s83
  s_mov_b32 s54, 256
  s_mov_b32 s55, 0x20000
  v_lshlrev_b32 v2, 3, v1
  v_mov_b32 v3, 1
  s_mov_b32 exec_lo, 0xff
  s_mov_b32 exec_hi, 0
  s_mov_b32 s56, 0
L_poll_3019:
  buffer_load_dword v4, v2, s[52:55], 0 offen sc1
  s_add_u32 s56, s56, 1
  s_waitcnt vmcnt(0)
  v_cmp_ne_u32 vcc, v4, v3
  s_cmp_gt_u32 s56, 262144
  s_cbranch_scc1 L_got_3020
  s_cbranch_vccz L_got_3020
  s_sleep 1
  s_branch L_poll_3019
L_got_3020:
  s_mov_b64 exec, -1
L_fl_3017:
  s_barrier
  s_barrier
  s_cmp_ge_u32 s63, 24
  s_cbranch_scc1 L_nop2_3018
L_pa_3021:
  s_add_u32 m0, s33, s35
  s_add_u32 s30, s29, 9216
  buffer_load_dwordx4 v9, s[12:15], s29 offen offset:0 lds
  buffer_load_dwordx4 v10, s[12:15], s29 offen offset:1024 lds
  buffer_load_dwordx4 v11, s[12:15], s29 offen offset:2048 lds
  s_add_u32 m0, m0, 3072
  s_add_u32 s29, s29, 73728
  buffer_load_dwordx4 v12, s[12:15], s30 offen offset:0 lds
  buffer_load_dwordx4 v13, s[12:15], s30 offen offset:1024 lds
  buffer_load_dwordx4 v14, s[12:15], s30 offen offset:2048 lds
  s_add_u32 s33, s33, 24576
  s_cmp_lt_u32 s33, s60
  s_cbranch_scc1 L_pa_3021
L_nop2_3018:
  s_barrier
  s_cmp_ge_u32 s63, 24
  s_cbranch_scc1 L_l2k_3022
  s_cmp_lt_u32 s61, 8
  s_cbranch_scc1 L_nq_3023
L_pa_3024:
  s_add_u32 m0, s33, s35
  s_add_u32 s30, s29, 9216
  buffer_load_dwordx4 v9, s[12:15], s29 offen offset:0 lds
  buffer_load_dwordx4 v10, s[12:15], s29 offen offset:1024 lds
  buffer_load_dwordx4 v11, s[12:15], s29 offen offset:2048 lds
  s_add_u32 m0, m0, 3072
  s_add_u32 s29, s29, 73728
  buffer_load_dwordx4 v12, s[12:15], s30 offen offset:0 lds
  buffer_load_dwordx4 v13, s[12:15], s30 offen offset:1024 lds
  buffer_load_dwordx4 v14, s[12:15], s30 offen offset:2048 lds
  s_add_u32 s33, s33, 24576
  s_cmp_lt_u32 s33, 98304
  s_cbranch_scc1 L_pa_3024
L_nq_3023:
  s_waitcnt vmcnt(0)
  s_barrier
  ds_read_b64_tr_b16 v[28:29], v184 offset:0
  ds_read_b64_tr_b16 v[30:31], v184 offset:1536
  ds_read_b64_tr_b16 v[32:33], v185 offset:0
  ds_read_b64_tr_b16 v[34:35], v185 offset:1536
  ds_read_b64_tr_b16 v[36:37], v186 offset:0
  ds_read_b64_tr_b16 v[38:39], v186 offset:1536
  ds_read_b64_tr_b16 v[40:41], v184 offset:12288
  ds_read_b64_tr_b16 v[42:43], v184 offset:13824
  ds_read_b64_tr_b16 v[44:45], v185 offset:12288
  ds_read_b64_tr_b16 v[46:47], v185 offset:13824
  ds_read_b64_tr_b16 v[48:49], v186 offset:12288
  ds_read_b64_tr_b16 v[50:51], v186 offset:13824
  ds_read_b64_tr_b16 v[52:53], v184 offset:24576
  ds_read_b64_tr_b16 v[54:55], v184 offset:26112
  ds_read_b64_tr_b16 v[56:57], v185 offset:24576
  ds_read_b64_tr_b16 v[58:59], v185 offset:26112
  ds_read_b64_tr_b16 v[60:61], v186 offset:24576
  ds_read_b64_tr_b16 v[62:63], v186 offset:26112
  ds_read_b64_tr_b16 v[64:65], v184 offset:36864
  ds_read_b64_tr_b16 v[66:67], v184 offset:38400
  ds_read_b64_tr_b16 v[68:69], v185 offset:36864
  ds_read_b64_tr_b16 v[70:71], v185 offset:38400
  ds_read_b64_tr_b16 v[72:73], v186 offset:36864
  ds_read_b64_tr_b16 v[74:75], v186 offset:38400
  ds_read_b64_tr_b16 v[76:77], v184 offset:49152
  ds_read_b64_tr_b16 v[78:79], v184 offset:50688
  ds_read_b64_tr_b16 v[80:81], v185 offset:49152
  ds_read_b64_tr_b16 v[82:83], v185 offset:50688
  ds_read_b64_tr_b16 v[84:85], v186 offset:49152
  ds_read_b64_tr_b16 v[86:87], v186 offset:50688
  ds_read_b64_tr_b16 v[88:89], v184 offset:61440
  ds_read_b64_tr_b16 v[90:91], v184 offset:62976
  ds_read_b64_tr_b16 v[92:93], v185 offset:61440
  ds_read_b64_tr_b16 v[94:95], v185 offset:62976
  ds_read_b64_tr_b16 v[96:97], v186 offset:61440
  ds_read_b64_tr_b16 v[98:99], v186 offset:62976
  v_add_u32 v184, 73728, v184
  v_add_u32 v185, 73728, v185
  v_add_u32 v186, 73728, v186
  ds_read_b64_tr_b16 v[100:101], v184 offset:0
  ds_read_b64_tr_b16 v[102:103], v184 offset:1536
  ds_read_b64_tr_b16 v[104:105], v185 offset:0
  ds_read_b64_tr_b16 v[106:107], v185 offset:1536
  ds_read_b64_tr_b16 v[108:109], v186 offset:0
  ds_read_b64_tr_b16 v[110:111], v186 offset:1536
  ds_read_b64_tr_b16 v[112:113], v184 offset:12288
  ds_read_b64_tr_b16 v[114:115], v184 offset:13824
  ds_read_b64_tr_b16 v[116:117], v185 offset:12288
  ds_read_b64_tr_b16 v[118:119], v185 offset:13824
  ds_read_b64_tr_b16 v[120:121], v186 offset:12288
  ds_read_b64_tr_b16 v[122:123], v186 offset:13824
  ds_read_b64_tr_b16 v[204:205], v184 offset:53248
  ds_read_b64_tr_b16 v[206:207], v184 offset:54784
  ds_read_b64_tr_b16 v[208:209], v185 offset:53248
  ds_read_b64_tr_b16 v[210:211], v185 offset:54784
  ds_read_b64_tr_b16 v[212:213], v186 offset:53248
  ds_read_b64_tr_b16 v[214:215], v186 offset:54784
  s_add_u32 s52, s84, 20463616
  s_addc_u32 s53, s85, 0
  s_mov_b32 s54, 45056
  s_mov_b32 s55, 0x20000
  s_lshl_b32 s37, s25, 2
  s_add_u32 s37, s37, s27
  s_lshl_b32 s37, s37, 3
  v_and_b32 v2, 1, v1
  v_mad_u32_u24 v2, v2, 7, s37
  v_mul_u32_u24 v2, 5578, v2
  v_lshrrev_b32 v2, 19, v2
  v_add_u32 v2, 328, v2
  v_lshlrev_b32 v2, 7, v2
  v_mov_b32 v3, 3
  s_waitcnt lgkmcnt(0)
  s_barrier
  s_add_u32 m0, s33, s35
  s_add_u32 s30, s29, 9216
  buffer_load_dwordx4 v9, s[12:15], s29 offen offset:0 lds
  buffer_load_dwordx4 v10, s[12:15], s29 offen offset:1024 lds
  buffer_load_dwordx4 v11, s[12:15], s29 offen offset:2048 lds
  s_add_u32 m0, m0, 3072
  s_add_u32 s29, s29, 73728
  buffer_load_dwordx4 v12, s[12:15], s30 offen offset:0 lds
  buffer_load_dwordx4 v13, s[12:15], s30 offen offset:1024 lds
  buffer_load_dwordx4 v14, s[12:15], s30 offen offset:2048 lds
  s_add_u32 s33, s33, 24576
  v_mfma_f32_16x16x32_bf16 v[124:127], v[148:151], v[204:207], 0
  v_mfma_f32_16x16x32_bf16 v[128:131], v[152:155], v[204:207], 0
  v_mfma_f32_16x16x32_bf16 v[132:135], v[148:151], v[208:211], 0
  v_mfma_f32_16x16x32_bf16 v[136:139], v[152:155], v[208:211], 0
  v_mfma_f32_16x16x32_bf16 v[140:143], v[148:151], v[212:215], 0
  v_mfma_f32_16x16x32_bf16 v[144:147], v[152:155], v[212:215], 0
  buffer_load_dword v4, v2, s[52:55], 0 offen sc1
  s_add_u32 m0, s35, 0
  s_add_u32 s30, s29, 9216
  buffer_load_dwordx4 v9, s[12:15], s29 offen offset:0 lds
  buffer_load_dwordx4 v10, s[12:15], s29 offen offset:1024 lds
  buffer_load_dwordx4 v11, s[12:15], s29 offen offset:2048 lds
  s_add_u32 m0, m0, 3072
  s_add_u32 s29, s29, 73728
  buffer_load_dwordx4 v12, s[12:15], s30 offen offset:0 lds
  buffer_load_dwordx4 v13, s[12:15], s30 offen offset:1024 lds
  buffer_load_dwordx4 v14, s[12:15], s30 offen offset:2048 lds
  s_mov_b32 s60, 0
  s_waitcnt vmcnt(6)
  v_cmp_ne_u32 vcc, v4, v3
  s_cbranch_vccz L_qok_3025
  buffer_load_dword v4, v2, s[52:55], 0 offen sc1
  s_waitcnt vmcnt(0)
  v_cmp_ne_u32 vcc, v4, v3
  s_cbranch_vccz L_qok_3025
  s_mov_b32 s60, 1
  s_branch L_qno_3026
L_qok_3025:
  s_lshl_b32 s37, s27, 10
  s_add_u32 m0, s37, 122880
  s_nop 0
  buffer_load_dwordx4 v8, s[16:19], s31 offen sc1 lds
  s_add_u32 m0, m0, 4096
  s_add_u32 s31, s31, 128
  buffer_load_dwordx4 v8, s[16:19], s31 offen sc1 lds
  s_add_u32 m0, m0, 4096
  s_add_u32 s31, s31, 128
  buffer_load_dwordx4 v8, s[16:19], s31 offen sc1 lds
  s_add_u32 m0, m0, 4096
  s_add_u32 s31, s31, 128
  buffer_load_dwordx4 v8, s[16:19], s31 offen sc1 lds
  s_add_u32 m0, m0, 4096
  s_add_u32 s31, s31, 128
  buffer_load_dwordx4 v8, s[16:19], s31 offen sc1 lds
  s_add_u32 m0, m0, 4096
  s_add_u32 s31, s31, 128
  buffer_load_dwordx4 v8, s[16:19], s31 offen sc1 lds
  s_add_u32 m0, m0, 4096
  s_add_u32 s31, s31, 128
  buffer_load_dwordx4 v8, s[16:19], s31 offen sc1 lds
  s_add_u32 m0, m0, 4096
  s_add_u32 s31, s31, 128
  buffer_load_dwordx4 v8, s[16:19], s31 offen sc1 lds
  s_add_u32 m0, m0, 4096
  s_add_u32 s31, s31, 128
  buffer_load_dwordx4 v8, s[16:19], s31 offen sc1 lds
L_qno_3026:
L_lg2_3011:
  s_barrier
  s_setprio 1
  s_cmp_eq_u32 s60, 0
  s_cbranch_scc1 L_qin_3027
  s_lshl_b32 s37, s27, 10
  s_add_u32 m0, s37, 122880
  s_nop 0
  buffer_load_dwordx4 v8, s[16:19], s31 offen sc1 lds
  s_add_u32 m0, m0, 4096
  s_add_u32 s31, s31, 128
  buffer_load_dwordx4 v8, s[16:19], s31 offen sc1 lds
  s_add_u32 m0, m0, 4096
  s_add_u32 s31, s31, 128
  buffer_load_dwordx4 v8, s[16:19], s31 offen sc1 lds
  s_add_u32 m0, m0, 4096
  s_add_u32 s31, s31, 128
  buffer_load_dwordx4 v8, s[16:19], s31 offen sc1 lds
  s_add_u32 m0, m0, 4096
  s_add_u32 s31, s31, 128
  buffer_load_dwordx4 v8, s[16:19], s31 offen sc1 lds
  s_add_u32 m0, m0, 4096
  s_add_u32 s31, s31, 128
  buffer_load_dwordx4 v8, s[16:19], s31 offen sc1 lds
  s_add_u32 m0, m0, 4096
  s_add_u32 s31, s31, 128
  buffer_load_dwordx4 v8, s[16:19], s31 offen sc1 lds
  s_add_u32 m0, m0, 4096
  s_add_u32 s31, s31, 128
  buffer_load_dwordx4 v8, s[16:19], s31 offen sc1 lds
  s_add_u32 m0, m0, 4096
  s_add_u32 s31, s31, 128
  buffer_load_dwordx4 v8, s[16:19], s31 offen sc1 lds
L_qin_3027:
  buffer_load_dwordx2 v[220:221], v26, s[20:23], 0 offen offset:2560 sc1
  buffer_load_dwordx4 v[208:211], v16, s[20:23], 0 offen offset:2048 sc1
  buffer_load_dwordx4 v[204:207], v15, s[20:23], 0 offen offset:0 sc1
  buffer_load_dwordx4 v[212:215], v15, s[20:23], 0 offen offset:1024 sc1
  buffer_load_dwordx2 v[240:241], v26, s[20:23], s36 offen offset:2560 sc1
  buffer_load_dwordx4 v[228:231], v16, s[20:23], s36 offen offset:2048 sc1
  buffer_load_dwordx4 v[224:227], v15, s[20:23], s36 offen offset:0 sc1
  buffer_load_dwordx4 v[232:235], v15, s[20:23], s36 offen offset:1024 sc1
  v_mov_b32 v151, 0
  v_mov_b32 v155, 0
  v_mov_b32 v156, 0
  v_mov_b32 v160, 0
  v_mov_b32 v167, 0
  v_mov_b32 v171, 0
  v_mov_b32 v172, 0
  v_mov_b32 v176, 0
  s_waitcnt vmcnt(8)
  s_barrier
  ds_read_b64 v[180:181], v18 offset:0
  ds_read_b64 v[182:183], v19 offset:0
  ds_read_b64 v[184:185], v20 offset:0
  ds_read_b64 v[186:187], v18 offset:2048
  ds_read_b64 v[188:189], v19 offset:2048
  ds_read_b64 v[190:191], v20 offset:2048
  ds_read_b64 v[192:193], v21 offset:0
  ds_read_b64 v[194:195], v22 offset:0
  ds_read_b64 v[196:197], v23 offset:0
  ds_read_b64 v[198:199], v21 offset:2048
  ds_read_b64 v[200:201], v22 offset:2048
  ds_read_b64 v[202:203], v23 offset:2048
  s_add_u32 m0, s35, 24576
  s_add_u32 s30, s29, 9216
  buffer_load_dwordx4 v9, s[12:15], s29 offen offset:0 lds
  buffer_load_dwordx4 v10, s[12:15], s29 offen offset:1024 lds
  buffer_load_dwordx4 v11, s[12:15], s29 offen offset:2048 lds
  s_add_u32 m0, m0, 3072
  s_add_u32 s29, s29, 73728
  buffer_load_dwordx4 v12, s[12:15], s30 offen offset:0 lds
  buffer_load_dwordx4 v13, s[12:15], s30 offen offset:1024 lds
  buffer_load_dwordx4 v14, s[12:15], s30 offen offset:2048 lds
  s_waitcnt vmcnt(10)
  v_cvt_pk_bf16_f32 v220, v220, v221
  v_cvt_pk_bf16_f32 v152, v208, v209
  v_cvt_pk_bf16_f32 v153, v210, v211
  v_cvt_pk_bf16_f32 v162, v208, v209
  v_cvt_pk_bf16_f32 v163, v210, v211
  v_cndmask_b32 v150, 0, v220, s[40:41]
  v_cndmask_b32 v154, 0, v220, s[42:43]
  v_cndmask_b32 v157, 0, v220, s[48:49]
  v_cndmask_b32 v161, 0, v220, s[50:51]
  v_mov_b32_dpp v152, v152 row_shr:4 row_mask:0xf bank_mask:0xa
  v_mov_b32_dpp v153, v153 row_shr:4 row_mask:0xf bank_mask:0xa
  v_mov_b32_dpp v162, v162 row_shl:4 row_mask:0xf bank_mask:0x5
  v_mov_b32_dpp v163, v163 row_shl:4 row_mask:0xf bank_mask:0x5
  v_cvt_pk_bf16_f32 v148, v204, v205
  v_cvt_pk_bf16_f32 v149, v206, v207
  v_cvt_pk_bf16_f32 v158, v212, v213
  v_cvt_pk_bf16_f32 v159, v214, v215
  s_waitcnt vmcnt(6)
  v_cvt_pk_bf16_f32 v240, v240, v241
  v_cvt_pk_bf16_f32 v168, v228, v229
  v_cvt_pk_bf16_f32 v169, v230, v231
  v_cvt_pk_bf16_f32 v178, v228, v229
  v_cvt_pk_bf16_f32 v179, v230, v231
  v_cndmask_b32 v166, 0, v240, s[40:41]
  v_cndmask_b32 v170, 0, v240, s[42:43]
  v_cndmask_b32 v173, 0, v240, s[48:49]
  v_cndmask_b32 v177, 0, v240, s[50:51]
  v_mov_b32_dpp v168, v168 row_shr:4 row_mask:0xf bank_mask:0xa
  v_mov_b32_dpp v169, v169 row_shr:4 row_mask:0xf bank_mask:0xa
  v_mov_b32_dpp v178, v178 row_shl:4 row_mask:0xf bank_mask:0x5
  v_mov_b32_dpp v179, v179 row_shl:4 row_mask:0xf bank_mask:0x5
  v_cvt_pk_bf16_f32 v164, v224, v225
  v_cvt_pk_bf16_f32 v165, v226, v227
  v_cvt_pk_bf16_f32 v174, v232, v233
  v_cvt_pk_bf16_f32 v175, v234, v235
  s_waitcnt lgkmcnt(0)
  v_mfma_f32_16x16x32_bf16 v[204:207], v[148:151], v[180:183], 0
  v_mfma_f32_16x16x32_bf16 v[208:211], v[152:155], v[180:183], 0
  v_mfma_f32_16x16x32_bf16 v[212:215], v[156:159], v[182:185], 0
  v_mfma_f32_16x16x32_bf16 v[216:219], v[160:163], v[182:185], 0
  v_mfma_f32_16x16x32_bf16 v[220:223], v[148:151], v[186:189], 0
  v_mfma_f32_16x16x32_bf16 v[224:227], v[152:155], v[186:189], 0
  v_mfma_f32_16x16x32_bf16 v[228:231], v[156:159], v[188:191], 0
  v_mfma_f32_16x16x32_bf16 v[232:235], v[160:163], v[188:191], 0
  v_mfma_f32_16x16x32_bf16 v[236:239], v[164:167], v[192:195], 0
  v_mfma_f32_16x16x32_bf16 v[240:243], v[168:171], v[192:195], 0
  v_mfma_f32_16x16x32_bf16 v[244:247], v[172:175], v[194:197], 0
  v_mfma_f32_16x16x32_bf16 v[248:251], v[176:179], v[194:197], 0
  v_add_f32 v210, s58, v210
  v_add_f32 v218, s58, v218
  v_rcp_f32 v210, v210
  v_rcp_f32 v218, v218
  v_pk_mul_f32 v[204:205], v[204:205], v[210:211] op_sel_hi:[1,0]
  v_pk_mul_f32 v[206:207], v[206:207], v[210:211] op_sel_hi:[1,0]
  v_pk_mul_f32 v[208:209], v[208:209], v[210:211] op_sel_hi:[1,0]
  v_pk_mul_f32 v[212:213], v[212:213], v[218:219] op_sel_hi:[1,0]
  v_pk_mul_f32 v[214:215], v[214:215], v[218:219] op_sel_hi:[1,0]
  v_pk_mul_f32 v[216:217], v[216:217], v[218:219] op_sel_hi:[1,0]
  v_cvt_pk_bf16_f32 v180, v204, v205
  v_cvt_pk_bf16_f32 v181, v206, v207
  v_cvt_pk_bf16_f32 v182, v208, v209
  v_cvt_pk_bf16_f32 v183, v216, v217
  v_cvt_pk_bf16_f32 v184, v212, v213
  v_cvt_pk_bf16_f32 v185, v214, v215
  v_mfma_f32_16x16x32_bf16 v[204:207], v[164:167], v[198:201], 0
  v_mfma_f32_16x16x32_bf16 v[208:211], v[168:171], v[198:201], 0
  v_mfma_f32_16x16x32_bf16 v[212:215], v[172:175], v[200:203], 0
  v_mfma_f32_16x16x32_bf16 v[216:219], v[176:179], v[200:203], 0
  ds_write_b64 v18, v[180:181] offset:0
  ds_write_b64 v19, v[182:183] offset:0
  ds_write_b64 v20, v[184:185] offset:0
  v_add_f32 v226, s58, v226
  v_add_f32 v234, s58, v234
  v_rcp_f32 v226, v226
  v_rcp_f32 v234, v234
  v_pk_mul_f32 v[220:221], v[220:221], v[226:227] op_sel_hi:[1,0]
  v_pk_mul_f32 v[222:223], v[222:223], v[226:227] op_sel_hi:[1,0]
  v_pk_mul_f32 v[224:225], v[224:225], v[226:227] op_sel_hi:[1,0]
  v_pk_mul_f32 v[228:229], v[228:229], v[234:235] op_sel_hi:[1,0]
  v_pk_mul_f32 v[230:231], v[230:231], v[234:235] op_sel_hi:[1,0]
  v_pk_mul_f32 v[232:233], v[232:233], v[234:235] op_sel_hi:[1,0]
  v_cvt_pk_bf16_f32 v186, v220, v221
  v_cvt_pk_bf16_f32 v187, v222, v223
  v_cvt_pk_bf16_f32 v188, v224, v225
  v_cvt_pk_bf16_f32 v189, v232, v233
  v_cvt_pk_bf16_f32 v190, v228, v229
  v_cvt_pk_bf16_f32 v191, v230, v231
  ds_write_b64 v18, v[186:187] offset:2048
  ds_write_b64 v19, v[188:189] offset:2048
  ds_write_b64 v20, v[190:191] offset:2048
  v_add_f32 v242, s58, v242
  v_add_f32 v250, s58, v250
  v_rcp_f32 v242, v242
  v_rcp_f32 v250, v250
  v_pk_mul_f32 v[236:237], v[236:237], v[242:243] op_sel_hi:[1,0]
  v_pk_mul_f32 v[238:239], v[238:239], v[242:243] op_sel_hi:[1,0]
  v_pk_mul_f32 v[240:241], v[240:241], v[242:243] op_sel_hi:[1,0]
  v_pk_mul_f32 v[244:245], v[244:245], v[250:251] op_sel_hi:[1,0]
  v_pk_mul_f32 v[246:247], v[246:247], v[250:251] op_sel_hi:[1,0]
  v_pk_mul_f32 v[248:249], v[248:249], v[250:251] op_sel_hi:[1,0]
  v_cvt_pk_bf16_f32 v192, v236, v237
  v_cvt_pk_bf16_f32 v193, v238, v239
  v_cvt_pk_bf16_f32 v194, v240, v241
  v_cvt_pk_bf16_f32 v195, v248, v249
  v_cvt_pk_bf16_f32 v196, v244, v245
  v_cvt_pk_bf16_f32 v197, v246, v247
  ds_write_b64 v21, v[192:193] offset:0
  ds_write_b64 v22, v[194:195] offset:0
  ds_write_b64 v23, v[196:197] offset:0
  v_add_f32 v210, s58, v210
  v_add_f32 v218, s58, v218
  v_rcp_f32 v210, v210
  v_rcp_f32 v218, v218
  v_pk_mul_f32 v[204:205], v[204:205], v[210:211] op_sel_hi:[1,0]
  v_pk_mul_f32 v[206:207], v[206:207], v[210:211] op_sel_hi:[1,0]
  v_pk_mul_f32 v[208:209], v[208:209], v[210:211] op_sel_hi:[1,0]
  v_pk_mul_f32 v[212:213], v[212:213], v[218:219] op_sel_hi:[1,0]
  v_pk_mul_f32 v[214:215], v[214:215], v[218:219] op_sel_hi:[1,0]
  v_pk_mul_f32 v[216:217], v[216:217], v[218:219] op_sel_hi:[1,0]
  v_cvt_pk_bf16_f32 v198, v204, v205
  v_cvt_pk_bf16_f32 v199, v206, v207
  v_cvt_pk_bf16_f32 v200, v208, v209
  v_cvt_pk_bf16_f32 v201, v216, v217
  v_cvt_pk_bf16_f32 v202, v212, v213
  v_cvt_pk_bf16_f32 v203, v214, v215
  ds_write_b64 v21, v[198:199] offset:2048
  ds_write_b64 v22, v[200:201] offset:2048
  ds_write_b64 v23, v[202:203] offset:2048
  s_waitcnt vmcnt(0) lgkmcnt(0)
  s_barrier
  s_setprio 2
  ds_read_b128 v[148:151], v24 offset:0
  ds_read_b128 v[152:155], v24 offset:2048
  ds_read_b128 v[156:159], v25 offset:0
  ds_read_b128 v[160:163], v25 offset:2048
  ds_read_b128 v[164:167], v24 offset:4096
  ds_read_b128 v[168:171], v24 offset:6144
  ds_read_b128 v[172:175], v25 offset:4096
  ds_read_b128 v[176:179], v25 offset:6144
  ds_read_b128 v[180:183], v24 offset:8192
  ds_read_b128 v[184:187], v24 offset:10240
  ds_read_b128 v[188:191], v25 offset:8192
  ds_read_b128 v[192:195], v25 offset:10240
  ds_read_b128 v[196:199], v24 offset:12288
  ds_read_b128 v[200:203], v24 offset:14336
  ds_read_b128 v[204:207], v25 offset:12288
  ds_read_b128 v[208:211], v25 offset:14336
  s_waitcnt lgkmcnt(14)
  v_mfma_f32_16x16x32_bf16 v[124:127], v[148:151], v[28:31], v[124:127]
  s_add_u32 m0, s35, 49152
  s_add_u32 s30, s29, 9216
  buffer_load_dwordx4 v9, s[12:15], s29 offen offset:0 lds
  buffer_load_dwordx4 v10, s[12:15], s29 offen offset:1024 lds
  v_mfma_f32_16x16x32_bf16 v[128:131], v[152:155], v[28:31], v[128:131]
  buffer_load_dwordx4 v11, s[12:15], s29 offen offset:2048 lds
  s_add_u32 m0, m0, 3072
  s_add_u32 s29, s29, 73728
  buffer_load_dwordx4 v12, s[12:15], s30 offen offset:0 lds
  v_mfma_f32_16x16x32_bf16 v[132:135], v[148:151], v[32:35], v[132:135]
  buffer_load_dwordx4 v13, s[12:15], s30 offen offset:1024 lds
  buffer_load_dwordx4 v14, s[12:15], s30 offen offset:2048 lds
  v_mfma_f32_16x16x32_bf16 v[136:139], v[152:155], v[32:35], v[136:139]
  s_add_u32 m0, s35, 73728
  s_add_u32 s30, s29, 9216
  buffer_load_dwordx4 v9, s[12:15], s29 offen offset:0 lds
  buffer_load_dwordx4 v10, s[12:15], s29 offen offset:1024 lds
  v_mfma_f32_16x16x32_bf16 v[140:143], v[148:151], v[36:39], v[140:143]
  buffer_load_dwordx4 v11, s[12:15], s29 offen offset:2048 lds
  s_add_u32 m0, m0, 3072
  s_add_u32 s29, s29, 73728
  buffer_load_dwordx4 v12, s[12:15], s30 offen offset:0 lds
  v_mfma_f32_16x16x32_bf16 v[144:147], v[152:155], v[36:39], v[144:147]
  buffer_load_dwordx4 v13, s[12:15], s30 offen offset:1024 lds
  buffer_load_dwordx4 v14, s[12:15], s30 offen offset:2048 lds
  s_waitcnt lgkmcnt(12)
  v_mfma_f32_16x16x32_bf16 v[124:127], v[156:159], v[40:43], v[124:127]
  v_mfma_f32_16x16x32_bf16 v[128:131], v[160:163], v[40:43], v[128:131]
  v_mfma_f32_16x16x32_bf16 v[132:135], v[156:159], v[44:47], v[132:135]
  v_mfma_f32_16x16x32_bf16 v[136:139], v[160:163], v[44:47], v[136:139]
  v_mfma_f32_16x16x32_bf16 v[140:143], v[156:159], v[48:51], v[140:143]
  v_mfma_f32_16x16x32_bf16 v[144:147], v[160:163], v[48:51], v[144:147]
  s_waitcnt lgkmcnt(10)
  v_mfma_f32_16x16x32_bf16 v[124:127], v[164:167], v[52:55], v[124:127]
  v_mfma_f32_16x16x32_bf16 v[128:131], v[168:171], v[52:55], v[128:131]
  v_mfma_f32_16x16x32_bf16 v[132:135], v[164:167], v[56:59], v[132:135]
  v_mfma_f32_16x16x32_bf16 v[136:139], v[168:171], v[56:59], v[136:139]
  v_mfma_f32_16x16x32_bf16 v[140:143], v[164:167], v[60:63], v[140:143]
  v_mfma_f32_16x16x32_bf16 v[144:147], v[168:171], v[60:63], v[144:147]
  s_waitcnt lgkmcnt(8)
  v_mfma_f32_16x16x32_bf16 v[124:127], v[172:175], v[64:67], v[124:127]
  v_mfma_f32_16x16x32_bf16 v[128:131], v[176:179], v[64:67], v[128:131]
  v_mfma_f32_16x16x32_bf16 v[132:135], v[172:175], v[68:71], v[132:135]
  v_mfma_f32_16x16x32_bf16 v[136:139], v[176:179], v[68:71], v[136:139]
  v_mfma_f32_16x16x32_bf16 v[140:143], v[172:175], v[72:75], v[140:143]
  v_mfma_f32_16x16x32_bf16 v[144:147], v[176:179], v[72:75], v[144:147]
  s_waitcnt lgkmcnt(6)
  v_mfma_f32_16x16x32_bf16 v[124:127], v[180:183], v[76:79], v[124:127]
  v_mfma_f32_16x16x32_bf16 v[128:131], v[184:187], v[76:79], v[128:131]
  v_mfma_f32_16x16x32_bf16 v[132:135], v[180:183], v[80:83], v[132:135]
  v_mfma_f32_16x16x32_bf16 v[136:139], v[184:187], v[80:83], v[136:139]
  v_mfma_f32_16x16x32_bf16 v[140:143], v[180:183], v[84:87], v[140:143]
  v_mfma_f32_16x16x32_bf16 v[144:147], v[184:187], v[84:87], v[144:147]
  s_waitcnt lgkmcnt(4)
  v_mfma_f32_16x16x32_bf16 v[124:127], v[188:191], v[88:91], v[124:127]
  v_mfma_f32_16x16x32_bf16 v[128:131], v[192:195], v[88:91], v[128:131]
  v_mfma_f32_16x16x32_bf16 v[132:135], v[188:191], v[92:95], v[132:135]
  v_mfma_f32_16x16x32_bf16 v[136:139], v[192:195], v[92:95], v[136:139]
  v_mfma_f32_16x16x32_bf16 v[140:143], v[188:191], v[96:99], v[140:143]
  v_mfma_f32_16x16x32_bf16 v[144:147], v[192:195], v[96:99], v[144:147]
  s_waitcnt lgkmcnt(2)
  v_mfma_f32_16x16x32_bf16 v[124:127], v[196:199], v[100:103], v[124:127]
  v_mfma_f32_16x16x32_bf16 v[128:131], v[200:203], v[100:103], v[128:131]
  v_mfma_f32_16x16x32_bf16 v[132:135], v[196:199], v[104:107], v[132:135]
  v_mfma_f32_16x16x32_bf16 v[136:139], v[200:203], v[104:107], v[136:139]
  v_mfma_f32_16x16x32_bf16 v[140:143], v[196:199], v[108:111], v[140:143]
  v_mfma_f32_16x16x32_bf16 v[144:147], v[200:203], v[108:111], v[144:147]
  s_waitcnt lgkmcnt(0)
  v_mfma_f32_16x16x32_bf16 v[124:127], v[204:207], v[112:115], v[124:127]
  v_mfma_f32_16x16x32_bf16 v[128:131], v[208:211], v[112:115], v[128:131]
  v_mfma_f32_16x16x32_bf16 v[132:135], v[204:207], v[116:119], v[132:135]
  v_mfma_f32_16x16x32_bf16 v[136:139], v[208:211], v[116:119], v[136:139]
  v_mfma_f32_16x16x32_bf16 v[140:143], v[204:207], v[120:123], v[140:143]
  v_mfma_f32_16x16x32_bf16 v[144:147], v[208:211], v[120:123], v[144:147]
  s_nop 2
  ds_write_b128 v17, v[124:127] offset:0
  ds_write_b128 v17, v[128:131] offset:1024
  ds_write_b128 v17, v[132:135] offset:2048
  ds_write_b128 v17, v[136:139] offset:3072
  ds_write_b128 v17, v[140:143] offset:4096
  ds_write_b128 v17, v[144:147] offset:5120
  s_waitcnt vmcnt(0)
  s_waitcnt lgkmcnt(0)
  s_setprio 0
  s_barrier
  s_getpc_b64 s[52:53]
L_pc_3028:
  s_sub_u32 s52, s52, L_pc_3028-sequential_preLN__linear_attn_block__mixer_token_mlp__prompt_kernel
  s_subb_u32 s53, s53, 0
  s_mov_b32 s54, L_cend-sequential_preLN__linear_attn_block__mixer_token_mlp__prompt_kernel
  s_mov_b32 s55, 0x20000
  s_mov_b32 s56, L_p2t-sequential_preLN__linear_attn_block__mixer_token_mlp__prompt_kernel
  s_cmp_eq_u32 s3, 5
  s_cselect_b32 s56, L_p3c-sequential_preLN__linear_attn_block__mixer_token_mlp__prompt_kernel, s56
  s_cmp_eq_u32 s3, 6
  s_cselect_b32 s56, L_cend-sequential_preLN__linear_attn_block__mixer_token_mlp__prompt_kernel, s56
  s_cmp_eq_u32 s3, 7
  s_cselect_b32 s56, L_cend-sequential_preLN__linear_attn_block__mixer_token_mlp__prompt_kernel, s56
  v_lshl_add_u32 v249, v1, 7, s56
  buffer_load_dword v250, v249, s[52:55], 0 offen
L_p2t:
  s_barrier
  s_barrier
  s_and_b32 s57, s2, 15
  s_cmp_lg_u32 s3, 4
  s_cbranch_scc1 L_nw4_3029
  s_add_u32 s52, s84, 20463616
  s_addc_u32 s53, s85, 0
  s_mov_b32 s54, 45056
  s_mov_b32 s55, 0x20000
  s_add_u32 s56, s57, 128
  s_lshl_b32 s56, s56, 7
  v_mul_u32_u24 v2, 2048, v1
  v_mov_b32 v3, 1
  v_add_u32 v2, s56, v2
  s_mov_b64 exec, 255
  buffer_atomic_add v3, v2, s[52:55], 0 offen
  s_mov_b64 exec, -1
L_nw4_3029:
  s_mul_i32 s24, s62, 27
  s_add_u32 s24, s24, s63
  s_mul_i32 s25, s24, 43691
  s_lshr_b32 s25, s25, 18
  s_mul_i32 s36, s25, 6
  s_sub_u32 s26, s24, s36
  s_and_b32 s27, s3, 3
  s_bfe_u32 s28, s3, 0x10001
  s_and_b32 s29, s3, 1
  s_lshl_b32 s38, s25, 1
  v_bfe_u32 v2, v1, 2, 2
  v_mul_u32_u24 v2, 9216, v2
  v_lshrrev_b32 v3, 4, v1
  v_lshl_add_u32 v2, v3, 6, v2
  v_and_b32 v3, 3, v1
  v_xor_b32 v4, 2, v3
  s_mul_i32 s36, s27, 147456
  s_lshl_b32 s30, s38, 7
  s_add_u32 s36, s36, s30
  v_add_u32 v2, s36, v2
  v_lshl_add_u32 v8, v3, 4, v2
  v_lshl_add_u32 v9, v4, 4, v2
  v_add_u32 v10, 71680, v8
  v_add_u32 v9, 35840, v9
  v_add_u32 v11, 71680, v9
  s_mul_i32 s39, s26, 0
  s_lshr_b32 s39, s39, 12
  s_mul_i32 s30, s39, 589824
  s_lshl_b32 s35, s27, 12
  s_mov_b32 s33, 0
  s_mov_b32 s8, s72
  s_mov_b32 s9, s73
  s_mov_b32 s10, 18874368
  s_mov_b32 s11, 0x20000
L_pro_3030:
  s_add_u32 m0, s33, s35
  s_add_u32 s33, s33, 28672
  buffer_load_dwordx4 v8, s[8:11], s30 offen offset:0 lds
  buffer_load_dwordx4 v9, s[8:11], s30 offen offset:1024 lds
  buffer_load_dwordx4 v10, s[8:11], s30 offen offset:2048 lds
  buffer_load_dwordx4 v11, s[8:11], s30 offen offset:3072 lds
  s_add_u32 s30, s30, 589824
  s_cmp_lt_u32 s33, 143360
  s_cbranch_scc1 L_pro_3030
  s_mul_i32 s36, s29, 3
  s_mul_i32 s31, s26, 6
  s_add_u32 s36, s36, s31
  s_mul_i32 s31, s28, 43008
  v_and_b32 v3, 7, v1
  v_lshrrev_b32 v2, 3, v1
  v_lshl_add_u32 v3, v3, 4, s31
  s_lshl_b32 s31, s36, 3
  v_add_u32 v2, s31, v2
  v_add_u32 v12, 4, v2
  v_mul_u32_u24 v12, 9363, v12
  v_lshrrev_b32 v12, 16, v12
  v_add3_u32 v12, v12, v2, 0
  v_lshl_add_u32 v12, v12, 7, v3
  v_add_u32 v13, 12, v2
  v_mul_u32_u24 v13, 9363, v13
  v_lshrrev_b32 v13, 16, v13
  v_add3_u32 v13, v13, v2, 0
  v_lshl_add_u32 v13, v13, 7, v3
  v_add_u32 v14, 20, v2
  v_mul_u32_u24 v14, 9363, v14
  v_lshrrev_b32 v14, 16, v14
  v_add3_u32 v14, v14, v2, 0
  v_lshl_add_u32 v14, v14, 7, v3
  s_mul_i32 s31, s39, 86016
  s_mul_i32 s37, s27, 3072
  s_add_u32 s37, s37, 16384
  s_mov_b32 s33, 0
  s_add_u32 s12, s84, 33554432
  s_addc_u32 s13, s85, 0
  s_mov_b32 s14, 2752512
  s_mov_b32 s15, 0x20000
  s_lshl_b32 s44, s62, 2
  s_lshr_b32 s44, 0x34560012, s44
  s_and_b32 s44, s44, 15
  s_mul_i32 s44, s44, 3
  s_cmp_eq_u32 s62, 3
  s_cselect_b32 s45, 3, 6
  s_cmp_lt_u32 s63, s44
  s_cselect_b32 s45, 0, s45
  s_sub_u32 s45, s63, s45
  s_lshl2_add_u32 s46, s45, s27
  s_mul_i32 s46, s46, 9216
  s_lshr_b32 s47, s62, 2
  s_add_u32 s47, s47, s62
  s_lshl_b32 s47, s47, 10
  s_add_u32 s46, s46, s47
  s_add_u32 s46, s46, 2949376
  s_and_b32 s44, s25, 3
  s_cmp_eq_u32 s44, 1
  s_cselect_b32 s45, 99, s45
  s_cmp_lt_u32 s45, 16
  s_cselect_b32 s46, s46, 18874112
  s_add_u32 s47, s46, 1024
  s_or_b32 s44, s62, 1
  s_cmp_eq_u32 s44, 3
  s_cselect_b32 s47, s47, 18874112
  s_min_u32 s46, s46, 18874112
  s_min_u32 s47, s47, 18874112
  s_add_u32 s50, s46, 60
  s_buffer_load_dwordx2 s[44:45], s[8:11], s50
  s_add_u32 s50, s46, 188
  s_buffer_load_dwordx2 s[44:45], s[8:11], s50
  s_add_u32 s46, s46, 589824
  s_add_u32 s50, s47, 60
  s_buffer_load_dwordx2 s[44:45], s[8:11], s50
  s_add_u32 s50, s47, 188
  s_buffer_load_dwordx2 s[44:45], s[8:11], s50
  s_add_u32 s47, s47, 589824
  s_branch L_lg3_3007
L_l2k_3022:
  s_barrier
  s_barrier
L_l2i_3006:
  v_lshlrev_b32 v2, 7, v0
  s_mov_b32 s8, s72
  s_mov_b32 s9, s73
  s_mov_b32 s10, 18874368
  s_mov_b32 s11, 0x20000
  s_mov_b32 s56, s76
  s_mov_b32 s57, s77
  s_mov_b32 s58, 18874368
  s_mov_b32 s59, 0x20000
  s_add_u32 s4, s2, -106
  s_mov_b32 s5, 1
  s_cmp_eq_u32 s5, 0
  s_cbranch_scc1 L_ple_3032
L_pl_3031:
  s_sub_u32 s6, s4, 288
  s_cbranch_scc0 L_pl2_3033
  s_lshl_b32 s6, s4, 16
  v_add_u32 v3, s6, v2
  buffer_load_dword v250, v3, s[8:11], 0 offen
  s_branch L_pl3_3034
L_pl2_3033:
  s_and_b32 s7, s6, 3
  s_mul_i32 s7, s7, 72
  s_lshr_b32 s6, s6, 2
  s_add_u32 s6, s6, s7
  s_lshl_b32 s6, s6, 16
  v_add_u32 v3, s6, v2
  buffer_load_dword v250, v3, s[56:59], 0 offen
L_pl3_3034:
  s_mov_b64 exec, -1
  s_add_u32 s4, s4, 64
  s_sub_u32 s5, s5, 1
  s_waitcnt vmcnt(0)
  s_cmp_lg_u32 s5, 0
  s_cbranch_scc1 L_pl_3031
L_ple_3032:
  v_lshlrev_b32 v2, 7, v0
  s_mov_b32 s8, s72
  s_mov_b32 s9, s73
  s_mov_b32 s10, 18874368
  s_mov_b32 s11, 0x20000
  s_mov_b32 s56, s76
  s_mov_b32 s57, s77
  s_mov_b32 s58, 18874368
  s_mov_b32 s59, 0x20000
  s_add_u32 s4, s2, -42
  s_mov_b32 s5, 1
  s_cmp_eq_u32 s5, 0
  s_cbranch_scc1 L_ple_3038
L_pl_3037:
  s_sub_u32 s6, s4, 288
  s_cbranch_scc0 L_pl2_3039
  s_lshl_b32 s6, s4, 16
  v_add_u32 v3, s6, v2
  buffer_load_dword v250, v3, s[8:11], 0 offen
  s_branch L_pl3_3040
L_pl2_3039:
  s_and_b32 s7, s6, 3
  s_mul_i32 s7, s7, 72
  s_lshr_b32 s6, s6, 2
  s_add_u32 s6, s6, s7
  s_lshl_b32 s6, s6, 16
  v_add_u32 v3, s6, v2
  buffer_load_dword v250, v3, s[56:59], 0 offen
L_pl3_3040:
  s_mov_b64 exec, -1
  s_add_u32 s4, s4, 64
  s_sub_u32 s5, s5, 1
  s_waitcnt vmcnt(0)
  s_cmp_lg_u32 s5, 0
  s_cbranch_scc1 L_pl_3037
L_ple_3038:
  v_lshlrev_b32 v2, 7, v0
  s_mov_b32 s8, s72
  s_mov_b32 s9, s73
  s_mov_b32 s10, 18874368
  s_mov_b32 s11, 0x20000
  s_mov_b32 s56, s76
  s_mov_b32 s57, s77
  s_mov_b32 s58, 18874368
  s_mov_b32 s59, 0x20000
  s_add_u32 s4, s2, 22
  s_cmp_lt_u32 s63, 27
  s_cselect_b32 s5, 2, 0
  s_cmp_eq_u32 s5, 0
  s_cbranch_scc1 L_ple_3044
L_pl_3043:
  s_sub_u32 s6, s4, 288
  s_cbranch_scc0 L_pl2_3045
  s_lshl_b32 s6, s4, 16
  v_add_u32 v3, s6, v2
  buffer_load_dword v250, v3, s[8:11], 0 offen
  s_branch L_pl3_3046
L_pl2_3045:
  s_and_b32 s7, s6, 3
  s_mul_i32 s7, s7, 72
  s_lshr_b32 s6, s6, 2
  s_add_u32 s6, s6, s7
  s_lshl_b32 s6, s6, 16
  v_add_u32 v3, s6, v2
  buffer_load_dword v250, v3, s[56:59], 0 offen
L_pl3_3046:
  s_mov_b64 exec, -1
  s_add_u32 s4, s4, 24
  s_sub_u32 s5, s5, 1
  s_waitcnt vmcnt(0)
  s_cmp_lg_u32 s5, 0
  s_cbranch_scc1 L_pl_3043
L_ple_3044:
  s_cmp_ge_u32 s63, 27
  s_cbranch_scc1 L_l2j_3010
  s_mul_i32 s24, s62, 27
  s_add_u32 s24, s24, s63
  s_mul_i32 s25, s24, 43691
  s_lshr_b32 s25, s25, 18
  s_mul_i32 s36, s25, 6
  s_sub_u32 s26, s24, s36
  s_and_b32 s27, s3, 3
  s_bfe_u32 s28, s3, 0x10001
  s_and_b32 s29, s3, 1
  s_lshl_b32 s38, s25, 1
  v_bfe_u32 v2, v1, 2, 2
  v_mul_u32_u24 v2, 9216, v2
  v_lshrrev_b32 v3, 4, v1
  v_lshl_add_u32 v2, v3, 6, v2
  v_and_b32 v3, 3, v1
  v_xor_b32 v4, 2, v3
  s_mul_i32 s36, s27, 147456
  s_lshl_b32 s30, s38, 7
  s_add_u32 s36, s36, s30
  v_add_u32 v2, s36, v2
  v_lshl_add_u32 v8, v3, 4, v2
  v_lshl_add_u32 v9, v4, 4, v2
  v_add_u32 v10, 71680, v8
  v_add_u32 v9, 35840, v9
  v_add_u32 v11, 71680, v9
  s_mul_i32 s39, s26, 0
  s_lshr_b32 s39, s39, 12
  s_mul_i32 s30, s39, 589824
  s_lshl_b32 s35, s27, 12
  s_mov_b32 s33, 0
  s_mov_b32 s8, s72
  s_mov_b32 s9, s73
  s_mov_b32 s10, 18874368
  s_mov_b32 s11, 0x20000
L_pro_3049:
  s_add_u32 m0, s33, s35
  s_add_u32 s33, s33, 28672
  buffer_load_dwordx4 v8, s[8:11], s30 offen offset:0 lds
  buffer_load_dwordx4 v9, s[8:11], s30 offen offset:1024 lds
  buffer_load_dwordx4 v10, s[8:11], s30 offen offset:2048 lds
  buffer_load_dwordx4 v11, s[8:11], s30 offen offset:3072 lds
  s_add_u32 s30, s30, 589824
  s_cmp_lt_u32 s33, 143360
  s_cbranch_scc1 L_pro_3049
  s_mul_i32 s36, s29, 3
  s_mul_i32 s31, s26, 6
  s_add_u32 s36, s36, s31
  s_mul_i32 s31, s28, 43008
  v_and_b32 v3, 7, v1
  v_lshrrev_b32 v2, 3, v1
  v_lshl_add_u32 v3, v3, 4, s31
  s_lshl_b32 s31, s36, 3
  v_add_u32 v2, s31, v2
  v_add_u32 v12, 4, v2
  v_mul_u32_u24 v12, 9363, v12
  v_lshrrev_b32 v12, 16, v12
  v_add3_u32 v12, v12, v2, 0
  v_lshl_add_u32 v12, v12, 7, v3
  v_add_u32 v13, 12, v2
  v_mul_u32_u24 v13, 9363, v13
  v_lshrrev_b32 v13, 16, v13
  v_add3_u32 v13, v13, v2, 0
  v_lshl_add_u32 v13, v13, 7, v3
  v_add_u32 v14, 20, v2
  v_mul_u32_u24 v14, 9363, v14
  v_lshrrev_b32 v14, 16, v14
  v_add3_u32 v14, v14, v2, 0
  v_lshl_add_u32 v14, v14, 7, v3
  s_mul_i32 s31, s39, 86016
  s_mul_i32 s37, s27, 3072
  s_add_u32 s37, s37, 16384
  s_mov_b32 s33, 0
  s_add_u32 s12, s84, 33554432
  s_addc_u32 s13, s85, 0
  s_mov_b32 s14, 2752512
  s_mov_b32 s15, 0x20000
  s_lshl_b32 s44, s62, 2
  s_lshr_b32 s44, 0x34560012, s44
  s_and_b32 s44, s44, 15
  s_mul_i32 s44, s44, 3
  s_cmp_eq_u32 s62, 3
  s_cselect_b32 s45, 3, 6
  s_cmp_lt_u32 s63, s44
  s_cselect_b32 s45, 0, s45
  s_sub_u32 s45, s63, s45
  s_lshl2_add_u32 s46, s45, s27
  s_mul_i32 s46, s46, 9216
  s_lshr_b32 s47, s62, 2
  s_add_u32 s47, s47, s62
  s_lshl_b32 s47, s47, 10
  s_add_u32 s46, s46, s47
  s_add_u32 s46, s46, 2949376
  s_and_b32 s44, s25, 3
  s_cmp_eq_u32 s44, 1
  s_cselect_b32 s45, 99, s45
  s_cmp_lt_u32 s45, 16
  s_cselect_b32 s46, s46, 18874112
  s_add_u32 s47, s46, 1024
  s_or_b32 s44, s62, 1
  s_cmp_eq_u32 s44, 3
  s_cselect_b32 s47, s47, 18874112
  s_min_u32 s46, s46, 18874112
  s_min_u32 s47, s47, 18874112
  s_add_u32 s50, s46, 60
  s_buffer_load_dwordx2 s[44:45], s[8:11], s50
  s_add_u32 s50, s46, 188
  s_buffer_load_dwordx2 s[44:45], s[8:11], s50
  s_add_u32 s46, s46, 589824
  s_add_u32 s50, s47, 60
  s_buffer_load_dwordx2 s[44:45], s[8:11], s50
  s_add_u32 s50, s47, 188
  s_buffer_load_dwordx2 s[44:45], s[8:11], s50
  s_add_u32 s47, s47, 589824
L_lg3_3007:
  s_barrier
L_pro_3050:
  s_add_u32 m0, s33, s37
  s_add_u32 s33, s33, 28672
  buffer_load_dwordx4 v12, s[12:15], s31 offen offset:0 sc1 lds
  buffer_load_dwordx4 v13, s[12:15], s31 offen offset:1024 sc1 lds
  buffer_load_dwordx4 v14, s[12:15], s31 offen offset:2048 sc1 lds
  s_add_u32 s31, s31, 86016
  s_cmp_lt_u32 s33, 143360
  s_cbranch_scc1 L_pro_3050
  s_mov_b32 s33, 0
  s_mov_b32 s34, 0
  s_waitcnt vmcnt(12)
  s_barrier
  s_waitcnt vmcnt(9)
  s_barrier
  s_add_u32 m0, s33, s35
  s_add_u32 s36, s33, s37
  buffer_load_dwordx4 v8, s[8:11], s30 offen offset:0 lds
  buffer_load_dwordx4 v9, s[8:11], s30 offen offset:1024 lds
  buffer_load_dwordx4 v10, s[8:11], s30 offen offset:2048 lds
  buffer_load_dwordx4 v11, s[8:11], s30 offen offset:3072 lds
  s_mov_b32 m0, s36
  s_add_u32 s30, s30, 589824
  buffer_load_dwordx4 v12, s[12:15], s31 offen offset:0 sc1 lds
  buffer_load_dwordx4 v13, s[12:15], s31 offen offset:1024 sc1 lds
  buffer_load_dwordx4 v14, s[12:15], s31 offen offset:2048 sc1 lds
  s_min_u32 s46, s46, 18874112
  s_min_u32 s47, s47, 18874112
  s_add_u32 s50, s46, 60
  s_buffer_load_dwordx2 s[44:45], s[8:11], s50
  s_add_u32 s50, s46, 188
  s_buffer_load_dwordx2 s[44:45], s[8:11], s50
  s_add_u32 s46, s46, 589824
  s_add_u32 s50, s47, 60
  s_buffer_load_dwordx2 s[44:45], s[8:11], s50
  s_add_u32 s50, s47, 188
  s_buffer_load_dwordx2 s[44:45], s[8:11], s50
  s_add_u32 s47, s47, 589824
  s_add_u32 s31, s31, 86016
  s_add_u32 s33, s33, 28672
  s_waitcnt vmcnt(13)
  s_barrier
  s_add_u32 m0, s33, s35
  s_add_u32 s36, s33, s37
  buffer_load_dwordx4 v8, s[8:11], s30 offen offset:0 lds
  buffer_load_dwordx4 v9, s[8:11], s30 offen offset:1024 lds
  buffer_load_dwordx4 v10, s[8:11], s30 offen offset:2048 lds
  buffer_load_dwordx4 v11, s[8:11], s30 offen offset:3072 lds
  s_mov_b32 m0, s36
  s_add_u32 s30, s30, 589824
  buffer_load_dwordx4 v12, s[12:15], s31 offen offset:0 sc1 lds
  buffer_load_dwordx4 v13, s[12:15], s31 offen offset:1024 sc1 lds
  buffer_load_dwordx4 v14, s[12:15], s31 offen offset:2048 sc1 lds
  s_min_u32 s46, s46, 18874112
  s_min_u32 s47, s47, 18874112
  s_add_u32 s50, s46, 60
  s_buffer_load_dwordx2 s[44:45], s[8:11], s50
  s_add_u32 s50, s46, 188
  s_buffer_load_dwordx2 s[44:45], s[8:11], s50
  s_add_u32 s46, s46, 589824
  s_add_u32 s50, s47, 60
  s_buffer_load_dwordx2 s[44:45], s[8:11], s50
  s_add_u32 s50, s47, 188
  s_buffer_load_dwordx2 s[44:45], s[8:11], s50
  s_add_u32 s47, s47, 589824
  s_add_u32 s31, s31, 86016
  s_add_u32 s33, s33, 28672
  s_waitcnt vmcnt(17)
  s_barrier
  s_add_u32 m0, s33, s35
  s_add_u32 s36, s33, s37
  buffer_load_dwordx4 v8, s[8:11], s30 offen offset:0 lds
  buffer_load_dwordx4 v9, s[8:11], s30 offen offset:1024 lds
  buffer_load_dwordx4 v10, s[8:11], s30 offen offset:2048 lds
  buffer_load_dwordx4 v11, s[8:11], s30 offen offset:3072 lds
  s_mov_b32 m0, s36
  s_add_u32 s30, s30, 589824
  buffer_load_dwordx4 v12, s[12:15], s31 offen offset:0 sc1 lds
  buffer_load_dwordx4 v13, s[12:15], s31 offen offset:1024 sc1 lds
  buffer_load_dwordx4 v14, s[12:15], s31 offen offset:2048 sc1 lds
  s_min_u32 s46, s46, 18874112
  s_min_u32 s47, s47, 18874112
  s_add_u32 s50, s46, 60
  s_buffer_load_dwordx2 s[44:45], s[8:11], s50
  s_add_u32 s50, s46, 188
  s_buffer_load_dwordx2 s[44:45], s[8:11], s50
  s_add_u32 s46, s46, 589824
  s_add_u32 s50, s47, 60
  s_buffer_load_dwordx2 s[44:45], s[8:11], s50
  s_add_u32 s50, s47, 188
  s_buffer_load_dwordx2 s[44:45], s[8:11], s50
  s_add_u32 s47, s47, 589824
  s_add_u32 s31, s31, 86016
  s_add_u32 s33, s33, 28672
L_ld_3051:
  s_waitcnt vmcnt(21)
  s_barrier
  s_add_u32 m0, s33, s35
  s_add_u32 s36, s33, s37
  buffer_load_dwordx4 v8, s[8:11], s30 offen offset:0 lds
  buffer_load_dwordx4 v9, s[8:11], s30 offen offset:1024 lds
  buffer_load_dwordx4 v10, s[8:11], s30 offen offset:2048 lds
  buffer_load_dwordx4 v11, s[8:11], s30 offen offset:3072 lds
  s_mov_b32 m0, s36
  s_add_u32 s30, s30, 589824
  buffer_load_dwordx4 v12, s[12:15], s31 offen offset:0 sc1 lds
  buffer_load_dwordx4 v13, s[12:15], s31 offen offset:1024 sc1 lds
  buffer_load_dwordx4 v14, s[12:15], s31 offen offset:2048 sc1 lds
  s_min_u32 s46, s46, 18874112
  s_min_u32 s47, s47, 18874112
  s_add_u32 s50, s46, 60
  s_buffer_load_dwordx2 s[44:45], s[8:11], s50
  s_add_u32 s50, s46, 188
  s_buffer_load_dwordx2 s[44:45], s[8:11], s50
  s_add_u32 s46, s46, 589824
  s_add_u32 s50, s47, 60
  s_buffer_load_dwordx2 s[44:45], s[8:11], s50
  s_add_u32 s50, s47, 188
  s_buffer_load_dwordx2 s[44:45], s[8:11], s50
  s_add_u32 s47, s47, 589824
  s_add_u32 s31, s31, 86016
  s_add_u32 s33, s33, 28672
  s_cmp_eq_u32 s33, 143360
  s_cselect_b32 s33, 0, s33
  s_add_u32 s34, s34, 1
  s_cmp_lt_u32 s34, 24
  s_cbranch_scc1 L_ld_3051
  s_getpc_b64 s[52:53]
L_pc_3052:
  s_sub_u32 s52, s52, L_pc_3052-sequential_preLN__linear_attn_block__mixer_token_mlp__prompt_kernel
  s_subb_u32 s53, s53, 0
  s_mov_b32 s54, L_cend-sequential_preLN__linear_attn_block__mixer_token_mlp__prompt_kernel
  s_mov_b32 s55, 0x20000
  s_mov_b32 s56, L_p3t-sequential_preLN__linear_attn_block__mixer_token_mlp__prompt_kernel
  s_cmp_eq_u32 s3, 5
  s_cselect_b32 s56, L_p3e-sequential_preLN__linear_attn_block__mixer_token_mlp__prompt_kernel, s56
  s_cmp_eq_u32 s3, 6
  s_cselect_b32 s56, L_cend-sequential_preLN__linear_attn_block__mixer_token_mlp__prompt_kernel, s56
  s_cmp_eq_u32 s3, 7
  s_cselect_b32 s56, L_cend-sequential_preLN__linear_attn_block__mixer_token_mlp__prompt_kernel, s56
  v_lshl_add_u32 v249, v1, 7, s56
  buffer_load_dword v250, v249, s[52:55], 0 offen
L_p3t:
  s_waitcnt vmcnt(22)
  s_barrier
  s_waitcnt vmcnt(15)
  s_barrier
  s_waitcnt vmcnt(8)
  s_barrier
  s_waitcnt vmcnt(0)
  s_barrier
  s_waitcnt lgkmcnt(0)
  s_barrier
  s_mul_i32 s57, s38, 3641
  s_lshr_b32 s57, s57, 16
  s_mul_i32 s58, s57, 18
  s_sub_u32 s58, s38, s58
  s_cmp_lt_u32 s58, 4
  s_cselect_b32 s58, 0x100, 1
  s_mul_i32 s57, s57, 6
  s_add_u32 s57, s57, s26
  s_barrier
  s_cmp_lg_u32 s3, 4
  s_cbranch_scc1 L_nw4_3053
  s_add_u32 s52, s84, 20463616
  s_addc_u32 s53, s85, 0
  s_mov_b32 s54, 45056
  s_mov_b32 s55, 0x20000
  s_add_u32 s56, s57, 256
  s_lshl_b32 s56, s56, 7
  v_mul_u32_u24 v2, 3072, v1
  v_mov_b32 v3, s58
  v_add_u32 v2, s56, v2
  s_mov_b64 exec, 3
  buffer_atomic_add v3, v2, s[52:55], 0 offen
  s_mov_b64 exec, -1
L_nw4_3053:
  s_branch L_lg4_3009
L_l2j_3010:
  s_sub_u32 s4, s63, 27
  s_lshl_b32 s4, s4, 3
  s_add_u32 s4, s4, s62
  s_mul_i32 s4, s4, 196608
  s_add_u32 s5, s4, 196608
  v_lshlrev_b32 v2, 4, v0
  v_mov_b32 v4, -1
  v_mov_b32 v5, -1
  v_mov_b32 v6, -1
  v_mov_b32 v7, -1
  s_add_u32 s52, s84, 12599296
  s_addc_u32 s53, s85, 0
  s_mov_b32 s54, 7864320
  s_mov_b32 s55, 0x20000
L_ps_3054:
  buffer_store_dwordx4 v[4:7], v2, s[52:55], s4 offen sc1
  s_add_u32 s4, s4, 8192
  s_cmp_lt_u32 s4, s5
  s_cbranch_scc1 L_ps_3054
  v_lshlrev_b32 v2, 7, v0
  s_mov_b32 s8, s72
  s_mov_b32 s9, s73
  s_mov_b32 s10, 18874368
  s_mov_b32 s11, 0x20000
  s_mov_b32 s56, s76
  s_mov_b32 s57, s77
  s_mov_b32 s58, 18874368
  s_mov_b32 s59, 0x20000
  s_sub_u32 s4, 30, s63
  s_cselect_b32 s4, 4, s4
  s_lshl3_add_u32 s4, s4, s62
  s_add_u32 s4, s4, 262
  s_mov_b32 s5, 1
  s_cmp_eq_u32 s5, 0
  s_cbranch_scc1 L_ple_3056
L_pl_3055:
  s_sub_u32 s6, s4, 288
  s_cbranch_scc0 L_pl2_3057
  s_lshl_b32 s6, s4, 16
  v_add_u32 v3, s6, v2
  buffer_load_dword v250, v3, s[8:11], 0 offen
  s_branch L_pl3_3058
L_pl2_3057:
  s_and_b32 s7, s6, 3
  s_mul_i32 s7, s7, 72
  s_lshr_b32 s6, s6, 2
  s_add_u32 s6, s6, s7
  s_lshl_b32 s6, s6, 16
  v_add_u32 v3, s6, v2
  buffer_load_dword v250, v3, s[56:59], 0 offen
L_pl3_3058:
  s_mov_b64 exec, -1
  s_add_u32 s4, s4, 40
  s_sub_u32 s5, s5, 1
  s_waitcnt vmcnt(0)
  s_cmp_lg_u32 s5, 0
  s_cbranch_scc1 L_pl_3055
L_ple_3056:
  s_cmp_lg_u32 s3, 4
  s_cbranch_scc1 L_nw4_3061
  s_mov_b32 s52, s82
  s_mov_b32 s53, s83
  s_mov_b32 s54, 256
  s_mov_b32 s55, 0x20000
  v_lshlrev_b32 v2, 3, v1
  v_mov_b32 v3, 1
  s_mov_b32 exec_lo, 0xff
  s_mov_b32 exec_hi, 0
  s_mov_b32 s56, 0
L_poll_3062:
  buffer_load_dword v4, v2, s[52:55], 0 offen sc1
  s_add_u32 s56, s56, 1
  s_waitcnt vmcnt(0)
  v_cmp_ne_u32 vcc, v4, v3
  s_cmp_gt_u32 s56, 262144
  s_cbranch_scc1 L_got_3063
  s_cbranch_vccz L_got_3063
  s_sleep 1
  s_branch L_poll_3062
L_got_3063:
  s_mov_b64 exec, -1
L_nw4_3061:
  s_barrier
  s_cmp_lg_u32 s3, 4
  s_cbranch_scc1 L_nw4_3064
  s_add_u32 s52, s84, 20463616
  s_addc_u32 s53, s85, 0
  s_mov_b32 s54, 45056
  s_mov_b32 s55, 0x20000
  s_add_u32 s56, s62, 304
  s_lshl_b32 s56, s56, 7
  v_mul_u32_u24 v2, 0, v1
  v_mov_b32 v3, 1
  v_add_u32 v2, s56, v2
  s_mov_b64 exec, 1
  buffer_atomic_add v3, v2, s[52:55], 0 offen
  s_mov_b64 exec, -1
L_nw4_3064:
  v_lshlrev_b32 v2, 7, v0
  s_mov_b32 s8, s72
  s_mov_b32 s9, s73
  s_mov_b32 s10, 18874368
  s_mov_b32 s11, 0x20000
  s_mov_b32 s56, s76
  s_mov_b32 s57, s77
  s_mov_b32 s58, 18874368
  s_mov_b32 s59, 0x20000
  s_add_u32 s52, s84, 20463616
  s_addc_u32 s53, s85, 0
  s_mov_b32 s54, 45056
  s_mov_b32 s55, 0x20000
  s_add_u32 s4, s62, 312
  s_lshl_b32 s4, s4, 7
  v_mov_b32 v5, s4
  s_sub_u32 s4, 30, s63
  s_cselect_b32 s4, 4, s4
  s_lshl3_add_u32 s4, s4, s62
  s_add_u32 s4, s4, 302
  s_cmp_eq_u32 s63, 31
  s_cselect_b32 s5, 7, 7
  s_cmp_eq_u32 s5, 0
  s_cbranch_scc1 L_ple_3066
L_pl_3065:
  s_sub_u32 s6, s4, 288
  s_cbranch_scc0 L_pl2_3067
  s_lshl_b32 s6, s4, 16
  v_add_u32 v3, s6, v2
  buffer_load_dword v250, v3, s[8:11], 0 offen
  s_branch L_pl3_3068
L_pl2_3067:
  s_and_b32 s7, s6, 3
  s_mul_i32 s7, s7, 72
  s_lshr_b32 s6, s6, 2
  s_add_u32 s6, s6, s7
  s_lshl_b32 s6, s6, 16
  v_add_u32 v3, s6, v2
  buffer_load_dword v250, v3, s[56:59], 0 offen
L_pl3_3068:
  s_mov_b64 exec, -1
  buffer_load_dword v4, v5, s[52:55], 0 offen sc1
  s_add_u32 s4, s4, 40
  s_sub_u32 s5, s5, 1
  s_waitcnt vmcnt(0)
  v_readfirstlane_b32 s7, v4
  s_cmp_ge_u32 s4, 576
  s_cselect_b32 s5, 0, s5
  s_cmp_eq_u32 s7, 1
  s_cselect_b32 s5, 0, s5
  s_cmp_lg_u32 s5, 0
  s_cbranch_scc1 L_pl_3065
L_ple_3066:
  s_barrier
L_lg4_3009:
  s_bfe_u32 s24, s2, 0x20001
  s_and_b32 s25, s2, 1
  s_lshl_b32 s25, s25, 3
  s_lshr_b32 s35, s2, 5
  s_add_u32 s25, s25, s35
  s_bfe_u32 s26, s2, 0x20003
  s_and_b32 s27, s3, 3
  s_mov_b32 s32, 0
  s_mov_b32 s33, 0
  s_and_b32 s36, s27, 1
  s_cmp_lt_u32 s27, 2
  s_cbranch_scc1 L_a_3071
  v_bfe_u32 v2, v1, 2, 2
  v_lshlrev_b32 v2, 12, v2
  v_lshrrev_b32 v3, 4, v1
  v_lshl_add_u32 v2, v3, 6, v2
  v_and_b32 v3, 3, v1
  v_xor_b32 v4, 2, v3
  s_mul_i32 s35, s24, 4718592
  s_lshl_b32 s28, s36, 17
  s_add_u32 s35, s35, s28
  s_lshl_b32 s28, s25, 8
  s_add_u32 s35, s35, s28
  v_add_u32 v2, s35, v2
  v_lshl_add_u32 v8, v3, 4, v2
  v_lshl_add_u32 v9, v4, 4, v2
  v_add_u32 v10, 30720, v8
  v_add_u32 v9, 15360, v9
  v_add_u32 v11, 30720, v9
  s_lshl_b32 s34, s36, 13
  s_add_u32 s34, s34, 18432
  s_mul_i32 s28, s26, 0
  s_lshr_b32 s28, s28, 1
  s_lshl_b32 s28, s28, 18
  s_mov_b32 s8, s76
  s_mov_b32 s9, s77
  s_mov_b32 s10, 18874368
  s_mov_b32 s11, 0x20000
L_pro_3073:
  s_add_u32 m0, s32, s34
  s_add_u32 s29, s28, 65536
  buffer_load_dwordx4 v8, s[8:11], s28 offen offset:0 lds
  buffer_load_dwordx4 v9, s[8:11], s28 offen offset:1024 lds
  buffer_load_dwordx4 v10, s[8:11], s28 offen offset:2048 lds
  buffer_load_dwordx4 v11, s[8:11], s28 offen offset:3072 lds
  s_add_u32 m0, m0, 4096
  s_add_u32 s28, s28, 262144
  buffer_load_dwordx4 v8, s[8:11], s29 offen offset:0 lds
  buffer_load_dwordx4 v9, s[8:11], s29 offen offset:1024 lds
  buffer_load_dwordx4 v10, s[8:11], s29 offen offset:2048 lds
  buffer_load_dwordx4 v11, s[8:11], s29 offen offset:3072 lds
  s_add_u32 s32, s32, 34816
  s_cmp_lt_u32 s32, 139264
  s_cbranch_scc1 L_pro_3073
  s_mov_b32 s32, 0
  s_branch L_b_3072
L_a_3071:
  s_mul_i32 s35, s24, 36
  s_add_u32 s35, s35, s36
  s_mul_i32 s28, s26, 9
  s_mul_i32 s29, s35, 43008
  v_and_b32 v3, 7, v1
  v_lshrrev_b32 v2, 3, v1
  v_lshl_add_u32 v3, v3, 4, s29
  s_lshl_b32 s29, s28, 3
  v_add_u32 v2, s29, v2
  v_add_u32 v8, 4, v2
  v_mul_u32_u24 v8, 9363, v8
  v_lshrrev_b32 v8, 16, v8
  v_add3_u32 v8, v8, v2, 0
  v_lshl_add_u32 v8, v8, 7, v3
  v_add_u32 v9, 12, v2
  v_mul_u32_u24 v9, 9363, v9
  v_lshrrev_b32 v9, 16, v9
  v_add3_u32 v9, v9, v2, 0
  v_lshl_add_u32 v9, v9, 7, v3
  v_add_u32 v10, 20, v2
  v_mul_u32_u24 v10, 9363, v10
  v_lshrrev_b32 v10, 16, v10
  v_add3_u32 v10, v10, v2, 0
  v_lshl_add_u32 v10, v10, 7, v3
  v_add_u32 v11, 28, v2
  v_mul_u32_u24 v11, 9363, v11
  v_lshrrev_b32 v11, 16, v11
  v_add3_u32 v11, v11, v2, 0
  v_lshl_add_u32 v11, v11, 7, v3
  v_add_u32 v12, 36, v2
  v_mul_u32_u24 v12, 9363, v12
  v_lshrrev_b32 v12, 16, v12
  v_add3_u32 v12, v12, v2, 32
  v_lshl_add_u32 v12, v12, 7, v3
  v_add_u32 v13, 44, v2
  v_mul_u32_u24 v13, 9363, v13
  v_lshrrev_b32 v13, 16, v13
  v_add3_u32 v13, v13, v2, 32
  v_lshl_add_u32 v13, v13, 7, v3
  v_add_u32 v14, 52, v2
  v_mul_u32_u24 v14, 9363, v14
  v_lshrrev_b32 v14, 16, v14
  v_add3_u32 v14, v14, v2, 32
  v_lshl_add_u32 v14, v14, 7, v3
  v_add_u32 v15, 60, v2
  v_mul_u32_u24 v15, 9363, v15
  v_lshrrev_b32 v15, 16, v15
  v_add3_u32 v15, v15, v2, 32
  v_lshl_add_u32 v15, v15, 7, v3
  v_add_u32 v16, 68, v2
  v_mul_u32_u24 v16, 9363, v16
  v_lshrrev_b32 v16, 16, v16
  v_add3_u32 v16, v16, v2, 64
  v_lshl_add_u32 v16, v16, 7, v3
  s_mul_i32 s34, s36, 9216
  s_mul_i32 s28, s26, 0
  s_lshr_b32 s28, s28, 1
  s_mul_i32 s28, s28, 86016
  s_add_u32 s8, s84, 37748736
  s_addc_u32 s9, s85, 0
  s_mov_b32 s10, 6193152
  s_mov_b32 s11, 0x20000
L_b_3072:
  s_mov_b32 s40, s76
  s_mov_b32 s41, s77
  s_mov_b32 s42, 18874368
  s_mov_b32 s43, 0x20000
  s_lshl2_add_u32 s46, s63, s27
  s_lshr_b32 s47, s46, 6
  s_and_b32 s46, s46, 63
  s_mul_i32 s44, s24, 1152
  s_add_u32 s46, s46, s44
  s_add_u32 s46, s46, 256
  s_lshl_b32 s46, s46, 12
  s_and_b32 s44, s2, 1
  s_lshl1_add_u32 s47, s44, s47
  s_lshl_b32 s47, s47, 10
  s_add_u32 s46, s46, s47
  s_add_u32 s46, s46, 316
  s_add_u32 s48, s24, 1
  s_mul_i32 s48, s48, 4718592
  s_sub_u32 s48, s48, 196
  s_min_u32 s46, s46, s48
  s_add_u32 s47, s46, 128
  s_buffer_load_dwordx2 s[44:45], s[40:43], s46
  s_buffer_load_dwordx2 s[44:45], s[40:43], s47
  s_add_u32 s46, s46, 262144
  s_barrier
  s_cmp_ge_u32 s27, 2
  s_cbranch_scc1 L_b_3074
L_pro_3075:
  s_add_u32 m0, s32, s34
  s_nop 0
  buffer_load_dwordx4 v8, s[8:11], s28 offen offset:0 sc1 lds
  buffer_load_dwordx4 v9, s[8:11], s28 offen offset:1024 sc1 lds
  buffer_load_dwordx4 v10, s[8:11], s28 offen offset:2048 sc1 lds
  buffer_load_dwordx4 v11, s[8:11], s28 offen offset:3072 sc1 lds
  s_add_u32 m0, m0, 4096
  s_nop 0
  buffer_load_dwordx4 v12, s[8:11], s28 offen offset:0 sc1 lds
  buffer_load_dwordx4 v13, s[8:11], s28 offen offset:1024 sc1 lds
  buffer_load_dwordx4 v14, s[8:11], s28 offen offset:2048 sc1 lds
  buffer_load_dwordx4 v15, s[8:11], s28 offen offset:3072 sc1 lds
  s_add_u32 m0, m0, 4096
  s_nop 0
  buffer_load_dwordx4 v16, s[8:11], s28 offen offset:0 sc1 lds
  s_add_u32 s28, s28, 86016
  s_add_u32 s32, s32, 34816
  s_cmp_lt_u32 s32, 139264
  s_cbranch_scc1 L_pro_3075
  s_mov_b32 s32, 0
  s_waitcnt vmcnt(27)
  s_barrier
L_ld_3076:
  s_waitcnt vmcnt(18)
  s_barrier
  s_add_u32 m0, s32, s34
  s_nop 0
  buffer_load_dwordx4 v8, s[8:11], s28 offen offset:0 sc1 lds
  buffer_load_dwordx4 v9, s[8:11], s28 offen offset:1024 sc1 lds
  buffer_load_dwordx4 v10, s[8:11], s28 offen offset:2048 sc1 lds
  buffer_load_dwordx4 v11, s[8:11], s28 offen offset:3072 sc1 lds
  s_add_u32 m0, m0, 4096
  s_nop 0
  buffer_load_dwordx4 v12, s[8:11], s28 offen offset:0 sc1 lds
  buffer_load_dwordx4 v13, s[8:11], s28 offen offset:1024 sc1 lds
  buffer_load_dwordx4 v14, s[8:11], s28 offen offset:2048 sc1 lds
  buffer_load_dwordx4 v15, s[8:11], s28 offen offset:3072 sc1 lds
  s_add_u32 m0, m0, 4096
  s_nop 0
  buffer_load_dwordx4 v16, s[8:11], s28 offen offset:0 sc1 lds
  s_add_u32 s28, s28, 86016
  s_add_u32 s32, s32, 34816
  s_min_u32 s46, s46, s48
  s_add_u32 s47, s46, 128
  s_buffer_load_dwordx2 s[44:45], s[40:43], s46
  s_buffer_load_dwordx2 s[44:45], s[40:43], s47
  s_add_u32 s46, s46, 262144
  s_cmp_lg_u32 s33, 9
  s_cbranch_scc1 L_ncp_3077
  s_getpc_b64 s[52:53]
L_pc_3078:
  s_sub_u32 s52, s52, L_pc_3078-sequential_preLN__linear_attn_block__mixer_token_mlp__prompt_kernel
  s_subb_u32 s53, s53, 0
  s_mov_b32 s54, L_cend-sequential_preLN__linear_attn_block__mixer_token_mlp__prompt_kernel
  s_mov_b32 s55, 0x20000
  s_mov_b32 s56, L_p4e-sequential_preLN__linear_attn_block__mixer_token_mlp__prompt_kernel
  s_cmp_eq_u32 s24, 1
  s_cselect_b32 s56, L_x1-sequential_preLN__linear_attn_block__mixer_token_mlp__prompt_kernel, s56
  s_cmp_eq_u32 s24, 2
  s_cselect_b32 s56, L_x2-sequential_preLN__linear_attn_block__mixer_token_mlp__prompt_kernel, s56
  s_cmp_eq_u32 s24, 3
  s_cselect_b32 s56, L_x3-sequential_preLN__linear_attn_block__mixer_token_mlp__prompt_kernel, s56
  s_cmp_eq_u32 s3, 4
  s_cselect_b32 s56, s56, L_cend-sequential_preLN__linear_attn_block__mixer_token_mlp__prompt_kernel
  v_lshl_add_u32 v249, v1, 7, s56
  buffer_load_dword v250, v249, s[52:55], 0 offen
L_ncp_3077:
  s_cmp_eq_u32 s32, 139264
  s_cselect_b32 s32, 0, s32
  s_add_u32 s33, s33, 1
  s_cmp_lt_u32 s33, 14
  s_cbranch_scc1 L_ld_3076
  s_waitcnt vmcnt(18)
  s_barrier
  s_waitcnt vmcnt(9)
  s_barrier
  s_waitcnt vmcnt(0)
  s_barrier
  s_waitcnt lgkmcnt(0)
  s_endpgm
L_b_3074:
  s_waitcnt vmcnt(24)
  s_barrier
L_ld_3079:
  s_waitcnt vmcnt(16)
  s_barrier
  s_add_u32 m0, s32, s34
  s_add_u32 s29, s28, 65536
  buffer_load_dwordx4 v8, s[8:11], s28 offen offset:0 lds
  buffer_load_dwordx4 v9, s[8:11], s28 offen offset:1024 lds
  buffer_load_dwordx4 v10, s[8:11], s28 offen offset:2048 lds
  buffer_load_dwordx4 v11, s[8:11], s28 offen offset:3072 lds
  s_add_u32 m0, m0, 4096
  s_add_u32 s28, s28, 262144
  buffer_load_dwordx4 v8, s[8:11], s29 offen offset:0 lds
  buffer_load_dwordx4 v9, s[8:11], s29 offen offset:1024 lds
  buffer_load_dwordx4 v10, s[8:11], s29 offen offset:2048 lds
  buffer_load_dwordx4 v11, s[8:11], s29 offen offset:3072 lds
  s_add_u32 s32, s32, 34816
  s_min_u32 s46, s46, s48
  s_add_u32 s47, s46, 128
  s_buffer_load_dwordx2 s[44:45], s[40:43], s46
  s_buffer_load_dwordx2 s[44:45], s[40:43], s47
  s_add_u32 s46, s46, 262144
  s_cmp_eq_u32 s32, 139264
  s_cselect_b32 s32, 0, s32
  s_add_u32 s33, s33, 1
  s_cmp_lt_u32 s33, 14
  s_cbranch_scc1 L_ld_3079
  s_waitcnt vmcnt(16)
  s_barrier
  s_waitcnt vmcnt(8)
  s_barrier
  s_waitcnt vmcnt(0)
  s_barrier
  s_waitcnt lgkmcnt(0)
  s_endpgm
L_svc_3004:
  s_mul_i32 s4, s62, 6400
  v_lshl_add_u32 v2, v0, 4, s4
  v_mov_b32 v12, 0
  v_mov_b32 v13, 0
  v_mov_b32 v14, 0
  v_mov_b32 v15, 0
  v_mov_b32 v16, -1
  v_mov_b32 v17, -1
  v_mov_b32 v18, -1
  v_mov_b32 v19, -1
  s_mul_i32 s4, s62, 6144
  v_cmp_gt_u32 vcc, 400, v0
  v_lshl_add_u32 v3, v0, 4, s4
  s_mul_i32 s4, s62, 5632
  v_cndmask_b32 v2, -1, v2, vcc
  v_cmp_gt_u32 vcc, 384, v0
  v_lshl_add_u32 v4, v0, 7, s4
  s_getpc_b64 s[20:21]
L_pc:
  v_cndmask_b32 v3, -1, v3, vcc
  v_cmp_gt_u32 vcc, 44, v0
  s_sub_u32 s20, s20, L_pc-sequential_preLN__linear_attn_block__mixer_token_mlp__prompt_kernel
  s_subb_u32 s21, s21, 0
  v_cndmask_b32 v4, -1, v4, vcc
  s_mov_b32 s22, L_cend_3005-sequential_preLN__linear_attn_block__mixer_token_mlp__prompt_kernel
  s_mov_b32 s23, 0x20000
  v_lshlrev_b32 v6, 7, v0
  buffer_load_dword v250, v6, s[20:23], 0 offen
  s_waitcnt lgkmcnt(0)
  s_add_u32 s8, s84, 12386304
  s_addc_u32 s9, s85, 0
  s_mov_b32 s10, 51200
  s_mov_b32 s11, 0x20000
  s_add_u32 s12, s84, 12451840
  s_addc_u32 s13, s85, 0
  s_mov_b32 s14, 49152
  s_mov_b32 s15, 0x20000
  s_add_u32 s16, s84, 20463616
  s_addc_u32 s17, s85, 0
  s_mov_b32 s18, 45184
  s_mov_b32 s19, 0x20000
  v_mov_b32 v9, 45056
  buffer_store_dwordx4 v[12:15], v2, s[8:11], 0 offen sc1
  buffer_store_dword v12, v4, s[16:19], 0 offen sc1
  buffer_store_dwordx4 v[16:19], v3, s[12:15], 0 offen sc1
  s_lshl_b32 s4, s62, 3
  v_mov_b32 v2, s4
  v_cmp_eq_u32 vcc, 0, v0
  v_mov_b32 v8, 1
  s_mov_b32 s8, s82
  s_mov_b32 s9, s83
  s_mov_b32 s10, 256
  s_mov_b32 s11, 0x20000
  s_mov_b32 s12, s68
  s_mov_b32 s13, s69
  s_mov_b32 s14, 663552
  s_mov_b32 s15, 0x20000
  v_cndmask_b32 v2, -1, v2, vcc
  s_waitcnt vmcnt(0)
  v_add_u32 v9, 1, v9
  s_barrier
  buffer_store_dwordx2 v[8:9], v2, s[8:11], 0 offen sc1
  s_mul_i32 s4, s62, 82944
  v_cmp_gt_u32 vcc, 136, v0
  v_add_u32 v7, s4, v6
  v_add_u32 v6, 0x10000, v7
  v_cndmask_b32 v6, -1, v6, vcc
  buffer_load_dword v250, v7, s[12:15], 0 offen
  buffer_load_dword v250, v6, s[12:15], 0 offen
L_idle1_3003:
  s_waitcnt lgkmcnt(0)
  v_mov_b32 v8, 0
  v_mov_b32 v9, 0
  v_mov_b32 v10, 0
  v_mov_b32 v11, 0
  v_mov_b32 v12, 0
  v_mov_b32 v13, 0
  v_mov_b32 v14, 0
  v_mov_b32 v15, 0
  v_mov_b32 v16, 0
  v_lshlrev_b32 v2, 7, v0
  s_mov_b32 s8, s72
  s_mov_b32 s9, s73
  s_mov_b32 s10, 18874368
  s_mov_b32 s11, 0x20000
  s_mov_b32 s56, s76
  s_mov_b32 s57, s77
  s_mov_b32 s58, 18874368
  s_mov_b32 s59, 0x20000
  s_lshr_b32 s5, s62, 2
  s_sub_u32 s4, s62, s5
  s_cmp_eq_u32 s63, 30
  s_cselect_b32 s5, 4, 0
  s_cmp_eq_u32 s5, 0
  s_cbranch_scc1 L_ple_3084
L_pl_3083:
  s_sub_u32 s6, s4, 288
  s_cbranch_scc0 L_pl2_3085
  s_lshl_b32 s6, s4, 16
  v_add_u32 v3, s6, v2
  buffer_load_dword v250, v3, s[8:11], 0 offen
  s_branch L_pl3_3086
L_pl2_3085:
  s_and_b32 s7, s6, 3
  s_mul_i32 s7, s7, 72
  s_lshr_b32 s6, s6, 2
  s_add_u32 s6, s6, s7
  s_lshl_b32 s6, s6, 16
  v_add_u32 v3, s6, v2
  buffer_load_dword v250, v3, s[56:59], 0 offen
L_pl3_3086:
  s_mov_b64 exec, -1
  s_add_u32 s4, s4, 6
  s_sub_u32 s5, s5, 1
  s_waitcnt vmcnt(0)
  s_cmp_lg_u32 s5, 0
  s_cbranch_scc1 L_pl_3083
L_ple_3084:
  s_add_u32 s4, s62, 24
  s_cmp_eq_u32 s63, 31
  s_cselect_b32 s5, 3, 0
  s_cmp_eq_u32 s5, 0
  s_cbranch_scc1 L_ple_3090
L_pl_3089:
  s_sub_u32 s6, s4, 288
  s_cbranch_scc0 L_pl2_3091
  s_lshl_b32 s6, s4, 16
  v_add_u32 v3, s6, v2
  buffer_load_dword v250, v3, s[8:11], 0 offen
  s_branch L_pl3_3092
L_pl2_3091:
  s_and_b32 s7, s6, 3
  s_mul_i32 s7, s7, 72
  s_lshr_b32 s6, s6, 2
  s_add_u32 s6, s6, s7
  s_lshl_b32 s6, s6, 16
  v_add_u32 v3, s6, v2
  buffer_load_dword v250, v3, s[56:59], 0 offen
L_pl3_3092:
  s_mov_b64 exec, -1
  s_add_u32 s4, s4, 8
  s_sub_u32 s5, s5, 1
  s_waitcnt vmcnt(0)
  s_cmp_lg_u32 s5, 0
  s_cbranch_scc1 L_pl_3089
L_ple_3090:
  s_lshr_b32 s5, s62, 2
  s_sub_u32 s4, s62, s5
  s_add_u32 s5, s62, 6
  s_cmp_eq_u32 s63, 30
  s_cselect_b32 s4, s4, s5
  s_add_u32 s4, s4, 48
  s_mov_b32 s5, 1
  s_cmp_eq_u32 s5, 0
  s_cbranch_scc1 L_ple_3096
L_pl_3095:
  s_sub_u32 s6, s4, 288
  s_cbranch_scc0 L_pl2_3097
  s_lshl_b32 s6, s4, 16
  v_add_u32 v3, s6, v2
  buffer_load_dword v250, v3, s[8:11], 0 offen
  s_branch L_pl3_3098
L_pl2_3097:
  s_and_b32 s7, s6, 3
  s_mul_i32 s7, s7, 72
  s_lshr_b32 s6, s6, 2
  s_add_u32 s6, s6, s7
  s_lshl_b32 s6, s6, 16
  v_add_u32 v3, s6, v2
  buffer_load_dword v250, v3, s[56:59], 0 offen
L_pl3_3098:
  s_mov_b64 exec, -1
  s_add_u32 s4, s4, 14
  s_sub_u32 s5, s5, 1
  s_waitcnt vmcnt(0)
  s_cmp_lg_u32 s5, 0
  s_cbranch_scc1 L_pl_3095
L_ple_3096:
  s_cmp_ge_u32 s3, 4
  s_cbranch_scc1 L_l2i_3006
  s_setprio 1
  s_branch L_c2i_3082
L_comp_3002:
  s_setprio 1
  s_waitcnt lgkmcnt(0)
  s_cmp_gt_u32 s27, 1
  s_cbranch_scc1 L_pfy_3106
  s_cmp_eq_u32 s27, 1
  s_cbranch_scc1 L_pfx_3105
  s_mul_i32 s37, s2, 5504
  s_add_u32 s37, s37, 663552
  v_cmp_gt_u32 vcc, 43, v1
  v_lshl_add_u32 v2, v1, 7, s37
  s_nop 0
  v_cndmask_b32 v2, -1, v2, vcc
  s_mov_b32 s8, s66
  s_mov_b32 s9, s67
  s_mov_b32 s10, 1990656
  s_mov_b32 s11, 0x20000
  buffer_load_dword v250, v2, s[8:11], 0 offen
  s_branch L_pfy_3106
L_pfx_3105:
  v_mul_u32_u24 v2, 10923, v1
  s_mul_i32 s37, s2, 10368
  v_lshrrev_b32 v2, 16, v2
  s_add_u32 s37, s37, 384
  v_mul_u32_u24 v2, 384, v2
  v_cmp_gt_u32 vcc, 54, v1
  v_lshl_add_u32 v2, v1, 7, v2
  v_add_u32 v2, s37, v2
  v_cndmask_b32 v2, -1, v2, vcc
  s_mov_b32 s8, s64
  s_mov_b32 s9, s65
  s_mov_b32 s10, 2359296
  s_mov_b32 s11, 0x20000
  buffer_load_dword v250, v2, s[8:11], 0 offen
L_pfy_3106:
  s_lshr_b32 s50, s27, 1
  s_and_b32 s51, s27, 1
  v_lshrrev_b32 v6, 4, v1
  v_and_b32 v7, 15, v1
  s_mul_i32 s37, s27, 36864
  s_add_u32 s37, s37, 30592
  v_lshrrev_b32 v2, 5, v1
  v_mul_u32_u24 v2, 6144, v2
  v_and_b32 v3, 31, v1
  v_lshl_add_u32 v2, v3, 2, v2
  v_add_u32 v2, s37, v2
  v_mov_b32 v3, 0x3f803f80
  ds_write_b32 v2, v3
  v_mov_b32 v100, 0
  v_mov_b32 v101, 0
  v_mov_b32 v102, 0
  v_mov_b32 v103, 0
  v_mov_b32 v104, 0
  v_mov_b32 v105, 0
  v_mov_b32 v106, 0
  v_mov_b32 v107, 0
  v_mov_b32 v108, 0
  v_mov_b32 v109, 0
  v_mov_b32 v110, 0
  v_mov_b32 v111, 0
  v_mov_b32 v112, 0
  v_mov_b32 v113, 0
  v_mov_b32 v114, 0
  v_mov_b32 v115, 0
  v_mov_b32 v116, 0
  v_mov_b32 v117, 0
  v_mov_b32 v118, 0
  v_mov_b32 v119, 0
  v_mov_b32 v120, 0
  v_mov_b32 v121, 0
  v_mov_b32 v122, 0
  v_mov_b32 v123, 0
  v_mov_b32 v124, 0
  v_mov_b32 v125, 0
  v_mov_b32 v126, 0
  v_mov_b32 v127, 0
  v_mov_b32 v128, 0
  v_mov_b32 v129, 0
  v_mov_b32 v130, 0
  v_mov_b32 v131, 0
  v_mov_b32 v132, 0
  v_mov_b32 v133, 0
  v_mov_b32 v134, 0
  v_mov_b32 v135, 0
  v_mov_b32 v136, 0
  v_mov_b32 v137, 0
  v_mov_b32 v138, 0
  v_mov_b32 v139, 0
  v_mov_b32 v140, 0
  v_mov_b32 v141, 0
  v_mov_b32 v142, 0
  v_mov_b32 v143, 0
  v_mov_b32 v144, 0
  v_mov_b32 v145, 0
  v_mov_b32 v146, 0
  v_mov_b32 v147, 0
  v_mov_b32 v148, 0
  v_mov_b32 v149, 0
  v_mov_b32 v150, 0
  v_mov_b32 v151, 0
  v_mov_b32 v152, 0
  v_mov_b32 v153, 0
  v_mov_b32 v154, 0
  v_mov_b32 v155, 0
  v_mov_b32 v156, 0
  v_mov_b32 v157, 0
  v_mov_b32 v158, 0
  v_mov_b32 v159, 0
  v_mov_b32 v160, 0
  v_mov_b32 v161, 0
  v_mov_b32 v162, 0
  v_mov_b32 v163, 0
  v_mov_b32 v164, 0
  v_mov_b32 v165, 0
  v_mov_b32 v166, 0
  v_mov_b32 v167, 0
  v_mov_b32 v168, 0
  v_mov_b32 v169, 0
  v_mov_b32 v170, 0
  v_mov_b32 v171, 0
  v_lshlrev_b32 v2, 4, v0
  v_add_u32 v2, 149504, v2
  ds_write_b128 v2, v[100:103]
  ds_write_b128 v2, v[100:103] offset:4096
  ds_write_b128 v2, v[100:103] offset:8192
  ds_write_b128 v2, v[100:103] offset:8704
  v_mov_b32 v3, 162304
  ds_write_b64 v3, v[100:101]
  s_mul_i32 s37, s50, 6144
  s_add_u32 s37, s37, 24576
  v_lshrrev_b32 v2, 1, v7
  v_xor_b32 v2, v2, v6
  v_lshlrev_b32 v2, 4, v2
  v_lshl_add_u32 v2, v7, 7, v2
  v_add_u32 v8, s37, v2
  v_xor_b32 v9, 64, v8
  v_mul_u32_u24 v2, 3072, v6
  v_bfe_u32 v3, v1, 2, 2
  v_lshl_add_u32 v22, v3, 6, v2
  v_and_b32 v5, 1, v6
  v_lshlrev_b32 v5, 5, v5
  v_and_b32 v4, 3, v1
  v_mov_b32 v24, 0xb5c1a2a0
  v_mov_b32 v25, 0xb5c1a2a0
  s_mov_b32 s42, 0x3fb8aa3b
  s_mov_b32 s43, 0x3fb8aa3b
  s_mov_b32 s44, 0x358637bd
  s_mov_b32 s45, 0x358637bd
  v_mov_b32 v40, 0
  v_mov_b32 v41, 0
  v_mov_b32 v42, 0
  v_mov_b32 v43, 0
  v_mov_b32 v44, 0
  v_mov_b32 v45, 0
  v_mov_b32 v46, 0
  v_mov_b32 v47, 0
  v_mov_b32 v48, 0
  v_mov_b32 v49, 0
  v_mov_b32 v50, 0
  v_mov_b32 v51, 0
  v_mov_b32 v76, 0
  v_mov_b32 v77, 0
  v_mov_b32 v78, 0
  v_mov_b32 v79, 0
  v_mov_b32 v80, 0
  v_mov_b32 v81, 0
  v_mov_b32 v82, 0
  v_mov_b32 v83, 0
  v_mov_b32 v84, 0
  v_mov_b32 v85, 0
  v_mov_b32 v86, 0
  v_mov_b32 v87, 0
  v_mov_b32 v88, 0
  v_mov_b32 v89, 0
  v_mov_b32 v90, 0
  v_mov_b32 v91, 0
  v_mov_b32 v92, 0
  v_mov_b32 v93, 0
  v_mov_b32 v94, 0
  v_mov_b32 v95, 0
  v_mov_b32 v96, 0
  v_mov_b32 v97, 0
  v_mov_b32 v98, 0
  v_mov_b32 v99, 0
  v_mov_b32 v196, 0
  v_mov_b32 v197, 0
  v_mov_b32 v198, 0
  v_mov_b32 v199, 0
  v_mov_b32 v200, 0
  v_mov_b32 v201, 0
  v_mov_b32 v202, 0
  v_mov_b32 v203, 0
  v_mov_b32 v204, 0
  v_mov_b32 v205, 0
  v_mov_b32 v206, 0
  v_mov_b32 v207, 0
  v_mov_b32 v208, 0x3f803f80
  v_mov_b32 v209, 0x3f803f80
  v_mov_b32 v210, 0x3f803f80
  v_mov_b32 v211, 0x3f803f80
  s_cmp_ge_u32 s26, 8
  s_cbranch_scc1 L_q_3104
  s_and_b32 s37, s26, 3
  s_lshl_b32 s37, s37, 4
  s_mul_i32 s38, s51, 72
  s_add_u32 s37, s37, s38
  v_lshl_add_u32 v172, v4, 3, s37
  v_add_u32 v2, 0, v172
  v_lshrrev_b32 v3, 6, v2
  v_and_b32 v2, 63, v2
  v_xor_b32 v2, v2, v5
  v_lshl_add_u32 v2, v3, 8, v2
  v_add_u32 v12, v2, v22
  v_add_u32 v2, 32, v172
  v_lshrrev_b32 v3, 6, v2
  v_and_b32 v2, 63, v2
  v_xor_b32 v2, v2, v5
  v_lshl_add_u32 v2, v3, 8, v2
  v_add_u32 v13, v2, v22
  v_min_u32 v2, 1, v4
  v_mul_u32_u24 v2, 120, v2
  v_add3_u32 v2, v2, v172, 64
  v_lshrrev_b32 v3, 6, v2
  v_and_b32 v2, 63, v2
  v_xor_b32 v2, v2, v5
  v_lshl_add_u32 v2, v3, 8, v2
  v_add_u32 v14, v2, v22
  v_add_u32 v2, 216, v172
  v_lshrrev_b32 v3, 6, v2
  v_and_b32 v2, 63, v2
  v_xor_b32 v2, v2, v5
  v_lshl_add_u32 v2, v3, 8, v2
  v_add_u32 v15, v2, v22
  v_add_u32 v2, 248, v172
  v_lshrrev_b32 v3, 6, v2
  v_and_b32 v2, 63, v2
  v_xor_b32 v2, v2, v5
  v_lshl_add_u32 v2, v3, 8, v2
  v_add_u32 v16, v2, v22
  s_mov_b32 s56, 0xf000f
  s_mov_b32 s57, 0xf000f
  s_mov_b32 s58, 0x1000100
  s_mov_b32 s59, 0x1000100
  v_mov_b32 v2, s44
  v_cndmask_b32 v26, 0, v2, s[56:57]
  v_cndmask_b32 v27, 0, v2, s[56:57]
  v_add_u32 v10, s32, v8
  v_add_u32 v11, s32, v9
  v_add_u32 v17, s32, v12
  v_add_u32 v18, s32, v13
  v_add_u32 v19, s32, v14
  v_add_u32 v20, s32, v15
  v_add_u32 v21, s32, v16
  s_cmp_lg_u32 s51, 0
  s_cbranch_scc1 L_h1_3107
  .p2align 6
L_k_3109:
  s_waitcnt lgkmcnt(0)
  s_barrier
  v_mfma_f32_16x16x32_bf16 v[100:103], v[40:43], v[76:79], v[100:103]
  ds_read_b64_tr_b16 v[52:53], v17 offset:0
  v_mfma_f32_16x16x32_bf16 v[104:107], v[44:47], v[76:79], v[104:107]
  ds_read_b64_tr_b16 v[54:55], v17 offset:1536
  v_mfma_f32_16x16x32_bf16 v[108:111], v[48:51], v[76:79], v[108:111]
  ds_read_b128 v[28:31], v10 offset:0
  v_mfma_f32_16x16x32_bf16 v[112:115], v[40:43], v[80:83], v[112:115]
  ds_read_b128 v[32:35], v10 offset:2048
  v_mfma_f32_16x16x32_bf16 v[116:119], v[44:47], v[80:83], v[116:119]
  ds_read_b128 v[36:39], v10 offset:4096
  v_mfma_f32_16x16x32_bf16 v[120:123], v[48:51], v[80:83], v[120:123]
  ds_read_b64_tr_b16 v[56:57], v18 offset:0
  v_mfma_f32_16x16x32_bf16 v[124:127], v[40:43], v[84:87], v[124:127]
  ds_read_b64_tr_b16 v[58:59], v18 offset:1536
  v_mfma_f32_16x16x32_bf16 v[128:131], v[44:47], v[84:87], v[128:131]
  ds_read_b64_tr_b16 v[60:61], v19 offset:0
  v_mfma_f32_16x16x32_bf16 v[132:135], v[48:51], v[84:87], v[132:135]
  ds_read_b64_tr_b16 v[62:63], v19 offset:1536
  v_mfma_f32_16x16x32_bf16 v[136:139], v[40:43], v[88:91], v[136:139]
  ds_read_b64_tr_b16 v[64:65], v20 offset:0
  v_mfma_f32_16x16x32_bf16 v[140:143], v[44:47], v[88:91], v[140:143]
  ds_read_b64_tr_b16 v[66:67], v20 offset:1536
  v_mfma_f32_16x16x32_bf16 v[144:147], v[48:51], v[88:91], v[144:147]
  ds_read_b64_tr_b16 v[68:69], v21 offset:0
  v_mfma_f32_16x16x32_bf16 v[148:151], v[40:43], v[92:95], v[148:151]
  ds_read_b64_tr_b16 v[70:71], v21 offset:1536
  v_mfma_f32_16x16x32_bf16 v[152:155], v[44:47], v[92:95], v[152:155]
  s_add_u32 s32, s32, 36864
  s_cmp_eq_u32 s32, 147456
  v_mfma_f32_16x16x32_bf16 v[156:159], v[48:51], v[92:95], v[156:159]
  s_cselect_b32 s32, 0, s32
  s_add_u32 s34, s34, 1
  v_mfma_f32_16x16x32_bf16 v[196:199], v[40:43], v[40:43], v[196:199]
  v_mfma_f32_16x16x32_bf16 v[200:203], v[44:47], v[44:47], v[200:203]
  v_mfma_f32_16x16x32_bf16 v[204:207], v[48:51], v[48:51], v[204:207]
  s_waitcnt lgkmcnt(0)
  v_mfma_f32_16x16x32_bf16 v[100:103], v[28:31], v[52:55], v[100:103]
  ds_read_b64_tr_b16 v[76:77], v17 offset:12288
  v_mfma_f32_16x16x32_bf16 v[104:107], v[32:35], v[52:55], v[104:107]
  ds_read_b64_tr_b16 v[78:79], v17 offset:13824
  v_mfma_f32_16x16x32_bf16 v[108:111], v[36:39], v[52:55], v[108:111]
  ds_read_b128 v[40:43], v11 offset:0
  v_mfma_f32_16x16x32_bf16 v[112:115], v[28:31], v[56:59], v[112:115]
  ds_read_b128 v[44:47], v11 offset:2048
  v_mfma_f32_16x16x32_bf16 v[116:119], v[32:35], v[56:59], v[116:119]
  ds_read_b128 v[48:51], v11 offset:4096
  v_mfma_f32_16x16x32_bf16 v[120:123], v[36:39], v[56:59], v[120:123]
  ds_read_b64_tr_b16 v[80:81], v18 offset:12288
  v_mfma_f32_16x16x32_bf16 v[124:127], v[28:31], v[60:63], v[124:127]
  ds_read_b64_tr_b16 v[82:83], v18 offset:13824
  v_mfma_f32_16x16x32_bf16 v[128:131], v[32:35], v[60:63], v[128:131]
  ds_read_b64_tr_b16 v[84:85], v19 offset:12288
  v_mfma_f32_16x16x32_bf16 v[132:135], v[36:39], v[60:63], v[132:135]
  ds_read_b64_tr_b16 v[86:87], v19 offset:13824
  v_mfma_f32_16x16x32_bf16 v[136:139], v[28:31], v[64:67], v[136:139]
  ds_read_b64_tr_b16 v[88:89], v20 offset:12288
  v_mfma_f32_16x16x32_bf16 v[140:143], v[32:35], v[64:67], v[140:143]
  ds_read_b64_tr_b16 v[90:91], v20 offset:13824
  v_mfma_f32_16x16x32_bf16 v[144:147], v[36:39], v[64:67], v[144:147]
  ds_read_b64_tr_b16 v[92:93], v21 offset:12288
  v_mfma_f32_16x16x32_bf16 v[148:151], v[28:31], v[68:71], v[148:151]
  ds_read_b64_tr_b16 v[94:95], v21 offset:13824
  v_mfma_f32_16x16x32_bf16 v[152:155], v[32:35], v[68:71], v[152:155]
  v_add_u32 v10, s32, v8
  v_add_u32 v11, s32, v9
  v_add_u32 v17, s32, v12
  v_add_u32 v18, s32, v13
  v_mfma_f32_16x16x32_bf16 v[156:159], v[36:39], v[68:71], v[156:159]
  v_add_u32 v19, s32, v14
  v_add_u32 v20, s32, v15
  v_add_u32 v21, s32, v16
  s_cmp_lt_u32 s34, 9
  v_mfma_f32_16x16x32_bf16 v[196:199], v[28:31], v[28:31], v[196:199]
  v_mfma_f32_16x16x32_bf16 v[200:203], v[32:35], v[32:35], v[200:203]
  v_mfma_f32_16x16x32_bf16 v[204:207], v[36:39], v[36:39], v[204:207]
  s_cbranch_scc1 L_k_3109
  s_waitcnt lgkmcnt(0)
  v_mfma_f32_16x16x32_bf16 v[196:199], v[40:43], v[40:43], v[196:199]
  v_mfma_f32_16x16x32_bf16 v[200:203], v[44:47], v[44:47], v[200:203]
  v_mfma_f32_16x16x32_bf16 v[204:207], v[48:51], v[48:51], v[204:207]
  s_branch L_hj_3108
L_h1_3107:
  .p2align 6
L_k_3110:
  s_waitcnt lgkmcnt(0)
  s_barrier
  v_mfma_f32_16x16x32_bf16 v[100:103], v[40:43], v[76:79], v[100:103]
  ds_read_b64_tr_b16 v[52:53], v17 offset:0
  v_mfma_f32_16x16x32_bf16 v[104:107], v[44:47], v[76:79], v[104:107]
  ds_read_b64_tr_b16 v[54:55], v17 offset:1536
  v_mfma_f32_16x16x32_bf16 v[108:111], v[48:51], v[76:79], v[108:111]
  ds_read_b128 v[28:31], v10 offset:0
  v_mfma_f32_16x16x32_bf16 v[112:115], v[40:43], v[80:83], v[112:115]
  ds_read_b128 v[32:35], v10 offset:2048
  v_mfma_f32_16x16x32_bf16 v[116:119], v[44:47], v[80:83], v[116:119]
  ds_read_b128 v[36:39], v10 offset:4096
  v_mfma_f32_16x16x32_bf16 v[120:123], v[48:51], v[80:83], v[120:123]
  ds_read_b64_tr_b16 v[56:57], v18 offset:0
  v_mfma_f32_16x16x32_bf16 v[124:127], v[40:43], v[84:87], v[124:127]
  ds_read_b64_tr_b16 v[58:59], v18 offset:1536
  v_mfma_f32_16x16x32_bf16 v[128:131], v[44:47], v[84:87], v[128:131]
  ds_read_b64_tr_b16 v[60:61], v19 offset:0
  v_mfma_f32_16x16x32_bf16 v[132:135], v[48:51], v[84:87], v[132:135]
  ds_read_b64_tr_b16 v[62:63], v19 offset:1536
  v_mfma_f32_16x16x32_bf16 v[136:139], v[40:43], v[88:91], v[136:139]
  ds_read_b64_tr_b16 v[64:65], v20 offset:0
  v_mfma_f32_16x16x32_bf16 v[140:143], v[44:47], v[88:91], v[140:143]
  ds_read_b64_tr_b16 v[66:67], v20 offset:1536
  v_mfma_f32_16x16x32_bf16 v[144:147], v[48:51], v[88:91], v[144:147]
  ds_read_b64_tr_b16 v[68:69], v21 offset:0
  v_mfma_f32_16x16x32_bf16 v[148:151], v[40:43], v[92:95], v[148:151]
  ds_read_b64_tr_b16 v[70:71], v21 offset:1536
  v_mfma_f32_16x16x32_bf16 v[152:155], v[44:47], v[92:95], v[152:155]
  s_add_u32 s32, s32, 36864
  s_cmp_eq_u32 s32, 147456
  v_mfma_f32_16x16x32_bf16 v[156:159], v[48:51], v[92:95], v[156:159]
  s_cselect_b32 s32, 0, s32
  s_add_u32 s34, s34, 1
  v_mfma_f32_16x16x32_bf16 v[196:199], v[40:43], v[208:211], v[196:199]
  v_mfma_f32_16x16x32_bf16 v[200:203], v[44:47], v[208:211], v[200:203]
  v_mfma_f32_16x16x32_bf16 v[204:207], v[48:51], v[208:211], v[204:207]
  s_waitcnt lgkmcnt(0)
  v_mfma_f32_16x16x32_bf16 v[100:103], v[28:31], v[52:55], v[100:103]
  ds_read_b64_tr_b16 v[76:77], v17 offset:12288
  v_mfma_f32_16x16x32_bf16 v[104:107], v[32:35], v[52:55], v[104:107]
  ds_read_b64_tr_b16 v[78:79], v17 offset:13824
  v_mfma_f32_16x16x32_bf16 v[108:111], v[36:39], v[52:55], v[108:111]
  ds_read_b128 v[40:43], v11 offset:0
  v_mfma_f32_16x16x32_bf16 v[112:115], v[28:31], v[56:59], v[112:115]
  ds_read_b128 v[44:47], v11 offset:2048
  v_mfma_f32_16x16x32_bf16 v[116:119], v[32:35], v[56:59], v[116:119]
  ds_read_b128 v[48:51], v11 offset:4096
  v_mfma_f32_16x16x32_bf16 v[120:123], v[36:39], v[56:59], v[120:123]
  ds_read_b64_tr_b16 v[80:81], v18 offset:12288
  v_mfma_f32_16x16x32_bf16 v[124:127], v[28:31], v[60:63], v[124:127]
  ds_read_b64_tr_b16 v[82:83], v18 offset:13824
  v_mfma_f32_16x16x32_bf16 v[128:131], v[32:35], v[60:63], v[128:131]
  ds_read_b64_tr_b16 v[84:85], v19 offset:12288
  v_mfma_f32_16x16x32_bf16 v[132:135], v[36:39], v[60:63], v[132:135]
  ds_read_b64_tr_b16 v[86:87], v19 offset:13824
  v_mfma_f32_16x16x32_bf16 v[136:139], v[28:31], v[64:67], v[136:139]
  ds_read_b64_tr_b16 v[88:89], v20 offset:12288
  v_mfma_f32_16x16x32_bf16 v[140:143], v[32:35], v[64:67], v[140:143]
  ds_read_b64_tr_b16 v[90:91], v20 offset:13824
  v_mfma_f32_16x16x32_bf16 v[144:147], v[36:39], v[64:67], v[144:147]
  ds_read_b64_tr_b16 v[92:93], v21 offset:12288
  v_mfma_f32_16x16x32_bf16 v[148:151], v[28:31], v[68:71], v[148:151]
  ds_read_b64_tr_b16 v[94:95], v21 offset:13824
  v_mfma_f32_16x16x32_bf16 v[152:155], v[32:35], v[68:71], v[152:155]
  v_add_u32 v10, s32, v8
  v_add_u32 v11, s32, v9
  v_add_u32 v17, s32, v12
  v_add_u32 v18, s32, v13
  v_mfma_f32_16x16x32_bf16 v[156:159], v[36:39], v[68:71], v[156:159]
  v_add_u32 v19, s32, v14
  v_add_u32 v20, s32, v15
  v_add_u32 v21, s32, v16
  s_cmp_lt_u32 s34, 9
  v_mfma_f32_16x16x32_bf16 v[196:199], v[28:31], v[208:211], v[196:199]
  v_mfma_f32_16x16x32_bf16 v[200:203], v[32:35], v[208:211], v[200:203]
  v_mfma_f32_16x16x32_bf16 v[204:207], v[36:39], v[208:211], v[204:207]
  s_cbranch_scc1 L_k_3110
  s_waitcnt lgkmcnt(0)
  v_mfma_f32_16x16x32_bf16 v[196:199], v[40:43], v[208:211], v[196:199]
  v_mfma_f32_16x16x32_bf16 v[200:203], v[44:47], v[208:211], v[200:203]
  v_mfma_f32_16x16x32_bf16 v[204:207], v[48:51], v[208:211], v[204:207]
L_hj_3108:
  v_mfma_f32_16x16x32_bf16 v[100:103], v[40:43], v[76:79], v[100:103]
  s_mul_i32 s37, s51, 384
  s_mul_i32 s38, s50, 192
  v_mfma_f32_16x16x32_bf16 v[104:107], v[44:47], v[76:79], v[104:107]
  s_add_u32 s38, s38, 147456
  s_add_u32 s37, s37, s38
  v_mfma_f32_16x16x32_bf16 v[108:111], v[48:51], v[76:79], v[108:111]
  v_lshl_add_u32 v2, v7, 2, s37
  v_lshl_add_u32 v3, v1, 2, s38
  v_mfma_f32_16x16x32_bf16 v[112:115], v[40:43], v[80:83], v[112:115]
  s_mov_b32 vcc_lo, 0x22222222
  s_mov_b32 vcc_hi, 0x22222222
  v_mfma_f32_16x16x32_bf16 v[116:119], v[44:47], v[80:83], v[116:119]
  v_cndmask_b32 v196, v196, v197, vcc
  v_mfma_f32_16x16x32_bf16 v[120:123], v[48:51], v[80:83], v[120:123]
  v_cndmask_b32 v200, v200, v201, vcc
  v_mfma_f32_16x16x32_bf16 v[124:127], v[40:43], v[84:87], v[124:127]
  v_cndmask_b32 v204, v204, v205, vcc
  v_mfma_f32_16x16x32_bf16 v[128:131], v[44:47], v[84:87], v[128:131]
  s_mov_b32 vcc_lo, 0x44444444
  s_mov_b32 vcc_hi, 0x44444444
  v_mfma_f32_16x16x32_bf16 v[132:135], v[48:51], v[84:87], v[132:135]
  v_cndmask_b32 v196, v196, v198, vcc
  v_mfma_f32_16x16x32_bf16 v[136:139], v[40:43], v[88:91], v[136:139]
  v_cndmask_b32 v200, v200, v202, vcc
  v_mfma_f32_16x16x32_bf16 v[140:143], v[44:47], v[88:91], v[140:143]
  v_cndmask_b32 v204, v204, v206, vcc
  v_mfma_f32_16x16x32_bf16 v[144:147], v[48:51], v[88:91], v[144:147]
  s_mov_b32 vcc_lo, 0x88888888
  s_mov_b32 vcc_hi, 0x88888888
  v_mfma_f32_16x16x32_bf16 v[148:151], v[40:43], v[92:95], v[148:151]
  v_cndmask_b32 v196, v196, v199, vcc
  v_mfma_f32_16x16x32_bf16 v[152:155], v[44:47], v[92:95], v[152:155]
  v_cndmask_b32 v200, v200, v203, vcc
  v_mfma_f32_16x16x32_bf16 v[156:159], v[48:51], v[92:95], v[156:159]
  v_cndmask_b32 v204, v204, v207, vcc
  s_mov_b32 exec_lo, 0xf0000f
  s_mov_b32 exec_hi, 0xf0000f00
  ds_write_b32 v2, v196 offset:0
  ds_write_b32 v2, v200 offset:64
  ds_write_b32 v2, v204 offset:128
  s_mov_b64 exec, -1
  s_mul_i32 s37, s50, 47
  s_add_u32 s37, s37, s28
  s_sub_u32 s37, 2048, s37
  s_max_i32 s37, s37, 0
  s_min_u32 s37, s37, 47
  s_mul_i32 s38, s27, 512
  s_add_u32 s38, s38, 124928
  v_cmp_gt_u32 vcc, s37, v1
  v_lshl_add_u32 v212, v1, 2, s38
  s_waitcnt lgkmcnt(0)
  s_barrier
  ds_read_b32 v196, v3
  ds_read_b32 v197, v3 offset:384
  s_mov_b32 s37, 0x3ae38e39
  s_waitcnt lgkmcnt(0)
  v_mul_f32 v197, s37, v197
  v_mul_f32 v196, s37, v196
  v_fma_f32 v196, -v197, v197, v196
  v_max_f32 v196, 0, v196
  v_add_f32 v196, 0x3727c5ac, v196
  v_rsq_f32 v196, v196
  v_cndmask_b32 v197, 0, v197, vcc
  v_cndmask_b32 v196, 0, v196, vcc
  v_mul_f32 v197, -v197, v196
  ds_write_b32 v212, v196
  ds_write_b32 v212, v197 offset:256
L_p1e:
  v_lshl_add_u32 v2, v6, 4, s38
  v_lshlrev_b32 v3, 2, v7
  v_add_u32 v3, 192, v3
  ds_read_b128 v[28:31], v2 offset:0
  ds_read_b128 v[40:43], v2 offset:256
  ds_read_b128 v[32:35], v2 offset:64
  ds_read_b128 v[44:47], v2 offset:320
  ds_read_b128 v[36:39], v2 offset:128
  ds_read_b128 v[48:51], v2 offset:384
  ds_bpermute_b32 v52, v3, v111
  ds_bpermute_b32 v54, v3, v123
  ds_bpermute_b32 v56, v3, v135
  ds_bpermute_b32 v58, v3, v147
  ds_bpermute_b32 v60, v3, v159
  s_mul_i32 s37, s51, 3200
  s_mul_i32 s38, s50, 6400
  s_add_u32 s37, s37, s38
  s_add_u32 s37, s37, 148992
  v_mul_u32_u24 v5, 320, v6
  v_cmp_eq_u32 vcc, 0, v6
  v_add_u32 v5, s37, v5
  v_lshl_add_u32 v12, v7, 4, v5
  v_cndmask_b32 v2, 0, 1, vcc
  v_cmp_gt_u32 vcc, 8, v7
  v_mul_u32_u24 v2, 1608, v2
  v_add_u32 v5, 1280, v12
  v_add_u32 v5, v2, v5
  v_cndmask_b32 v2, -8, 10, vcc
  v_cndmask_b32 v4, 10, 8, vcc
  v_lshl_add_u32 v13, v2, 4, v5
  v_lshl_add_u32 v14, v4, 4, v5
  s_waitcnt lgkmcnt(0)
  s_barrier
  v_pk_fma_f32 v[172:173], v[40:41], v[52:53], s[44:45] op_sel_hi:[1,0,1]
  v_pk_fma_f32 v[176:177], v[42:43], v[52:53], s[44:45] op_sel_hi:[1,0,1]
  v_pk_fma_f32 v[100:101], v[100:101], v[28:29], v[172:173]
  v_pk_fma_f32 v[102:103], v[102:103], v[30:31], v[176:177]
  v_pk_fma_f32 v[172:173], v[100:101], s[42:43], v[24:25]
  v_pk_fma_f32 v[176:177], v[102:103], s[42:43], v[24:25]
  v_exp_f32 v172, v172 clamp
  v_exp_f32 v173, v173 clamp
  v_exp_f32 v176, v176 clamp
  v_exp_f32 v177, v177 clamp
  v_max_f32 v100, s44, v100
  v_max_f32 v101, s44, v101
  v_max_f32 v102, s44, v102
  v_max_f32 v103, s44, v103
  v_pk_add_f32 v[100:101], v[100:101], v[172:173]
  v_pk_add_f32 v[102:103], v[102:103], v[176:177]
  v_cvt_pk_bf16_f32 v76, v100, v101
  v_cvt_pk_bf16_f32 v77, v102, v103
  v_pk_fma_f32 v[172:173], v[44:45], v[52:53], s[44:45] op_sel_hi:[1,0,1]
  v_pk_fma_f32 v[176:177], v[46:47], v[52:53], s[44:45] op_sel_hi:[1,0,1]
  v_pk_fma_f32 v[104:105], v[104:105], v[32:33], v[172:173]
  v_pk_fma_f32 v[106:107], v[106:107], v[34:35], v[176:177]
  v_pk_fma_f32 v[172:173], v[104:105], s[42:43], v[24:25]
  v_pk_fma_f32 v[176:177], v[106:107], s[42:43], v[24:25]
  v_exp_f32 v172, v172 clamp
  v_exp_f32 v173, v173 clamp
  v_exp_f32 v176, v176 clamp
  v_exp_f32 v177, v177 clamp
  v_max_f32 v104, s44, v104
  v_max_f32 v105, s44, v105
  v_max_f32 v106, s44, v106
  v_max_f32 v107, s44, v107
  v_pk_add_f32 v[104:105], v[104:105], v[172:173]
  v_pk_add_f32 v[106:107], v[106:107], v[176:177]
  v_cvt_pk_bf16_f32 v78, v104, v105
  v_cvt_pk_bf16_f32 v79, v106, v107
  v_pk_fma_f32 v[172:173], v[48:49], v[52:53], s[44:45] op_sel_hi:[1,0,1]
  v_pk_fma_f32 v[176:177], v[50:51], v[52:53], s[44:45] op_sel_hi:[1,0,1]
  v_pk_fma_f32 v[108:109], v[108:109], v[36:37], v[172:173]
  v_pk_fma_f32 v[110:111], v[110:111], v[38:39], v[176:177]
  v_pk_fma_f32 v[172:173], v[108:109], s[42:43], v[24:25]
  v_pk_fma_f32 v[176:177], v[110:111], s[42:43], v[24:25]
  v_exp_f32 v172, v172 clamp
  v_exp_f32 v173, v173 clamp
  v_exp_f32 v176, v176 clamp
  v_exp_f32 v177, v177 clamp
  v_max_f32 v108, s44, v108
  v_max_f32 v109, s44, v109
  v_max_f32 v110, s44, v110
  v_max_f32 v111, s44, v111
  v_pk_add_f32 v[108:109], v[108:109], v[172:173]
  v_pk_add_f32 v[110:111], v[110:111], v[176:177]
  v_cvt_pk_bf16_f32 v80, v108, v109
  v_cvt_pk_bf16_f32 v81, v110, v111
  v_pk_fma_f32 v[172:173], v[40:41], v[54:55], s[44:45] op_sel_hi:[1,0,1]
  v_pk_fma_f32 v[176:177], v[42:43], v[54:55], s[44:45] op_sel_hi:[1,0,1]
  v_pk_fma_f32 v[112:113], v[112:113], v[28:29], v[172:173]
  v_pk_fma_f32 v[114:115], v[114:115], v[30:31], v[176:177]
  v_pk_fma_f32 v[172:173], v[112:113], s[42:43], v[24:25]
  v_pk_fma_f32 v[176:177], v[114:115], s[42:43], v[24:25]
  v_exp_f32 v172, v172 clamp
  v_exp_f32 v173, v173 clamp
  v_exp_f32 v176, v176 clamp
  v_exp_f32 v177, v177 clamp
  v_max_f32 v112, s44, v112
  v_max_f32 v113, s44, v113
  v_max_f32 v114, s44, v114
  v_max_f32 v115, s44, v115
  v_pk_add_f32 v[112:113], v[112:113], v[172:173]
  v_pk_add_f32 v[114:115], v[114:115], v[176:177]
  v_cvt_pk_bf16_f32 v82, v112, v113
  v_cvt_pk_bf16_f32 v83, v114, v115
  v_pk_fma_f32 v[172:173], v[44:45], v[54:55], s[44:45] op_sel_hi:[1,0,1]
  v_pk_fma_f32 v[176:177], v[46:47], v[54:55], s[44:45] op_sel_hi:[1,0,1]
  v_pk_fma_f32 v[116:117], v[116:117], v[32:33], v[172:173]
  v_pk_fma_f32 v[118:119], v[118:119], v[34:35], v[176:177]
  v_pk_fma_f32 v[172:173], v[116:117], s[42:43], v[24:25]
  v_pk_fma_f32 v[176:177], v[118:119], s[42:43], v[24:25]
  v_exp_f32 v172, v172 clamp
  v_exp_f32 v173, v173 clamp
  v_exp_f32 v176, v176 clamp
  v_exp_f32 v177, v177 clamp
  v_max_f32 v116, s44, v116
  v_max_f32 v117, s44, v117
  v_max_f32 v118, s44, v118
  v_max_f32 v119, s44, v119
  v_pk_add_f32 v[116:117], v[116:117], v[172:173]
  v_pk_add_f32 v[118:119], v[118:119], v[176:177]
  v_cvt_pk_bf16_f32 v84, v116, v117
  v_cvt_pk_bf16_f32 v85, v118, v119
  v_pk_fma_f32 v[172:173], v[48:49], v[54:55], s[44:45] op_sel_hi:[1,0,1]
  v_pk_fma_f32 v[176:177], v[50:51], v[54:55], s[44:45] op_sel_hi:[1,0,1]
  v_pk_fma_f32 v[120:121], v[120:121], v[36:37], v[172:173]
  v_pk_fma_f32 v[122:123], v[122:123], v[38:39], v[176:177]
  v_pk_fma_f32 v[172:173], v[120:121], s[42:43], v[24:25]
  v_pk_fma_f32 v[176:177], v[122:123], s[42:43], v[24:25]
  v_exp_f32 v172, v172 clamp
  v_exp_f32 v173, v173 clamp
  v_exp_f32 v176, v176 clamp
  v_exp_f32 v177, v177 clamp
  v_max_f32 v120, s44, v120
  v_max_f32 v121, s44, v121
  v_max_f32 v122, s44, v122
  v_max_f32 v123, s44, v123
  v_pk_add_f32 v[120:121], v[120:121], v[172:173]
  v_pk_add_f32 v[122:123], v[122:123], v[176:177]
  v_cvt_pk_bf16_f32 v86, v120, v121
  v_cvt_pk_bf16_f32 v87, v122, v123
  v_pk_fma_f32 v[172:173], v[40:41], v[56:57], v[26:27] op_sel_hi:[1,0,1]
  v_pk_fma_f32 v[176:177], v[42:43], v[56:57], v[26:27] op_sel_hi:[1,0,1]
  v_pk_fma_f32 v[124:125], v[124:125], v[28:29], v[172:173]
  v_pk_fma_f32 v[126:127], v[126:127], v[30:31], v[176:177]
  v_pk_fma_f32 v[172:173], v[124:125], s[42:43], v[24:25]
  v_pk_fma_f32 v[176:177], v[126:127], s[42:43], v[24:25]
  v_exp_f32 v172, v172 clamp
  v_exp_f32 v173, v173 clamp
  v_exp_f32 v176, v176 clamp
  v_exp_f32 v177, v177 clamp
  v_max_f32 v174, s44, v124
  v_max_f32 v175, s44, v125
  v_max_f32 v178, s44, v126
  v_max_f32 v179, s44, v127
  v_pk_add_f32 v[174:175], v[174:175], v[172:173]
  v_pk_add_f32 v[178:179], v[178:179], v[176:177]
  v_cndmask_b32 v124, v124, v174, s[56:57]
  v_cndmask_b32 v125, v125, v175, s[56:57]
  v_cndmask_b32 v126, v126, v178, s[56:57]
  v_cndmask_b32 v127, v127, v179, s[56:57]
  v_cvt_pk_bf16_f32 v88, v124, v125
  v_cvt_pk_bf16_f32 v89, v126, v127
  v_pk_fma_f32 v[172:173], v[44:45], v[56:57], v[26:27] op_sel_hi:[1,0,1]
  v_pk_fma_f32 v[176:177], v[46:47], v[56:57], v[26:27] op_sel_hi:[1,0,1]
  v_pk_fma_f32 v[128:129], v[128:129], v[32:33], v[172:173]
  v_pk_fma_f32 v[130:131], v[130:131], v[34:35], v[176:177]
  v_pk_fma_f32 v[172:173], v[128:129], s[42:43], v[24:25]
  v_pk_fma_f32 v[176:177], v[130:131], s[42:43], v[24:25]
  v_exp_f32 v172, v172 clamp
  v_exp_f32 v173, v173 clamp
  v_exp_f32 v176, v176 clamp
  v_exp_f32 v177, v177 clamp
  v_max_f32 v174, s44, v128
  v_max_f32 v175, s44, v129
  v_max_f32 v178, s44, v130
  v_max_f32 v179, s44, v131
  v_pk_add_f32 v[174:175], v[174:175], v[172:173]
  v_pk_add_f32 v[178:179], v[178:179], v[176:177]
  v_cndmask_b32 v128, v128, v174, s[56:57]
  v_cndmask_b32 v129, v129, v175, s[56:57]
  v_cndmask_b32 v130, v130, v178, s[56:57]
  v_cndmask_b32 v131, v131, v179, s[56:57]
  v_cvt_pk_bf16_f32 v90, v128, v129
  v_cvt_pk_bf16_f32 v91, v130, v131
  v_pk_fma_f32 v[172:173], v[48:49], v[56:57], v[26:27] op_sel_hi:[1,0,1]
  v_pk_fma_f32 v[176:177], v[50:51], v[56:57], v[26:27] op_sel_hi:[1,0,1]
  v_pk_fma_f32 v[132:133], v[132:133], v[36:37], v[172:173]
  v_pk_fma_f32 v[134:135], v[134:135], v[38:39], v[176:177]
  v_pk_fma_f32 v[172:173], v[132:133], s[42:43], v[24:25]
  v_pk_fma_f32 v[176:177], v[134:135], s[42:43], v[24:25]
  v_exp_f32 v172, v172 clamp
  v_exp_f32 v173, v173 clamp
  v_exp_f32 v176, v176 clamp
  v_exp_f32 v177, v177 clamp
  v_max_f32 v174, s44, v132
  v_max_f32 v175, s44, v133
  v_max_f32 v178, s44, v134
  v_max_f32 v179, s44, v135
  v_pk_add_f32 v[174:175], v[174:175], v[172:173]
  v_pk_add_f32 v[178:179], v[178:179], v[176:177]
  v_cndmask_b32 v132, v132, v174, s[56:57]
  v_cndmask_b32 v133, v133, v175, s[56:57]
  v_cndmask_b32 v134, v134, v178, s[56:57]
  v_cndmask_b32 v135, v135, v179, s[56:57]
  v_cvt_pk_bf16_f32 v92, v132, v133
  v_cvt_pk_bf16_f32 v93, v134, v135
  v_pk_mul_f32 v[172:173], v[40:41], v[58:59] op_sel_hi:[1,0]
  v_pk_mul_f32 v[176:177], v[42:43], v[58:59] op_sel_hi:[1,0]
  v_pk_fma_f32 v[136:137], v[136:137], v[28:29], v[172:173]
  v_pk_fma_f32 v[138:139], v[138:139], v[30:31], v[176:177]
  v_cvt_pk_bf16_f32 v94, v136, v137
  v_cvt_pk_bf16_f32 v95, v138, v139
  v_pk_mul_f32 v[172:173], v[44:45], v[58:59] op_sel_hi:[1,0]
  v_pk_mul_f32 v[176:177], v[46:47], v[58:59] op_sel_hi:[1,0]
  v_pk_fma_f32 v[140:141], v[140:141], v[32:33], v[172:173]
  v_pk_fma_f32 v[142:143], v[142:143], v[34:35], v[176:177]
  v_cvt_pk_bf16_f32 v96, v140, v141
  v_cvt_pk_bf16_f32 v97, v142, v143
  v_pk_mul_f32 v[172:173], v[48:49], v[58:59] op_sel_hi:[1,0]
  v_pk_mul_f32 v[176:177], v[50:51], v[58:59] op_sel_hi:[1,0]
  v_pk_fma_f32 v[144:145], v[144:145], v[36:37], v[172:173]
  v_pk_fma_f32 v[146:147], v[146:147], v[38:39], v[176:177]
  v_cvt_pk_bf16_f32 v98, v144, v145
  v_cvt_pk_bf16_f32 v99, v146, v147
  v_pk_mul_f32 v[172:173], v[40:41], v[60:61] op_sel_hi:[1,0]
  v_pk_mul_f32 v[176:177], v[42:43], v[60:61] op_sel_hi:[1,0]
  v_pk_fma_f32 v[148:149], v[148:149], v[28:29], v[172:173]
  v_pk_fma_f32 v[150:151], v[150:151], v[30:31], v[176:177]
  v_cmp_ne_u32 s[44:45], 0, v28
  v_cmp_ne_u32 s[46:47], 0, v29
  v_cmp_ne_u32 s[48:49], 0, v30
  v_cmp_ne_u32 s[50:51], 0, v31
  v_cndmask_b32 v172, 0, 1.0, s[44:45]
  v_cndmask_b32 v173, 0, 1.0, s[46:47]
  v_cndmask_b32 v176, 0, 1.0, s[48:49]
  v_cndmask_b32 v177, 0, 1.0, s[50:51]
  v_cndmask_b32 v148, v148, v172, s[58:59]
  v_cndmask_b32 v149, v149, v173, s[58:59]
  v_cndmask_b32 v150, v150, v176, s[58:59]
  v_cndmask_b32 v151, v151, v177, s[58:59]
  v_cvt_pk_bf16_f32 v188, v148, v149
  v_cvt_pk_bf16_f32 v189, v150, v151
  v_pk_mul_f32 v[172:173], v[44:45], v[60:61] op_sel_hi:[1,0]
  v_pk_mul_f32 v[176:177], v[46:47], v[60:61] op_sel_hi:[1,0]
  v_pk_fma_f32 v[152:153], v[152:153], v[32:33], v[172:173]
  v_pk_fma_f32 v[154:155], v[154:155], v[34:35], v[176:177]
  v_cmp_ne_u32 s[44:45], 0, v32
  v_cmp_ne_u32 s[46:47], 0, v33
  v_cmp_ne_u32 s[48:49], 0, v34
  v_cmp_ne_u32 s[50:51], 0, v35
  v_cndmask_b32 v172, 0, 1.0, s[44:45]
  v_cndmask_b32 v173, 0, 1.0, s[46:47]
  v_cndmask_b32 v176, 0, 1.0, s[48:49]
  v_cndmask_b32 v177, 0, 1.0, s[50:51]
  v_cndmask_b32 v152, v152, v172, s[58:59]
  v_cndmask_b32 v153, v153, v173, s[58:59]
  v_cndmask_b32 v154, v154, v176, s[58:59]
  v_cndmask_b32 v155, v155, v177, s[58:59]
  v_cvt_pk_bf16_f32 v190, v152, v153
  v_cvt_pk_bf16_f32 v191, v154, v155
  v_pk_mul_f32 v[172:173], v[48:49], v[60:61] op_sel_hi:[1,0]
  v_pk_mul_f32 v[176:177], v[50:51], v[60:61] op_sel_hi:[1,0]
  v_pk_fma_f32 v[156:157], v[156:157], v[36:37], v[172:173]
  v_pk_fma_f32 v[158:159], v[158:159], v[38:39], v[176:177]
  v_cmp_ne_u32 s[44:45], 0, v36
  v_cmp_ne_u32 s[46:47], 0, v37
  v_cmp_ne_u32 s[48:49], 0, v38
  v_cmp_ne_u32 s[50:51], 0, v39
  v_cndmask_b32 v172, 0, 1.0, s[44:45]
  v_cndmask_b32 v173, 0, 1.0, s[46:47]
  v_cndmask_b32 v176, 0, 1.0, s[48:49]
  v_cndmask_b32 v177, 0, 1.0, s[50:51]
  v_cndmask_b32 v156, v156, v172, s[58:59]
  v_cndmask_b32 v157, v157, v173, s[58:59]
  v_cndmask_b32 v158, v158, v176, s[58:59]
  v_cndmask_b32 v159, v159, v177, s[58:59]
  v_cvt_pk_bf16_f32 v192, v156, v157
  v_cvt_pk_bf16_f32 v193, v158, v159
  v_mfma_f32_16x16x32_bf16 v[100:103], v[76:79], v[88:91], 0
  v_mfma_f32_16x16x32_bf16 v[104:107], v[76:79], v[94:97], 0
  v_mfma_f32_16x16x32_bf16 v[108:111], v[76:79], v[188:191], 0
  v_mfma_f32_16x16x32_bf16 v[112:115], v[82:85], v[88:91], 0
  v_mfma_f32_16x16x32_bf16 v[116:119], v[82:85], v[94:97], 0
  v_mfma_f32_16x16x32_bf16 v[120:123], v[82:85], v[188:191], 0
  v_mfma_f32_16x16x32_bf16 v[124:127], v[88:91], v[94:97], 0
  v_mfma_f32_16x16x32_bf16 v[128:131], v[88:91], v[188:191], 0
  v_mfma_f32_16x16x16_bf16 v[100:103], v[80:81], v[92:93], v[100:103]
  v_mfma_f32_16x16x16_bf16 v[104:107], v[80:81], v[98:99], v[104:107]
  v_mfma_f32_16x16x16_bf16 v[108:111], v[80:81], v[192:193], v[108:111]
  v_mfma_f32_16x16x16_bf16 v[112:115], v[86:87], v[92:93], v[112:115]
  v_mfma_f32_16x16x16_bf16 v[116:119], v[86:87], v[98:99], v[116:119]
  v_mfma_f32_16x16x16_bf16 v[120:123], v[86:87], v[192:193], v[120:123]
  v_mfma_f32_16x16x16_bf16 v[124:127], v[92:93], v[98:99], v[124:127]
  v_mfma_f32_16x16x16_bf16 v[128:131], v[92:93], v[192:193], v[128:131]
  s_add_u32 s16, s84, 12386304
  s_addc_u32 s17, s85, 0
  s_mov_b32 s18, 51200
  s_mov_b32 s19, 0x20000
  v_subrev_u32 v4, 128, v0
  v_cmp_le_i32 vcc, 40, v4
  v_lshrrev_b32 v2, 5, v0
  v_bfe_u32 v3, v0, 4, 1
  v_cndmask_b32 v5, 0, 1, vcc
  v_mul_u32_u24 v2, 320, v2
  v_mul_u32_u24 v3, 1600, v3
  v_mul_u32_u24 v5, 1288, v5
  v_add3_u32 v2, v2, v3, 64
  v_lshl_add_u32 v2, v7, 2, v2
  v_lshrrev_b32 v3, 1, v4
  v_lshl_add_u32 v5, v3, 4, v5
  v_and_b32 v3, 1, v0
  v_lshl_add_u32 v5, v3, 2, v5
  v_add_u32 v5, 1088, v5
  v_cmp_gt_i32 vcc, 0, v4
  s_movk_i32 s38, 80
  s_mul_i32 s37, s26, 6144
  v_cndmask_b32 v5, v5, v2, vcc
  v_cmp_gt_i32 vcc, s38, v4
  v_lshl_add_u32 v3, v0, 2, s37
  s_mul_i32 s37, s27, 320
  s_add_u32 s37, s37, 149504
  v_mov_b32 v4, 0x7fff0000
  v_cndmask_b32 v5, 0, v5, vcc
  v_lshl_add_u32 v2, v1, 2, s37
  v_cndmask_b32 v4, v4, v3, vcc
  v_add_u32 v5, 149696, v5
  s_movk_i32 s37, 4096
  s_mov_b32 exec_lo, 0xfff0fff0
  s_mov_b32 exec_hi, 0xfff0fff0
  ds_write_b128 v12, v[100:103] offset:448
  s_mov_b32 exec_lo, 0x3f003f
  s_mov_b32 exec_hi, 0x3f003f
  ds_write_b128 v12, v[104:107] offset:704
  s_mov_b32 exec_lo, 0x1000100
  s_mov_b32 exec_hi, 0x1000100
  ds_write_b128 v12, v[108:111] offset:672
  s_mov_b32 exec_lo, 0xfff0
  s_mov_b32 exec_hi, 0x0
  ds_write_b64 v12, v[112:113] offset:1728
  s_mov_b32 exec_lo, 0x3f
  s_mov_b32 exec_hi, 0x0
  ds_write_b64 v12, v[116:117] offset:1984
  s_mov_b32 exec_lo, 0xffc00000
  s_mov_b32 exec_hi, 0xffc0ffc0
  ds_write_b128 v13, v[116:119] offset:512
  s_mov_b32 exec_lo, 0xffc0
  s_mov_b32 exec_hi, 0x0
  ds_write_b64 v13, v[118:119] offset:512
  ds_write_b128 v13, v[124:127] offset:184
  s_mov_b32 exec_lo, 0x100
  s_mov_b32 exec_hi, 0x0
  ds_write_b64 v12, v[120:121] offset:1952
  s_mov_b32 exec_lo, 0x1ff0000
  s_mov_b32 exec_hi, 0x1ff01ff
  ds_write_b128 v14, v[120:123] offset:512
  s_mov_b32 exec_lo, 0x1ff
  s_mov_b32 exec_hi, 0x0
  ds_write_b64 v14, v[122:123] offset:512
  ds_write_b128 v14, v[128:131] offset:184
  s_mov_b64 exec, -1
  s_waitcnt lgkmcnt(0)
  s_barrier
  ds_read_b32 v172, v2 offset:0
  ds_read_b32 v173, v2 offset:6400
  ds_read_b32 v174, v2 offset:1600
  ds_read_b32 v175, v2 offset:8000
  ds_read_b32 v176, v5 offset:0
  ds_read_b32 v177, v5 offset:6400
  ds_read_b32 v178, v2 offset:3200
  ds_read_b32 v179, v2 offset:9600
  ds_read_b32 v180, v2 offset:4800
  ds_read_b32 v181, v2 offset:11200
  ds_read_b32 v182, v5 offset:3200
  ds_read_b32 v183, v5 offset:9600
  s_waitcnt lgkmcnt(10)
  v_add_f32 v172, v172, v173
  buffer_atomic_add_f32 v172, v3, s[16:19], 0 offen offset:0
  s_waitcnt lgkmcnt(8)
  v_add_f32 v174, v174, v175
  buffer_atomic_add_f32 v174, v3, s[16:19], 0 offen offset:1024
  s_waitcnt lgkmcnt(6)
  v_add_f32 v176, v176, v177
  buffer_atomic_add_f32 v176, v4, s[16:19], 0 offen offset:2048
  s_waitcnt lgkmcnt(4)
  v_add_f32 v178, v178, v179
  buffer_atomic_add_f32 v178, v3, s[16:19], 0 offen offset:3072
  s_waitcnt lgkmcnt(2)
  v_add_f32 v180, v180, v181
  buffer_atomic_add_f32 v180, v3, s[16:19], s37 offen offset:0
  s_waitcnt lgkmcnt(0)
  v_add_f32 v182, v182, v183
  buffer_atomic_add_f32 v182, v4, s[16:19], s37 offen offset:1024
  s_branch L_c1d_3101
L_q_3104:
  s_mul_i32 s37, s51, 192
  v_lshl_add_u32 v2, v4, 3, s37
  v_lshrrev_b32 v3, 6, v2
  v_and_b32 v2, 63, v2
  v_xor_b32 v2, v2, v5
  v_lshl_add_u32 v2, v3, 8, v2
  v_add_u32 v12, v2, v22
  v_xor_b32 v13, 32, v12
  v_add_u32 v10, s32, v8
  v_add_u32 v11, s32, v9
  v_add_u32 v17, s32, v12
  v_add_u32 v18, s32, v13
  s_cmp_lg_u32 s51, 0
  s_cbranch_scc1 L_h1_3111
  .p2align 6
L_k_3113:
  s_waitcnt lgkmcnt(0)
  s_barrier
  v_mfma_f32_16x16x32_bf16 v[100:103], v[76:79], v[40:43], v[100:103]
  ds_read_b64_tr_b16 v[52:53], v17 offset:0
  v_mfma_f32_16x16x32_bf16 v[104:107], v[76:79], v[44:47], v[104:107]
  ds_read_b64_tr_b16 v[54:55], v17 offset:1536
  v_mfma_f32_16x16x32_bf16 v[108:111], v[76:79], v[48:51], v[108:111]
  ds_read_b128 v[28:31], v10 offset:0
  v_mfma_f32_16x16x32_bf16 v[112:115], v[80:83], v[40:43], v[112:115]
  ds_read_b128 v[32:35], v10 offset:2048
  v_mfma_f32_16x16x32_bf16 v[116:119], v[80:83], v[44:47], v[116:119]
  ds_read_b128 v[36:39], v10 offset:4096
  v_mfma_f32_16x16x32_bf16 v[120:123], v[80:83], v[48:51], v[120:123]
  ds_read_b64_tr_b16 v[56:57], v18 offset:0
  v_mfma_f32_16x16x32_bf16 v[124:127], v[84:87], v[40:43], v[124:127]
  ds_read_b64_tr_b16 v[58:59], v18 offset:1536
  v_mfma_f32_16x16x32_bf16 v[128:131], v[84:87], v[44:47], v[128:131]
  ds_read_b64_tr_b16 v[60:61], v17 offset:256
  v_mfma_f32_16x16x32_bf16 v[132:135], v[84:87], v[48:51], v[132:135]
  ds_read_b64_tr_b16 v[62:63], v17 offset:1792
  v_mfma_f32_16x16x32_bf16 v[136:139], v[88:91], v[40:43], v[136:139]
  ds_read_b64_tr_b16 v[64:65], v18 offset:256
  v_mfma_f32_16x16x32_bf16 v[140:143], v[88:91], v[44:47], v[140:143]
  ds_read_b64_tr_b16 v[66:67], v18 offset:1792
  v_mfma_f32_16x16x32_bf16 v[144:147], v[88:91], v[48:51], v[144:147]
  ds_read_b64_tr_b16 v[68:69], v17 offset:512
  v_mfma_f32_16x16x32_bf16 v[148:151], v[92:95], v[40:43], v[148:151]
  ds_read_b64_tr_b16 v[70:71], v17 offset:2048
  v_mfma_f32_16x16x32_bf16 v[152:155], v[92:95], v[44:47], v[152:155]
  ds_read_b64_tr_b16 v[72:73], v18 offset:512
  v_mfma_f32_16x16x32_bf16 v[156:159], v[92:95], v[48:51], v[156:159]
  ds_read_b64_tr_b16 v[74:75], v18 offset:2048
  v_mfma_f32_16x16x32_bf16 v[160:163], v[96:99], v[40:43], v[160:163]
  s_add_u32 s32, s32, 36864
  s_cmp_eq_u32 s32, 147456
  v_mfma_f32_16x16x32_bf16 v[164:167], v[96:99], v[44:47], v[164:167]
  s_cselect_b32 s32, 0, s32
  s_add_u32 s34, s34, 1
  v_mfma_f32_16x16x32_bf16 v[168:171], v[96:99], v[48:51], v[168:171]
  v_mfma_f32_16x16x32_bf16 v[196:199], v[40:43], v[40:43], v[196:199]
  v_mfma_f32_16x16x32_bf16 v[200:203], v[44:47], v[44:47], v[200:203]
  v_mfma_f32_16x16x32_bf16 v[204:207], v[48:51], v[48:51], v[204:207]
  s_waitcnt lgkmcnt(0)
  v_mfma_f32_16x16x32_bf16 v[100:103], v[52:55], v[28:31], v[100:103]
  ds_read_b64_tr_b16 v[76:77], v17 offset:12288
  v_mfma_f32_16x16x32_bf16 v[104:107], v[52:55], v[32:35], v[104:107]
  ds_read_b64_tr_b16 v[78:79], v17 offset:13824
  v_mfma_f32_16x16x32_bf16 v[108:111], v[52:55], v[36:39], v[108:111]
  ds_read_b128 v[40:43], v11 offset:0
  v_mfma_f32_16x16x32_bf16 v[112:115], v[56:59], v[28:31], v[112:115]
  ds_read_b128 v[44:47], v11 offset:2048
  v_mfma_f32_16x16x32_bf16 v[116:119], v[56:59], v[32:35], v[116:119]
  ds_read_b128 v[48:51], v11 offset:4096
  v_mfma_f32_16x16x32_bf16 v[120:123], v[56:59], v[36:39], v[120:123]
  ds_read_b64_tr_b16 v[80:81], v18 offset:12288
  v_mfma_f32_16x16x32_bf16 v[124:127], v[60:63], v[28:31], v[124:127]
  ds_read_b64_tr_b16 v[82:83], v18 offset:13824
  v_mfma_f32_16x16x32_bf16 v[128:131], v[60:63], v[32:35], v[128:131]
  ds_read_b64_tr_b16 v[84:85], v17 offset:12544
  v_mfma_f32_16x16x32_bf16 v[132:135], v[60:63], v[36:39], v[132:135]
  ds_read_b64_tr_b16 v[86:87], v17 offset:14080
  v_mfma_f32_16x16x32_bf16 v[136:139], v[64:67], v[28:31], v[136:139]
  ds_read_b64_tr_b16 v[88:89], v18 offset:12544
  v_mfma_f32_16x16x32_bf16 v[140:143], v[64:67], v[32:35], v[140:143]
  ds_read_b64_tr_b16 v[90:91], v18 offset:14080
  v_mfma_f32_16x16x32_bf16 v[144:147], v[64:67], v[36:39], v[144:147]
  ds_read_b64_tr_b16 v[92:93], v17 offset:12800
  v_mfma_f32_16x16x32_bf16 v[148:151], v[68:71], v[28:31], v[148:151]
  ds_read_b64_tr_b16 v[94:95], v17 offset:14336
  v_mfma_f32_16x16x32_bf16 v[152:155], v[68:71], v[32:35], v[152:155]
  ds_read_b64_tr_b16 v[96:97], v18 offset:12800
  v_mfma_f32_16x16x32_bf16 v[156:159], v[68:71], v[36:39], v[156:159]
  ds_read_b64_tr_b16 v[98:99], v18 offset:14336
  v_mfma_f32_16x16x32_bf16 v[160:163], v[72:75], v[28:31], v[160:163]
  v_add_u32 v10, s32, v8
  v_add_u32 v11, s32, v9
  v_add_u32 v17, s32, v12
  v_add_u32 v18, s32, v13
  v_mfma_f32_16x16x32_bf16 v[164:167], v[72:75], v[32:35], v[164:167]
  s_cmp_lt_u32 s34, 9
  v_mfma_f32_16x16x32_bf16 v[168:171], v[72:75], v[36:39], v[168:171]
  v_mfma_f32_16x16x32_bf16 v[196:199], v[28:31], v[28:31], v[196:199]
  v_mfma_f32_16x16x32_bf16 v[200:203], v[32:35], v[32:35], v[200:203]
  v_mfma_f32_16x16x32_bf16 v[204:207], v[36:39], v[36:39], v[204:207]
  s_cbranch_scc1 L_k_3113
  s_waitcnt lgkmcnt(0)
  v_mfma_f32_16x16x32_bf16 v[196:199], v[40:43], v[40:43], v[196:199]
  v_mfma_f32_16x16x32_bf16 v[200:203], v[44:47], v[44:47], v[200:203]
  v_mfma_f32_16x16x32_bf16 v[204:207], v[48:51], v[48:51], v[204:207]
  s_branch L_hj_3112
L_h1_3111:
  .p2align 6
L_k_3114:
  s_waitcnt lgkmcnt(0)
  s_barrier
  v_mfma_f32_16x16x32_bf16 v[100:103], v[76:79], v[40:43], v[100:103]
  ds_read_b64_tr_b16 v[52:53], v17 offset:0
  v_mfma_f32_16x16x32_bf16 v[104:107], v[76:79], v[44:47], v[104:107]
  ds_read_b64_tr_b16 v[54:55], v17 offset:1536
  v_mfma_f32_16x16x32_bf16 v[108:111], v[76:79], v[48:51], v[108:111]
  ds_read_b128 v[28:31], v10 offset:0
  v_mfma_f32_16x16x32_bf16 v[112:115], v[80:83], v[40:43], v[112:115]
  ds_read_b128 v[32:35], v10 offset:2048
  v_mfma_f32_16x16x32_bf16 v[116:119], v[80:83], v[44:47], v[116:119]
  ds_read_b128 v[36:39], v10 offset:4096
  v_mfma_f32_16x16x32_bf16 v[120:123], v[80:83], v[48:51], v[120:123]
  ds_read_b64_tr_b16 v[56:57], v18 offset:0
  v_mfma_f32_16x16x32_bf16 v[124:127], v[84:87], v[40:43], v[124:127]
  ds_read_b64_tr_b16 v[58:59], v18 offset:1536
  v_mfma_f32_16x16x32_bf16 v[128:131], v[84:87], v[44:47], v[128:131]
  ds_read_b64_tr_b16 v[60:61], v17 offset:256
  v_mfma_f32_16x16x32_bf16 v[132:135], v[84:87], v[48:51], v[132:135]
  ds_read_b64_tr_b16 v[62:63], v17 offset:1792
  v_mfma_f32_16x16x32_bf16 v[136:139], v[88:91], v[40:43], v[136:139]
  ds_read_b64_tr_b16 v[64:65], v18 offset:256
  v_mfma_f32_16x16x32_bf16 v[140:143], v[88:91], v[44:47], v[140:143]
  ds_read_b64_tr_b16 v[66:67], v18 offset:1792
  v_mfma_f32_16x16x32_bf16 v[144:147], v[88:91], v[48:51], v[144:147]
  ds_read_b64_tr_b16 v[68:69], v17 offset:512
  v_mfma_f32_16x16x32_bf16 v[148:151], v[92:95], v[40:43], v[148:151]
  ds_read_b64_tr_b16 v[70:71], v17 offset:2048
  v_mfma_f32_16x16x32_bf16 v[152:155], v[92:95], v[44:47], v[152:155]
  ds_read_b64_tr_b16 v[72:73], v18 offset:512
  v_mfma_f32_16x16x32_bf16 v[156:159], v[92:95], v[48:51], v[156:159]
  ds_read_b64_tr_b16 v[74:75], v18 offset:2048
  v_mfma_f32_16x16x32_bf16 v[160:163], v[96:99], v[40:43], v[160:163]
  s_add_u32 s32, s32, 36864
  s_cmp_eq_u32 s32, 147456
  v_mfma_f32_16x16x32_bf16 v[164:167], v[96:99], v[44:47], v[164:167]
  s_cselect_b32 s32, 0, s32
  s_add_u32 s34, s34, 1
  v_mfma_f32_16x16x32_bf16 v[168:171], v[96:99], v[48:51], v[168:171]
  v_mfma_f32_16x16x32_bf16 v[196:199], v[40:43], v[208:211], v[196:199]
  v_mfma_f32_16x16x32_bf16 v[200:203], v[44:47], v[208:211], v[200:203]
  v_mfma_f32_16x16x32_bf16 v[204:207], v[48:51], v[208:211], v[204:207]
  s_waitcnt lgkmcnt(0)
  v_mfma_f32_16x16x32_bf16 v[100:103], v[52:55], v[28:31], v[100:103]
  ds_read_b64_tr_b16 v[76:77], v17 offset:12288
  v_mfma_f32_16x16x32_bf16 v[104:107], v[52:55], v[32:35], v[104:107]
  ds_read_b64_tr_b16 v[78:79], v17 offset:13824
  v_mfma_f32_16x16x32_bf16 v[108:111], v[52:55], v[36:39], v[108:111]
  ds_read_b128 v[40:43], v11 offset:0
  v_mfma_f32_16x16x32_bf16 v[112:115], v[56:59], v[28:31], v[112:115]
  ds_read_b128 v[44:47], v11 offset:2048
  v_mfma_f32_16x16x32_bf16 v[116:119], v[56:59], v[32:35], v[116:119]
  ds_read_b128 v[48:51], v11 offset:4096
  v_mfma_f32_16x16x32_bf16 v[120:123], v[56:59], v[36:39], v[120:123]
  ds_read_b64_tr_b16 v[80:81], v18 offset:12288
  v_mfma_f32_16x16x32_bf16 v[124:127], v[60:63], v[28:31], v[124:127]
  ds_read_b64_tr_b16 v[82:83], v18 offset:13824
  v_mfma_f32_16x16x32_bf16 v[128:131], v[60:63], v[32:35], v[128:131]
  ds_read_b64_tr_b16 v[84:85], v17 offset:12544
  v_mfma_f32_16x16x32_bf16 v[132:135], v[60:63], v[36:39], v[132:135]
  ds_read_b64_tr_b16 v[86:87], v17 offset:14080
  v_mfma_f32_16x16x32_bf16 v[136:139], v[64:67], v[28:31], v[136:139]
  ds_read_b64_tr_b16 v[88:89], v18 offset:12544
  v_mfma_f32_16x16x32_bf16 v[140:143], v[64:67], v[32:35], v[140:143]
  ds_read_b64_tr_b16 v[90:91], v18 offset:14080
  v_mfma_f32_16x16x32_bf16 v[144:147], v[64:67], v[36:39], v[144:147]
  ds_read_b64_tr_b16 v[92:93], v17 offset:12800
  v_mfma_f32_16x16x32_bf16 v[148:151], v[68:71], v[28:31], v[148:151]
  ds_read_b64_tr_b16 v[94:95], v17 offset:14336
  v_mfma_f32_16x16x32_bf16 v[152:155], v[68:71], v[32:35], v[152:155]
  ds_read_b64_tr_b16 v[96:97], v18 offset:12800
  v_mfma_f32_16x16x32_bf16 v[156:159], v[68:71], v[36:39], v[156:159]
  ds_read_b64_tr_b16 v[98:99], v18 offset:14336
  v_mfma_f32_16x16x32_bf16 v[160:163], v[72:75], v[28:31], v[160:163]
  v_add_u32 v10, s32, v8
  v_add_u32 v11, s32, v9
  v_add_u32 v17, s32, v12
  v_add_u32 v18, s32, v13
  v_mfma_f32_16x16x32_bf16 v[164:167], v[72:75], v[32:35], v[164:167]
  s_cmp_lt_u32 s34, 9
  v_mfma_f32_16x16x32_bf16 v[168:171], v[72:75], v[36:39], v[168:171]
  v_mfma_f32_16x16x32_bf16 v[196:199], v[28:31], v[208:211], v[196:199]
  v_mfma_f32_16x16x32_bf16 v[200:203], v[32:35], v[208:211], v[200:203]
  v_mfma_f32_16x16x32_bf16 v[204:207], v[36:39], v[208:211], v[204:207]
  s_cbranch_scc1 L_k_3114
  s_waitcnt lgkmcnt(0)
  v_mfma_f32_16x16x32_bf16 v[196:199], v[40:43], v[208:211], v[196:199]
  v_mfma_f32_16x16x32_bf16 v[200:203], v[44:47], v[208:211], v[200:203]
  v_mfma_f32_16x16x32_bf16 v[204:207], v[48:51], v[208:211], v[204:207]
L_hj_3112:
  v_mfma_f32_16x16x32_bf16 v[100:103], v[76:79], v[40:43], v[100:103]
  s_mul_i32 s37, s51, 384
  s_mul_i32 s38, s50, 192
  v_mfma_f32_16x16x32_bf16 v[104:107], v[76:79], v[44:47], v[104:107]
  s_add_u32 s38, s38, 147456
  s_add_u32 s37, s37, s38
  v_mfma_f32_16x16x32_bf16 v[108:111], v[76:79], v[48:51], v[108:111]
  v_lshl_add_u32 v2, v7, 2, s37
  v_lshl_add_u32 v3, v1, 2, s38
  v_mfma_f32_16x16x32_bf16 v[112:115], v[80:83], v[40:43], v[112:115]
  s_mov_b32 vcc_lo, 0x22222222
  s_mov_b32 vcc_hi, 0x22222222
  v_mfma_f32_16x16x32_bf16 v[116:119], v[80:83], v[44:47], v[116:119]
  v_cndmask_b32 v196, v196, v197, vcc
  v_mfma_f32_16x16x32_bf16 v[120:123], v[80:83], v[48:51], v[120:123]
  v_cndmask_b32 v200, v200, v201, vcc
  v_mfma_f32_16x16x32_bf16 v[124:127], v[84:87], v[40:43], v[124:127]
  v_cndmask_b32 v204, v204, v205, vcc
  v_mfma_f32_16x16x32_bf16 v[128:131], v[84:87], v[44:47], v[128:131]
  s_mov_b32 vcc_lo, 0x44444444
  s_mov_b32 vcc_hi, 0x44444444
  v_mfma_f32_16x16x32_bf16 v[132:135], v[84:87], v[48:51], v[132:135]
  v_cndmask_b32 v196, v196, v198, vcc
  v_mfma_f32_16x16x32_bf16 v[136:139], v[88:91], v[40:43], v[136:139]
  v_cndmask_b32 v200, v200, v202, vcc
  v_mfma_f32_16x16x32_bf16 v[140:143], v[88:91], v[44:47], v[140:143]
  v_cndmask_b32 v204, v204, v206, vcc
  v_mfma_f32_16x16x32_bf16 v[144:147], v[88:91], v[48:51], v[144:147]
  s_mov_b32 vcc_lo, 0x88888888
  s_mov_b32 vcc_hi, 0x88888888
  v_mfma_f32_16x16x32_bf16 v[148:151], v[92:95], v[40:43], v[148:151]
  v_cndmask_b32 v196, v196, v199, vcc
  v_mfma_f32_16x16x32_bf16 v[152:155], v[92:95], v[44:47], v[152:155]
  v_cndmask_b32 v200, v200, v203, vcc
  v_mfma_f32_16x16x32_bf16 v[156:159], v[92:95], v[48:51], v[156:159]
  v_cndmask_b32 v204, v204, v207, vcc
  v_mfma_f32_16x16x32_bf16 v[160:163], v[96:99], v[40:43], v[160:163]
  v_mfma_f32_16x16x32_bf16 v[164:167], v[96:99], v[44:47], v[164:167]
  v_mfma_f32_16x16x32_bf16 v[168:171], v[96:99], v[48:51], v[168:171]
  s_mov_b32 exec_lo, 0xf0000f
  s_mov_b32 exec_hi, 0xf0000f00
  ds_write_b32 v2, v196 offset:0
  ds_write_b32 v2, v200 offset:64
  ds_write_b32 v2, v204 offset:128
  s_mov_b64 exec, -1
  s_mul_i32 s37, s50, 47
  s_add_u32 s37, s37, s28
  s_sub_u32 s37, 2048, s37
  s_max_i32 s37, s37, 0
  s_min_u32 s37, s37, 47
  s_mul_i32 s38, s27, 512
  s_add_u32 s38, s38, 124928
  v_cmp_gt_u32 vcc, s37, v1
  v_lshl_add_u32 v212, v1, 2, s38
  s_waitcnt lgkmcnt(0)
  s_barrier
  ds_read_b32 v196, v3
  ds_read_b32 v197, v3 offset:384
  s_mov_b32 s37, 0x3ae38e39
  s_waitcnt lgkmcnt(0)
  v_mul_f32 v197, s37, v197
  v_mul_f32 v196, s37, v196
  v_fma_f32 v196, -v197, v197, v196
  v_max_f32 v196, 0, v196
  v_add_f32 v196, 0x3727c5ac, v196
  v_rsq_f32 v196, v196
  v_cndmask_b32 v197, 0, v197, vcc
  v_cndmask_b32 v196, 0, v196, vcc
  v_mul_f32 v197, -v197, v196
  ds_write_b32 v212, v196
  ds_write_b32 v212, v197 offset:256
  v_lshl_add_u32 v2, v7, 2, s38
  ds_read_b32 v28, v2 offset:0
  ds_read_b32 v34, v2 offset:256
  ds_read_b32 v30, v2 offset:64
  ds_read_b32 v36, v2 offset:320
  ds_read_b32 v32, v2 offset:128
  ds_read_b32 v38, v2 offset:384
  s_add_u32 s16, s84, 0
  s_addc_u32 s17, s85, 0
  s_mov_b32 s18, 2359296
  s_mov_b32 s19, 0x20000
  s_mul_i32 s37, s50, 47
  s_add_u32 s37, s37, s28
  v_add_u32 v2, s37, v7
  v_mul_u32_u24 v2, 1152, v2
  s_sub_u32 s37, s26, 8
  s_lshl_b32 s37, s37, 1
  s_add_u32 s37, s37, s51
  s_mul_i32 s37, s37, 192
  v_and_b32 v3, 1, v6
  v_lshl_add_u32 v2, v3, 5, v2
  v_lshrrev_b32 v3, 1, v6
  v_lshl_add_u32 v2, v3, 4, v2
  v_cmp_ne_u32 vcc, 15, v7
  v_add_u32 v10, s37, v2
  v_add_u32 v11, 18432, v10
  v_add_u32 v17, 36864, v10
  v_cndmask_b32 v17, 0x40000000, v17, vcc
  v_mov_b32_dpp v52, v108 row_newbcast:15 row_mask:0xf bank_mask:0xf
  v_mov_b32_dpp v53, v109 row_newbcast:15 row_mask:0xf bank_mask:0xf
  v_mov_b32_dpp v54, v110 row_newbcast:15 row_mask:0xf bank_mask:0xf
  v_mov_b32_dpp v55, v111 row_newbcast:15 row_mask:0xf bank_mask:0xf
  v_mov_b32_dpp v56, v120 row_newbcast:15 row_mask:0xf bank_mask:0xf
  v_mov_b32_dpp v57, v121 row_newbcast:15 row_mask:0xf bank_mask:0xf
  v_mov_b32_dpp v58, v122 row_newbcast:15 row_mask:0xf bank_mask:0xf
  v_mov_b32_dpp v59, v123 row_newbcast:15 row_mask:0xf bank_mask:0xf
  v_mov_b32_dpp v60, v132 row_newbcast:15 row_mask:0xf bank_mask:0xf
  v_mov_b32_dpp v61, v133 row_newbcast:15 row_mask:0xf bank_mask:0xf
  v_mov_b32_dpp v62, v134 row_newbcast:15 row_mask:0xf bank_mask:0xf
  v_mov_b32_dpp v63, v135 row_newbcast:15 row_mask:0xf bank_mask:0xf
  v_mov_b32_dpp v64, v144 row_newbcast:15 row_mask:0xf bank_mask:0xf
  v_mov_b32_dpp v65, v145 row_newbcast:15 row_mask:0xf bank_mask:0xf
  v_mov_b32_dpp v66, v146 row_newbcast:15 row_mask:0xf bank_mask:0xf
  v_mov_b32_dpp v67, v147 row_newbcast:15 row_mask:0xf bank_mask:0xf
  v_mov_b32_dpp v68, v156 row_newbcast:15 row_mask:0xf bank_mask:0xf
  v_mov_b32_dpp v69, v157 row_newbcast:15 row_mask:0xf bank_mask:0xf
  v_mov_b32_dpp v70, v158 row_newbcast:15 row_mask:0xf bank_mask:0xf
  v_mov_b32_dpp v71, v159 row_newbcast:15 row_mask:0xf bank_mask:0xf
  v_mov_b32_dpp v72, v168 row_newbcast:15 row_mask:0xf bank_mask:0xf
  v_mov_b32_dpp v73, v169 row_newbcast:15 row_mask:0xf bank_mask:0xf
  v_mov_b32_dpp v74, v170 row_newbcast:15 row_mask:0xf bank_mask:0xf
  v_mov_b32_dpp v75, v171 row_newbcast:15 row_mask:0xf bank_mask:0xf
  s_waitcnt lgkmcnt(0)
  s_barrier
  v_pk_fma_f32 v[172:173], v[52:53], v[34:35], s[44:45] op_sel_hi:[1,0,1]
  v_pk_fma_f32 v[176:177], v[54:55], v[34:35], s[44:45] op_sel_hi:[1,0,1]
  v_pk_fma_f32 v[100:101], v[100:101], v[28:29], v[172:173] op_sel_hi:[1,0,1]
  v_pk_fma_f32 v[102:103], v[102:103], v[28:29], v[176:177] op_sel_hi:[1,0,1]
  v_pk_fma_f32 v[172:173], v[100:101], s[42:43], v[24:25]
  v_pk_fma_f32 v[176:177], v[102:103], s[42:43], v[24:25]
  v_exp_f32 v172, v172 clamp
  v_exp_f32 v173, v173 clamp
  v_exp_f32 v176, v176 clamp
  v_exp_f32 v177, v177 clamp
  v_max_f32 v100, s44, v100
  v_max_f32 v101, s44, v101
  v_max_f32 v102, s44, v102
  v_max_f32 v103, s44, v103
  v_pk_add_f32 v[100:101], v[100:101], v[172:173]
  v_pk_add_f32 v[102:103], v[102:103], v[176:177]
  v_cvt_pk_bf16_f32 v76, v100, v101
  v_cvt_pk_bf16_f32 v77, v102, v103
  v_pk_fma_f32 v[172:173], v[56:57], v[34:35], s[44:45] op_sel_hi:[1,0,1]
  v_pk_fma_f32 v[176:177], v[58:59], v[34:35], s[44:45] op_sel_hi:[1,0,1]
  v_pk_fma_f32 v[112:113], v[112:113], v[28:29], v[172:173] op_sel_hi:[1,0,1]
  v_pk_fma_f32 v[114:115], v[114:115], v[28:29], v[176:177] op_sel_hi:[1,0,1]
  v_pk_fma_f32 v[172:173], v[112:113], s[42:43], v[24:25]
  v_pk_fma_f32 v[176:177], v[114:115], s[42:43], v[24:25]
  v_exp_f32 v172, v172 clamp
  v_exp_f32 v173, v173 clamp
  v_exp_f32 v176, v176 clamp
  v_exp_f32 v177, v177 clamp
  v_max_f32 v112, s44, v112
  v_max_f32 v113, s44, v113
  v_max_f32 v114, s44, v114
  v_max_f32 v115, s44, v115
  v_pk_add_f32 v[112:113], v[112:113], v[172:173]
  v_pk_add_f32 v[114:115], v[114:115], v[176:177]
  v_cvt_pk_bf16_f32 v78, v112, v113
  v_cvt_pk_bf16_f32 v79, v114, v115
  s_nop 0
  v_permlane16_swap_b32 v76, v78
  v_permlane16_swap_b32 v77, v79
  buffer_store_dwordx4 v[76:79], v10, s[16:19], 0 offen offset:0 sc1
  v_pk_fma_f32 v[172:173], v[52:53], v[36:37], s[44:45] op_sel_hi:[1,0,1]
  v_pk_fma_f32 v[176:177], v[54:55], v[36:37], s[44:45] op_sel_hi:[1,0,1]
  v_pk_fma_f32 v[104:105], v[104:105], v[30:31], v[172:173] op_sel_hi:[1,0,1]
  v_pk_fma_f32 v[106:107], v[106:107], v[30:31], v[176:177] op_sel_hi:[1,0,1]
  v_pk_fma_f32 v[172:173], v[104:105], s[42:43], v[24:25]
  v_pk_fma_f32 v[176:177], v[106:107], s[42:43], v[24:25]
  v_exp_f32 v172, v172 clamp
  v_exp_f32 v173, v173 clamp
  v_exp_f32 v176, v176 clamp
  v_exp_f32 v177, v177 clamp
  v_max_f32 v104, s44, v104
  v_max_f32 v105, s44, v105
  v_max_f32 v106, s44, v106
  v_max_f32 v107, s44, v107
  v_pk_add_f32 v[104:105], v[104:105], v[172:173]
  v_pk_add_f32 v[106:107], v[106:107], v[176:177]
  v_cvt_pk_bf16_f32 v80, v104, v105
  v_cvt_pk_bf16_f32 v81, v106, v107
  v_pk_fma_f32 v[172:173], v[56:57], v[36:37], s[44:45] op_sel_hi:[1,0,1]
  v_pk_fma_f32 v[176:177], v[58:59], v[36:37], s[44:45] op_sel_hi:[1,0,1]
  v_pk_fma_f32 v[116:117], v[116:117], v[30:31], v[172:173] op_sel_hi:[1,0,1]
  v_pk_fma_f32 v[118:119], v[118:119], v[30:31], v[176:177] op_sel_hi:[1,0,1]
  v_pk_fma_f32 v[172:173], v[116:117], s[42:43], v[24:25]
  v_pk_fma_f32 v[176:177], v[118:119], s[42:43], v[24:25]
  v_exp_f32 v172, v172 clamp
  v_exp_f32 v173, v173 clamp
  v_exp_f32 v176, v176 clamp
  v_exp_f32 v177, v177 clamp
  v_max_f32 v116, s44, v116
  v_max_f32 v117, s44, v117
  v_max_f32 v118, s44, v118
  v_max_f32 v119, s44, v119
  v_pk_add_f32 v[116:117], v[116:117], v[172:173]
  v_pk_add_f32 v[118:119], v[118:119], v[176:177]
  v_cvt_pk_bf16_f32 v82, v116, v117
  v_cvt_pk_bf16_f32 v83, v118, v119
  s_nop 0
  v_permlane16_swap_b32 v80, v82
  v_permlane16_swap_b32 v81, v83
  buffer_store_dwordx4 v[80:83], v11, s[16:19], 0 offen offset:0 sc1
  v_pk_fma_f32 v[172:173], v[52:53], v[38:39], s[44:45] op_sel_hi:[1,0,1]
  v_pk_fma_f32 v[176:177], v[54:55], v[38:39], s[44:45] op_sel_hi:[1,0,1]
  v_pk_fma_f32 v[108:109], v[108:109], v[32:33], v[172:173] op_sel_hi:[1,0,1]
  v_pk_fma_f32 v[110:111], v[110:111], v[32:33], v[176:177] op_sel_hi:[1,0,1]
  v_pk_fma_f32 v[172:173], v[108:109], s[42:43], v[24:25]
  v_pk_fma_f32 v[176:177], v[110:111], s[42:43], v[24:25]
  v_exp_f32 v172, v172 clamp
  v_exp_f32 v173, v173 clamp
  v_exp_f32 v176, v176 clamp
  v_exp_f32 v177, v177 clamp
  v_max_f32 v108, s44, v108
  v_max_f32 v109, s44, v109
  v_max_f32 v110, s44, v110
  v_max_f32 v111, s44, v111
  v_pk_add_f32 v[108:109], v[108:109], v[172:173]
  v_pk_add_f32 v[110:111], v[110:111], v[176:177]
  v_cvt_pk_bf16_f32 v84, v108, v109
  v_cvt_pk_bf16_f32 v85, v110, v111
  v_pk_fma_f32 v[172:173], v[56:57], v[38:39], s[44:45] op_sel_hi:[1,0,1]
  v_pk_fma_f32 v[176:177], v[58:59], v[38:39], s[44:45] op_sel_hi:[1,0,1]
  v_pk_fma_f32 v[120:121], v[120:121], v[32:33], v[172:173] op_sel_hi:[1,0,1]
  v_pk_fma_f32 v[122:123], v[122:123], v[32:33], v[176:177] op_sel_hi:[1,0,1]
  v_pk_fma_f32 v[172:173], v[120:121], s[42:43], v[24:25]
  v_pk_fma_f32 v[176:177], v[122:123], s[42:43], v[24:25]
  v_exp_f32 v172, v172 clamp
  v_exp_f32 v173, v173 clamp
  v_exp_f32 v176, v176 clamp
  v_exp_f32 v177, v177 clamp
  v_max_f32 v120, s44, v120
  v_max_f32 v121, s44, v121
  v_max_f32 v122, s44, v122
  v_max_f32 v123, s44, v123
  v_pk_add_f32 v[120:121], v[120:121], v[172:173]
  v_pk_add_f32 v[122:123], v[122:123], v[176:177]
  v_cvt_pk_bf16_f32 v86, v120, v121
  v_cvt_pk_bf16_f32 v87, v122, v123
  s_nop 0
  v_permlane16_swap_b32 v84, v86
  v_permlane16_swap_b32 v85, v87
  buffer_store_dwordx4 v[84:87], v17, s[16:19], 0 offen offset:0 sc1
  v_pk_fma_f32 v[172:173], v[60:61], v[34:35], s[44:45] op_sel_hi:[1,0,1]
  v_pk_fma_f32 v[176:177], v[62:63], v[34:35], s[44:45] op_sel_hi:[1,0,1]
  v_pk_fma_f32 v[124:125], v[124:125], v[28:29], v[172:173] op_sel_hi:[1,0,1]
  v_pk_fma_f32 v[126:127], v[126:127], v[28:29], v[176:177] op_sel_hi:[1,0,1]
  v_pk_fma_f32 v[172:173], v[124:125], s[42:43], v[24:25]
  v_pk_fma_f32 v[176:177], v[126:127], s[42:43], v[24:25]
  v_exp_f32 v172, v172 clamp
  v_exp_f32 v173, v173 clamp
  v_exp_f32 v176, v176 clamp
  v_exp_f32 v177, v177 clamp
  v_max_f32 v124, s44, v124
  v_max_f32 v125, s44, v125
  v_max_f32 v126, s44, v126
  v_max_f32 v127, s44, v127
  v_pk_add_f32 v[124:125], v[124:125], v[172:173]
  v_pk_add_f32 v[126:127], v[126:127], v[176:177]
  v_cvt_pk_bf16_f32 v88, v124, v125
  v_cvt_pk_bf16_f32 v89, v126, v127
  v_pk_fma_f32 v[172:173], v[64:65], v[34:35], s[44:45] op_sel_hi:[1,0,1]
  v_pk_fma_f32 v[176:177], v[66:67], v[34:35], s[44:45] op_sel_hi:[1,0,1]
  v_pk_fma_f32 v[136:137], v[136:137], v[28:29], v[172:173] op_sel_hi:[1,0,1]
  v_pk_fma_f32 v[138:139], v[138:139], v[28:29], v[176:177] op_sel_hi:[1,0,1]
  v_pk_fma_f32 v[172:173], v[136:137], s[42:43], v[24:25]
  v_pk_fma_f32 v[176:177], v[138:139], s[42:43], v[24:25]
  v_exp_f32 v172, v172 clamp
  v_exp_f32 v173, v173 clamp
  v_exp_f32 v176, v176 clamp
  v_exp_f32 v177, v177 clamp
  v_max_f32 v136, s44, v136
  v_max_f32 v137, s44, v137
  v_max_f32 v138, s44, v138
  v_max_f32 v139, s44, v139
  v_pk_add_f32 v[136:137], v[136:137], v[172:173]
  v_pk_add_f32 v[138:139], v[138:139], v[176:177]
  v_cvt_pk_bf16_f32 v90, v136, v137
  v_cvt_pk_bf16_f32 v91, v138, v139
  s_nop 0
  v_permlane16_swap_b32 v88, v90
  v_permlane16_swap_b32 v89, v91
  buffer_store_dwordx4 v[88:91], v10, s[16:19], 0 offen offset:64 sc1
  v_pk_fma_f32 v[172:173], v[60:61], v[36:37], s[44:45] op_sel_hi:[1,0,1]
  v_pk_fma_f32 v[176:177], v[62:63], v[36:37], s[44:45] op_sel_hi:[1,0,1]
  v_pk_fma_f32 v[128:129], v[128:129], v[30:31], v[172:173] op_sel_hi:[1,0,1]
  v_pk_fma_f32 v[130:131], v[130:131], v[30:31], v[176:177] op_sel_hi:[1,0,1]
  v_pk_fma_f32 v[172:173], v[128:129], s[42:43], v[24:25]
  v_pk_fma_f32 v[176:177], v[130:131], s[42:43], v[24:25]
  v_exp_f32 v172, v172 clamp
  v_exp_f32 v173, v173 clamp
  v_exp_f32 v176, v176 clamp
  v_exp_f32 v177, v177 clamp
  v_max_f32 v128, s44, v128
  v_max_f32 v129, s44, v129
  v_max_f32 v130, s44, v130
  v_max_f32 v131, s44, v131
  v_pk_add_f32 v[128:129], v[128:129], v[172:173]
  v_pk_add_f32 v[130:131], v[130:131], v[176:177]
  v_cvt_pk_bf16_f32 v76, v128, v129
  v_cvt_pk_bf16_f32 v77, v130, v131
  v_pk_fma_f32 v[172:173], v[64:65], v[36:37], s[44:45] op_sel_hi:[1,0,1]
  v_pk_fma_f32 v[176:177], v[66:67], v[36:37], s[44:45] op_sel_hi:[1,0,1]
  v_pk_fma_f32 v[140:141], v[140:141], v[30:31], v[172:173] op_sel_hi:[1,0,1]
  v_pk_fma_f32 v[142:143], v[142:143], v[30:31], v[176:177] op_sel_hi:[1,0,1]
  v_pk_fma_f32 v[172:173], v[140:141], s[42:43], v[24:25]
  v_pk_fma_f32 v[176:177], v[142:143], s[42:43], v[24:25]
  v_exp_f32 v172, v172 clamp
  v_exp_f32 v173, v173 clamp
  v_exp_f32 v176, v176 clamp
  v_exp_f32 v177, v177 clamp
  v_max_f32 v140, s44, v140
  v_max_f32 v141, s44, v141
  v_max_f32 v142, s44, v142
  v_max_f32 v143, s44, v143
  v_pk_add_f32 v[140:141], v[140:141], v[172:173]
  v_pk_add_f32 v[142:143], v[142:143], v[176:177]
  v_cvt_pk_bf16_f32 v78, v140, v141
  v_cvt_pk_bf16_f32 v79, v142, v143
  s_nop 0
  v_permlane16_swap_b32 v76, v78
  v_permlane16_swap_b32 v77, v79
  buffer_store_dwordx4 v[76:79], v11, s[16:19], 0 offen offset:64 sc1
  v_pk_fma_f32 v[172:173], v[60:61], v[38:39], s[44:45] op_sel_hi:[1,0,1]
  v_pk_fma_f32 v[176:177], v[62:63], v[38:39], s[44:45] op_sel_hi:[1,0,1]
  v_pk_fma_f32 v[132:133], v[132:133], v[32:33], v[172:173] op_sel_hi:[1,0,1]
  v_pk_fma_f32 v[134:135], v[134:135], v[32:33], v[176:177] op_sel_hi:[1,0,1]
  v_pk_fma_f32 v[172:173], v[132:133], s[42:43], v[24:25]
  v_pk_fma_f32 v[176:177], v[134:135], s[42:43], v[24:25]
  v_exp_f32 v172, v172 clamp
  v_exp_f32 v173, v173 clamp
  v_exp_f32 v176, v176 clamp
  v_exp_f32 v177, v177 clamp
  v_max_f32 v132, s44, v132
  v_max_f32 v133, s44, v133
  v_max_f32 v134, s44, v134
  v_max_f32 v135, s44, v135
  v_pk_add_f32 v[132:133], v[132:133], v[172:173]
  v_pk_add_f32 v[134:135], v[134:135], v[176:177]
  v_cvt_pk_bf16_f32 v80, v132, v133
  v_cvt_pk_bf16_f32 v81, v134, v135
  v_pk_fma_f32 v[172:173], v[64:65], v[38:39], s[44:45] op_sel_hi:[1,0,1]
  v_pk_fma_f32 v[176:177], v[66:67], v[38:39], s[44:45] op_sel_hi:[1,0,1]
  v_pk_fma_f32 v[144:145], v[144:145], v[32:33], v[172:173] op_sel_hi:[1,0,1]
  v_pk_fma_f32 v[146:147], v[146:147], v[32:33], v[176:177] op_sel_hi:[1,0,1]
  v_pk_fma_f32 v[172:173], v[144:145], s[42:43], v[24:25]
  v_pk_fma_f32 v[176:177], v[146:147], s[42:43], v[24:25]
  v_exp_f32 v172, v172 clamp
  v_exp_f32 v173, v173 clamp
  v_exp_f32 v176, v176 clamp
  v_exp_f32 v177, v177 clamp
  v_max_f32 v144, s44, v144
  v_max_f32 v145, s44, v145
  v_max_f32 v146, s44, v146
  v_max_f32 v147, s44, v147
  v_pk_add_f32 v[144:145], v[144:145], v[172:173]
  v_pk_add_f32 v[146:147], v[146:147], v[176:177]
  v_cvt_pk_bf16_f32 v82, v144, v145
  v_cvt_pk_bf16_f32 v83, v146, v147
  s_nop 0
  v_permlane16_swap_b32 v80, v82
  v_permlane16_swap_b32 v81, v83
  buffer_store_dwordx4 v[80:83], v17, s[16:19], 0 offen offset:64 sc1
  v_pk_fma_f32 v[172:173], v[68:69], v[34:35], s[44:45] op_sel_hi:[1,0,1]
  v_pk_fma_f32 v[176:177], v[70:71], v[34:35], s[44:45] op_sel_hi:[1,0,1]
  v_pk_fma_f32 v[148:149], v[148:149], v[28:29], v[172:173] op_sel_hi:[1,0,1]
  v_pk_fma_f32 v[150:151], v[150:151], v[28:29], v[176:177] op_sel_hi:[1,0,1]
  v_pk_fma_f32 v[172:173], v[148:149], s[42:43], v[24:25]
  v_pk_fma_f32 v[176:177], v[150:151], s[42:43], v[24:25]
  v_exp_f32 v172, v172 clamp
  v_exp_f32 v173, v173 clamp
  v_exp_f32 v176, v176 clamp
  v_exp_f32 v177, v177 clamp
  v_max_f32 v148, s44, v148
  v_max_f32 v149, s44, v149
  v_max_f32 v150, s44, v150
  v_max_f32 v151, s44, v151
  v_pk_add_f32 v[148:149], v[148:149], v[172:173]
  v_pk_add_f32 v[150:151], v[150:151], v[176:177]
  v_cvt_pk_bf16_f32 v84, v148, v149
  v_cvt_pk_bf16_f32 v85, v150, v151
  v_pk_fma_f32 v[172:173], v[72:73], v[34:35], s[44:45] op_sel_hi:[1,0,1]
  v_pk_fma_f32 v[176:177], v[74:75], v[34:35], s[44:45] op_sel_hi:[1,0,1]
  v_pk_fma_f32 v[160:161], v[160:161], v[28:29], v[172:173] op_sel_hi:[1,0,1]
  v_pk_fma_f32 v[162:163], v[162:163], v[28:29], v[176:177] op_sel_hi:[1,0,1]
  v_pk_fma_f32 v[172:173], v[160:161], s[42:43], v[24:25]
  v_pk_fma_f32 v[176:177], v[162:163], s[42:43], v[24:25]
  v_exp_f32 v172, v172 clamp
  v_exp_f32 v173, v173 clamp
  v_exp_f32 v176, v176 clamp
  v_exp_f32 v177, v177 clamp
  v_max_f32 v160, s44, v160
  v_max_f32 v161, s44, v161
  v_max_f32 v162, s44, v162
  v_max_f32 v163, s44, v163
  v_pk_add_f32 v[160:161], v[160:161], v[172:173]
  v_pk_add_f32 v[162:163], v[162:163], v[176:177]
  v_cvt_pk_bf16_f32 v86, v160, v161
  v_cvt_pk_bf16_f32 v87, v162, v163
  s_nop 0
  v_permlane16_swap_b32 v84, v86
  v_permlane16_swap_b32 v85, v87
  buffer_store_dwordx4 v[84:87], v10, s[16:19], 0 offen offset:128 sc1
  v_pk_fma_f32 v[172:173], v[68:69], v[36:37], s[44:45] op_sel_hi:[1,0,1]
  v_pk_fma_f32 v[176:177], v[70:71], v[36:37], s[44:45] op_sel_hi:[1,0,1]
  v_pk_fma_f32 v[152:153], v[152:153], v[30:31], v[172:173] op_sel_hi:[1,0,1]
  v_pk_fma_f32 v[154:155], v[154:155], v[30:31], v[176:177] op_sel_hi:[1,0,1]
  v_pk_fma_f32 v[172:173], v[152:153], s[42:43], v[24:25]
  v_pk_fma_f32 v[176:177], v[154:155], s[42:43], v[24:25]
  v_exp_f32 v172, v172 clamp
  v_exp_f32 v173, v173 clamp
  v_exp_f32 v176, v176 clamp
  v_exp_f32 v177, v177 clamp
  v_max_f32 v152, s44, v152
  v_max_f32 v153, s44, v153
  v_max_f32 v154, s44, v154
  v_max_f32 v155, s44, v155
  v_pk_add_f32 v[152:153], v[152:153], v[172:173]
  v_pk_add_f32 v[154:155], v[154:155], v[176:177]
  v_cvt_pk_bf16_f32 v88, v152, v153
  v_cvt_pk_bf16_f32 v89, v154, v155
  v_pk_fma_f32 v[172:173], v[72:73], v[36:37], s[44:45] op_sel_hi:[1,0,1]
  v_pk_fma_f32 v[176:177], v[74:75], v[36:37], s[44:45] op_sel_hi:[1,0,1]
  v_pk_fma_f32 v[164:165], v[164:165], v[30:31], v[172:173] op_sel_hi:[1,0,1]
  v_pk_fma_f32 v[166:167], v[166:167], v[30:31], v[176:177] op_sel_hi:[1,0,1]
  v_pk_fma_f32 v[172:173], v[164:165], s[42:43], v[24:25]
  v_pk_fma_f32 v[176:177], v[166:167], s[42:43], v[24:25]
  v_exp_f32 v172, v172 clamp
  v_exp_f32 v173, v173 clamp
  v_exp_f32 v176, v176 clamp
  v_exp_f32 v177, v177 clamp
  v_max_f32 v164, s44, v164
  v_max_f32 v165, s44, v165
  v_max_f32 v166, s44, v166
  v_max_f32 v167, s44, v167
  v_pk_add_f32 v[164:165], v[164:165], v[172:173]
  v_pk_add_f32 v[166:167], v[166:167], v[176:177]
  v_cvt_pk_bf16_f32 v90, v164, v165
  v_cvt_pk_bf16_f32 v91, v166, v167
  s_nop 0
  v_permlane16_swap_b32 v88, v90
  v_permlane16_swap_b32 v89, v91
  buffer_store_dwordx4 v[88:91], v11, s[16:19], 0 offen offset:128 sc1
  v_pk_fma_f32 v[172:173], v[68:69], v[38:39], s[44:45] op_sel_hi:[1,0,1]
  v_pk_fma_f32 v[176:177], v[70:71], v[38:39], s[44:45] op_sel_hi:[1,0,1]
  v_pk_fma_f32 v[156:157], v[156:157], v[32:33], v[172:173] op_sel_hi:[1,0,1]
  v_pk_fma_f32 v[158:159], v[158:159], v[32:33], v[176:177] op_sel_hi:[1,0,1]
  v_pk_fma_f32 v[172:173], v[156:157], s[42:43], v[24:25]
  v_pk_fma_f32 v[176:177], v[158:159], s[42:43], v[24:25]
  v_exp_f32 v172, v172 clamp
  v_exp_f32 v173, v173 clamp
  v_exp_f32 v176, v176 clamp
  v_exp_f32 v177, v177 clamp
  v_max_f32 v156, s44, v156
  v_max_f32 v157, s44, v157
  v_max_f32 v158, s44, v158
  v_max_f32 v159, s44, v159
  v_pk_add_f32 v[156:157], v[156:157], v[172:173]
  v_pk_add_f32 v[158:159], v[158:159], v[176:177]
  v_cvt_pk_bf16_f32 v76, v156, v157
  v_cvt_pk_bf16_f32 v77, v158, v159
  v_pk_fma_f32 v[172:173], v[72:73], v[38:39], s[44:45] op_sel_hi:[1,0,1]
  v_pk_fma_f32 v[176:177], v[74:75], v[38:39], s[44:45] op_sel_hi:[1,0,1]
  v_pk_fma_f32 v[168:169], v[168:169], v[32:33], v[172:173] op_sel_hi:[1,0,1]
  v_pk_fma_f32 v[170:171], v[170:171], v[32:33], v[176:177] op_sel_hi:[1,0,1]
  v_pk_fma_f32 v[172:173], v[168:169], s[42:43], v[24:25]
  v_pk_fma_f32 v[176:177], v[170:171], s[42:43], v[24:25]
  v_exp_f32 v172, v172 clamp
  v_exp_f32 v173, v173 clamp
  v_exp_f32 v176, v176 clamp
  v_exp_f32 v177, v177 clamp
  v_max_f32 v168, s44, v168
  v_max_f32 v169, s44, v169
  v_max_f32 v170, s44, v170
  v_max_f32 v171, s44, v171
  v_pk_add_f32 v[168:169], v[168:169], v[172:173]
  v_pk_add_f32 v[170:171], v[170:171], v[176:177]
  v_cvt_pk_bf16_f32 v78, v168, v169
  v_cvt_pk_bf16_f32 v79, v170, v171
  s_nop 0
  v_permlane16_swap_b32 v76, v78
  v_permlane16_swap_b32 v77, v79
  buffer_store_dwordx4 v[76:79], v17, s[16:19], 0 offen offset:128 sc1
  s_add_u32 s52, s84, 20463616
  s_addc_u32 s53, s85, 0
  s_mov_b32 s54, 45056
  s_mov_b32 s55, 0x20000
  s_and_b32 s56, s2, 15
  s_lshl_b32 s56, s56, 7
  v_mul_u32_u24 v2, 2048, v1
  v_mov_b32 v3, 1
  v_add_u32 v2, s56, v2
  s_add_u32 s56, s25, 328
  s_lshl_b32 s56, s56, 7
  v_mov_b32 v5, 162304
  v_writelane_b32 v2, s56, 8
  s_cmp_ge_u32 s26, 8
  s_cselect_b32 s57, 9, 8
  s_barrier
  s_mov_b64 exec, 1
  s_waitcnt vmcnt(0)
  ds_add_rtn_u32 v4, v5, v3
  s_waitcnt lgkmcnt(0)
  v_readfirstlane_b32 s56, v4
  s_bfm_b32 exec_lo, s57, 0
  s_cmp_lg_u32 s56, 3
  s_cbranch_scc1 L_nl_3116
  buffer_atomic_add v3, v2, s[52:55], 0 offen
L_nl_3116:
  s_mov_b64 exec, -1
  s_barrier
  s_barrier
  s_branch L_c1e_3115
L_c1d_3101:
  s_add_u32 s52, s84, 20463616
  s_addc_u32 s53, s85, 0
  s_mov_b32 s54, 45056
  s_mov_b32 s55, 0x20000
  s_and_b32 s56, s2, 15
  s_lshl_b32 s56, s56, 7
  v_mul_u32_u24 v2, 2048, v1
  v_mov_b32 v3, 1
  v_add_u32 v2, s56, v2
  s_add_u32 s56, s25, 328
  s_lshl_b32 s56, s56, 7
  v_mov_b32 v5, 162304
  v_writelane_b32 v2, s56, 8
  s_cmp_ge_u32 s26, 8
  s_cselect_b32 s57, 9, 8
  s_barrier
  s_mov_b64 exec, 1
  s_waitcnt vmcnt(0)
  ds_add_rtn_u32 v4, v5, v3
  s_waitcnt lgkmcnt(0)
  v_readfirstlane_b32 s56, v4
  s_bfm_b32 exec_lo, s57, 0
  s_cmp_lg_u32 s56, 3
  s_cbranch_scc1 L_nl_3117
  buffer_atomic_add v3, v2, s[52:55], 0 offen
L_nl_3117:
  s_mov_b64 exec, -1
  s_barrier
L_c1e_3115:
  s_cmp_ge_u32 s63, 24
  s_cbranch_scc1 L_c2i_3082
L_c2a_3080:
  s_mul_i32 s24, s62, 24
  s_add_u32 s24, s24, s63
  s_mul_i32 s25, s24, 21846
  s_lshr_b32 s25, s25, 16
  s_mul_i32 s37, s25, 3
  s_sub_u32 s26, s24, s37
  s_and_b32 s27, s3, 3
  v_lshrrev_b32 v6, 4, v1
  v_and_b32 v7, 15, v1
  v_lshrrev_b32 v2, 1, v7
  v_lshlrev_b32 v2, 4, v2
  v_lshl_add_u32 v5, v7, 7, v2
  s_mul_i32 s37, s27, 288
  s_add_u32 s37, s37, 3840
  v_lshl_add_u32 v4, v6, 3, s37
  s_movk_i32 s38, 127
  s_add_u32 s20, s84, 12386304
  s_addc_u32 s21, s85, 0
  s_mov_b32 s22, 51200
  s_mov_b32 s23, 0x20000
  s_mul_i32 s34, s27, 12288
  s_add_u32 s34, s34, 0
  v_lshl_add_u32 v25, v1, 4, s34
  v_and_b32 v2, 7, v7
  v_lshl_add_u32 v2, v6, 3, v2
  v_lshl_add_u32 v26, v2, 4, s34
  v_and_b32 v2, 1, v6
  v_cmp_eq_u32 vcc, 1, v2
  v_and_b32 v3, 3, v7
  v_add_u32 v3, 16, v3
  v_lshrrev_b32 v2, 1, v6
  v_cndmask_b32 v3, v7, v3, vcc
  v_mad_u32_u24 v2, v2, 20, v3
  v_lshl_add_u32 v27, v2, 3, s34
  s_movk_i32 s36, 3072
  v_add_u32 v2, 0, v4
  v_lshrrev_b32 v3, 7, v2
  v_bitop3_b32 v2, v2, s38, v5 bitop3:0x6a
  v_lshl_add_u32 v8, v3, 12, v2
  s_add_u32 s34, s37, 32
  v_mov_b32 v2, s34
  v_lshrrev_b32 v3, 7, v2
  v_bitop3_b32 v2, v2, s38, v5 bitop3:0x6a
  v_lshl_add_u32 v9, v3, 12, v2
  v_add_u32 v2, 40, v4
  v_lshrrev_b32 v3, 7, v2
  v_bitop3_b32 v2, v2, s38, v5 bitop3:0x6a
  v_lshl_add_u32 v10, v3, 12, v2
  v_add_u32 v2, 72, v4
  v_lshrrev_b32 v3, 7, v2
  v_bitop3_b32 v2, v2, s38, v5 bitop3:0x6a
  v_lshl_add_u32 v11, v3, 12, v2
  s_add_u32 s34, s37, 104
  v_mov_b32 v2, s34
  v_lshrrev_b32 v3, 7, v2
  v_bitop3_b32 v2, v2, s38, v5 bitop3:0x6a
  v_lshl_add_u32 v12, v3, 12, v2
  v_add_u32 v2, 112, v4
  v_lshrrev_b32 v3, 7, v2
  v_bitop3_b32 v2, v2, s38, v5 bitop3:0x6a
  v_lshl_add_u32 v13, v3, 12, v2
  s_mov_b32 s40, 0xffff
  s_mov_b32 s41, 0x0
  s_mov_b32 s42, 0xffff0000
  s_mov_b32 s43, 0x0
  s_mov_b32 s48, 0x0
  s_mov_b32 s49, 0xffff
  s_mov_b32 s50, 0x0
  s_mov_b32 s51, 0xffff0000
  s_mov_b32 s58, 0x358637bd
  v_lshlrev_b32 v2, 4, v6
  v_xor_b32 v14, v2, v5
  v_add_u32 v14, 122880, v14
  v_xor_b32 v15, 64, v14
  v_mul_u32_u24 v2, 3072, v6
  v_bfe_u32 v3, v1, 2, 2
  v_lshl_add_u32 v24, v3, 6, v2
  v_and_b32 v5, 1, v6
  v_lshlrev_b32 v5, 5, v5
  v_and_b32 v4, 3, v1
  s_mul_i32 s37, s27, 96
  v_lshl_add_u32 v4, v4, 3, s37
  s_movk_i32 s38, 63
  v_add_u32 v2, 0, v4
  v_lshrrev_b32 v3, 6, v2
  v_bitop3_b32 v2, v2, s38, v5 bitop3:0x6a
  v_lshl_add_u32 v2, v3, 8, v2
  v_add_u32 v16, v2, v24
  v_add_u32 v2, 32, v4
  v_lshrrev_b32 v3, 6, v2
  v_bitop3_b32 v2, v2, s38, v5 bitop3:0x6a
  v_lshl_add_u32 v2, v3, 8, v2
  v_add_u32 v17, v2, v24
  v_add_u32 v2, 64, v4
  v_lshrrev_b32 v3, 6, v2
  v_bitop3_b32 v2, v2, s38, v5 bitop3:0x6a
  v_lshl_add_u32 v2, v3, 8, v2
  v_add_u32 v18, v2, v24
  v_add_u32 v19, 73728, v16
  v_add_u32 v20, 73728, v17
  v_add_u32 v21, 73728, v18
  s_mul_i32 s37, s27, 6144
  s_add_u32 s37, s37, 98304
  v_lshl_add_u32 v24, v1, 4, s37
  v_and_b32 v2, 31, v1
  v_lshlrev_b32 v2, 3, v2
  s_lshl_b32 s37, s24, 8
  v_add_u32 v22, s37, v2
  v_lshrrev_b32 v3, 5, v1
  s_add_u32 s37, s26, 1
  v_add_u32 v3, s37, v3
  v_cmp_le_u32 vcc, 3, v3
  s_mul_i32 s37, s25, 768
  v_lshl_add_u32 v2, v3, 8, v2
  v_cndmask_b32 v3, 0, 3, vcc
  v_lshlrev_b32 v3, 8, v3
  v_sub_u32 v2, v2, v3
  v_add_u32 v23, s37, v2
  v_lshrrev_b32 v2, 3, v7
  v_lshlrev_b32 v2, 2, v2
  v_add_u32 v2, v2, v6
  v_bfe_u32 v3, v7, 2, 1
  v_lshl_add_u32 v2, v2, 1, v3
  s_lshl_b32 s37, s27, 8
  s_add_u32 s37, s37, 159744
  v_lshl_add_u32 v5, v2, 4, s37
  v_lshlrev_b32 v3, 3, v1
  v_add_u32 v7, 159744, v3
  s_add_u32 s8, s84, 12451840
  s_addc_u32 s9, s85, 0
  s_mov_b32 s10, 49152
  s_mov_b32 s11, 0x20000
  s_cmp_lg_u32 s3, 0
  s_cbranch_scc1 L_nw4_3118
  s_add_u32 s52, s84, 20463616
  s_addc_u32 s53, s85, 0
  s_mov_b32 s54, 45056
  s_mov_b32 s55, 0x20000
  s_lshl_b32 s56, s62, 11
  s_add_u32 s56, s56, 0
  v_lshl_add_u32 v2, v1, 7, s56
  v_mov_b32 v3, 16
  v_or_b32 v4, 4, v1
  v_cmp_eq_u32 vcc, 7, v4
  s_nop 1
  v_cndmask_b32 v3, 15, 16, vcc
  s_mov_b32 exec_lo, 0xffff
  s_mov_b32 exec_hi, 0
  s_mov_b32 s56, 0
L_poll_3119:
  buffer_load_dword v4, v2, s[52:55], 0 offen sc1
  s_add_u32 s56, s56, 1
  s_waitcnt vmcnt(0)
  v_cmp_ne_u32 vcc, v4, v3
  s_cmp_gt_u32 s56, 262144
  s_cbranch_scc1 L_got_3120
  s_cbranch_vccz L_got_3120
  s_sleep 1
  s_branch L_poll_3119
L_got_3120:
  s_mov_b64 exec, -1
L_nw4_3118:
  s_barrier
  buffer_load_dwordx2 v[220:221], v27, s[20:23], 0 offen offset:2560 sc1
  buffer_load_dwordx4 v[208:211], v26, s[20:23], 0 offen offset:2048 sc1
  buffer_load_dwordx4 v[204:207], v25, s[20:23], 0 offen offset:0 sc1
  buffer_load_dwordx4 v[212:215], v25, s[20:23], 0 offen offset:1024 sc1
  buffer_load_dwordx2 v[240:241], v27, s[20:23], s36 offen offset:2560 sc1
  buffer_load_dwordx4 v[228:231], v26, s[20:23], s36 offen offset:2048 sc1
  buffer_load_dwordx4 v[224:227], v25, s[20:23], s36 offen offset:0 sc1
  buffer_load_dwordx4 v[232:235], v25, s[20:23], s36 offen offset:1024 sc1
  v_mov_b32 v151, 0
  v_mov_b32 v155, 0
  v_mov_b32 v156, 0
  v_mov_b32 v160, 0
  v_mov_b32 v167, 0
  v_mov_b32 v171, 0
  v_mov_b32 v172, 0
  v_mov_b32 v176, 0
  s_barrier
  ds_read_b64 v[180:181], v8 offset:0
  ds_read_b64 v[182:183], v9 offset:0
  ds_read_b64 v[184:185], v10 offset:0
  ds_read_b64 v[186:187], v8 offset:2048
  ds_read_b64 v[188:189], v9 offset:2048
  ds_read_b64 v[190:191], v10 offset:2048
  ds_read_b64 v[192:193], v11 offset:0
  ds_read_b64 v[194:195], v12 offset:0
  ds_read_b64 v[196:197], v13 offset:0
  ds_read_b64 v[198:199], v11 offset:2048
  ds_read_b64 v[200:201], v12 offset:2048
  ds_read_b64 v[202:203], v13 offset:2048
  ds_read_b64_tr_b16 v[60:61], v19 offset:24576
  ds_read_b64_tr_b16 v[62:63], v19 offset:26112
  ds_read_b64_tr_b16 v[64:65], v20 offset:24576
  ds_read_b64_tr_b16 v[66:67], v20 offset:26112
  ds_read_b64_tr_b16 v[68:69], v21 offset:24576
  ds_read_b64_tr_b16 v[70:71], v21 offset:26112
  ds_read_b64_tr_b16 v[80:81], v19 offset:36864
  ds_read_b64_tr_b16 v[82:83], v19 offset:38400
  ds_read_b64_tr_b16 v[84:85], v20 offset:36864
  ds_read_b64_tr_b16 v[86:87], v20 offset:38400
  ds_read_b64_tr_b16 v[88:89], v21 offset:36864
  ds_read_b64_tr_b16 v[90:91], v21 offset:38400
  s_waitcnt vmcnt(4)
  v_cvt_pk_bf16_f32 v220, v220, v221
  v_cvt_pk_bf16_f32 v152, v208, v209
  v_cvt_pk_bf16_f32 v153, v210, v211
  v_cvt_pk_bf16_f32 v162, v208, v209
  v_cvt_pk_bf16_f32 v163, v210, v211
  v_cndmask_b32 v150, 0, v220, s[40:41]
  v_cndmask_b32 v154, 0, v220, s[42:43]
  v_cndmask_b32 v157, 0, v220, s[48:49]
  v_cndmask_b32 v161, 0, v220, s[50:51]
  v_mov_b32_dpp v152, v152 row_shr:4 row_mask:0xf bank_mask:0xa
  v_mov_b32_dpp v153, v153 row_shr:4 row_mask:0xf bank_mask:0xa
  v_mov_b32_dpp v162, v162 row_shl:4 row_mask:0xf bank_mask:0x5
  v_mov_b32_dpp v163, v163 row_shl:4 row_mask:0xf bank_mask:0x5
  v_cvt_pk_bf16_f32 v148, v204, v205
  v_cvt_pk_bf16_f32 v149, v206, v207
  v_cvt_pk_bf16_f32 v158, v212, v213
  v_cvt_pk_bf16_f32 v159, v214, v215
  s_waitcnt vmcnt(0)
  v_cvt_pk_bf16_f32 v240, v240, v241
  v_cvt_pk_bf16_f32 v168, v228, v229
  v_cvt_pk_bf16_f32 v169, v230, v231
  v_cvt_pk_bf16_f32 v178, v228, v229
  v_cvt_pk_bf16_f32 v179, v230, v231
  v_cndmask_b32 v166, 0, v240, s[40:41]
  v_cndmask_b32 v170, 0, v240, s[42:43]
  v_cndmask_b32 v173, 0, v240, s[48:49]
  v_cndmask_b32 v177, 0, v240, s[50:51]
  v_mov_b32_dpp v168, v168 row_shr:4 row_mask:0xf bank_mask:0xa
  v_mov_b32_dpp v169, v169 row_shr:4 row_mask:0xf bank_mask:0xa
  v_mov_b32_dpp v178, v178 row_shl:4 row_mask:0xf bank_mask:0x5
  v_mov_b32_dpp v179, v179 row_shl:4 row_mask:0xf bank_mask:0x5
  v_cvt_pk_bf16_f32 v164, v224, v225
  v_cvt_pk_bf16_f32 v165, v226, v227
  v_cvt_pk_bf16_f32 v174, v232, v233
  v_cvt_pk_bf16_f32 v175, v234, v235
  s_waitcnt lgkmcnt(0)
  v_mfma_f32_16x16x32_bf16 v[204:207], v[148:151], v[180:183], 0
  v_mfma_f32_16x16x32_bf16 v[208:211], v[152:155], v[180:183], 0
  v_mfma_f32_16x16x32_bf16 v[212:215], v[156:159], v[182:185], 0
  v_mfma_f32_16x16x32_bf16 v[216:219], v[160:163], v[182:185], 0
  v_mfma_f32_16x16x32_bf16 v[220:223], v[148:151], v[186:189], 0
  v_mfma_f32_16x16x32_bf16 v[224:227], v[152:155], v[186:189], 0
  v_mfma_f32_16x16x32_bf16 v[228:231], v[156:159], v[188:191], 0
  v_mfma_f32_16x16x32_bf16 v[232:235], v[160:163], v[188:191], 0
  v_mfma_f32_16x16x32_bf16 v[236:239], v[164:167], v[192:195], 0
  v_mfma_f32_16x16x32_bf16 v[240:243], v[168:171], v[192:195], 0
  v_mfma_f32_16x16x32_bf16 v[244:247], v[172:175], v[194:197], 0
  v_mfma_f32_16x16x32_bf16 v[248:251], v[176:179], v[194:197], 0
  v_add_f32 v210, s58, v210
  v_add_f32 v218, s58, v218
  v_rcp_f32 v210, v210
  v_rcp_f32 v218, v218
  v_pk_mul_f32 v[204:205], v[204:205], v[210:211] op_sel_hi:[1,0]
  v_pk_mul_f32 v[206:207], v[206:207], v[210:211] op_sel_hi:[1,0]
  v_pk_mul_f32 v[208:209], v[208:209], v[210:211] op_sel_hi:[1,0]
  v_pk_mul_f32 v[212:213], v[212:213], v[218:219] op_sel_hi:[1,0]
  v_pk_mul_f32 v[214:215], v[214:215], v[218:219] op_sel_hi:[1,0]
  v_pk_mul_f32 v[216:217], v[216:217], v[218:219] op_sel_hi:[1,0]
  v_cvt_pk_bf16_f32 v180, v204, v205
  v_cvt_pk_bf16_f32 v181, v206, v207
  v_cvt_pk_bf16_f32 v182, v208, v209
  v_cvt_pk_bf16_f32 v183, v216, v217
  v_cvt_pk_bf16_f32 v184, v212, v213
  v_cvt_pk_bf16_f32 v185, v214, v215
  v_mfma_f32_16x16x32_bf16 v[204:207], v[164:167], v[198:201], 0
  v_mfma_f32_16x16x32_bf16 v[208:211], v[168:171], v[198:201], 0
  v_mfma_f32_16x16x32_bf16 v[212:215], v[172:175], v[200:203], 0
  v_mfma_f32_16x16x32_bf16 v[216:219], v[176:179], v[200:203], 0
  ds_write_b64 v8, v[180:181] offset:0
  ds_write_b64 v9, v[182:183] offset:0
  ds_write_b64 v10, v[184:185] offset:0
  v_add_f32 v226, s58, v226
  v_add_f32 v234, s58, v234
  v_rcp_f32 v226, v226
  v_rcp_f32 v234, v234
  v_pk_mul_f32 v[220:221], v[220:221], v[226:227] op_sel_hi:[1,0]
  v_pk_mul_f32 v[222:223], v[222:223], v[226:227] op_sel_hi:[1,0]
  v_pk_mul_f32 v[224:225], v[224:225], v[226:227] op_sel_hi:[1,0]
  v_pk_mul_f32 v[228:229], v[228:229], v[234:235] op_sel_hi:[1,0]
  v_pk_mul_f32 v[230:231], v[230:231], v[234:235] op_sel_hi:[1,0]
  v_pk_mul_f32 v[232:233], v[232:233], v[234:235] op_sel_hi:[1,0]
  v_cvt_pk_bf16_f32 v186, v220, v221
  v_cvt_pk_bf16_f32 v187, v222, v223
  v_cvt_pk_bf16_f32 v188, v224, v225
  v_cvt_pk_bf16_f32 v189, v232, v233
  v_cvt_pk_bf16_f32 v190, v228, v229
  v_cvt_pk_bf16_f32 v191, v230, v231
  ds_write_b64 v8, v[186:187] offset:2048
  ds_write_b64 v9, v[188:189] offset:2048
  ds_write_b64 v10, v[190:191] offset:2048
  v_add_f32 v242, s58, v242
  v_add_f32 v250, s58, v250
  v_rcp_f32 v242, v242
  v_rcp_f32 v250, v250
  v_pk_mul_f32 v[236:237], v[236:237], v[242:243] op_sel_hi:[1,0]
  v_pk_mul_f32 v[238:239], v[238:239], v[242:243] op_sel_hi:[1,0]
  v_pk_mul_f32 v[240:241], v[240:241], v[242:243] op_sel_hi:[1,0]
  v_pk_mul_f32 v[244:245], v[244:245], v[250:251] op_sel_hi:[1,0]
  v_pk_mul_f32 v[246:247], v[246:247], v[250:251] op_sel_hi:[1,0]
  v_pk_mul_f32 v[248:249], v[248:249], v[250:251] op_sel_hi:[1,0]
  v_cvt_pk_bf16_f32 v192, v236, v237
  v_cvt_pk_bf16_f32 v193, v238, v239
  v_cvt_pk_bf16_f32 v194, v240, v241
  v_cvt_pk_bf16_f32 v195, v248, v249
  v_cvt_pk_bf16_f32 v196, v244, v245
  v_cvt_pk_bf16_f32 v197, v246, v247
  ds_write_b64 v11, v[192:193] offset:0
  ds_write_b64 v12, v[194:195] offset:0
  ds_write_b64 v13, v[196:197] offset:0
  v_add_f32 v210, s58, v210
  v_add_f32 v218, s58, v218
  v_rcp_f32 v210, v210
  v_rcp_f32 v218, v218
  v_pk_mul_f32 v[204:205], v[204:205], v[210:211] op_sel_hi:[1,0]
  v_pk_mul_f32 v[206:207], v[206:207], v[210:211] op_sel_hi:[1,0]
  v_pk_mul_f32 v[208:209], v[208:209], v[210:211] op_sel_hi:[1,0]
  v_pk_mul_f32 v[212:213], v[212:213], v[218:219] op_sel_hi:[1,0]
  v_pk_mul_f32 v[214:215], v[214:215], v[218:219] op_sel_hi:[1,0]
  v_pk_mul_f32 v[216:217], v[216:217], v[218:219] op_sel_hi:[1,0]
  v_cvt_pk_bf16_f32 v198, v204, v205
  v_cvt_pk_bf16_f32 v199, v206, v207
  v_cvt_pk_bf16_f32 v200, v208, v209
  v_cvt_pk_bf16_f32 v201, v216, v217
  v_cvt_pk_bf16_f32 v202, v212, v213
  v_cvt_pk_bf16_f32 v203, v214, v215
  ds_write_b64 v11, v[198:199] offset:2048
  ds_write_b64 v12, v[200:201] offset:2048
  ds_write_b64 v13, v[202:203] offset:2048
  s_waitcnt lgkmcnt(0)
  s_barrier
  ds_read_b128 v[52:55], v14 offset:16384
  ds_read_b128 v[56:59], v14 offset:18432
  ds_read_b128 v[72:75], v15 offset:16384
  ds_read_b128 v[76:79], v15 offset:18432
  ds_read_b64_tr_b16 v[100:101], v16 offset:0
  ds_read_b64_tr_b16 v[102:103], v16 offset:1536
  ds_read_b128 v[92:95], v14 offset:20480
  ds_read_b128 v[96:99], v14 offset:22528
  ds_read_b64_tr_b16 v[104:105], v17 offset:0
  ds_read_b64_tr_b16 v[106:107], v17 offset:1536
  ds_read_b64_tr_b16 v[108:109], v18 offset:0
  ds_read_b64_tr_b16 v[110:111], v18 offset:1536
  ds_read_b64_tr_b16 v[120:121], v16 offset:12288
  ds_read_b64_tr_b16 v[122:123], v16 offset:13824
  ds_read_b128 v[112:115], v15 offset:20480
  ds_read_b128 v[116:119], v15 offset:22528
  ds_read_b64_tr_b16 v[124:125], v17 offset:12288
  ds_read_b64_tr_b16 v[126:127], v17 offset:13824
  ds_read_b64_tr_b16 v[128:129], v18 offset:12288
  ds_read_b64_tr_b16 v[130:131], v18 offset:13824
  s_waitcnt lgkmcnt(15)
  v_mfma_f32_16x16x32_bf16 v[28:31], v[52:55], v[60:63], 0
  ds_read_b64_tr_b16 v[140:141], v16 offset:24576
  ds_read_b64_tr_b16 v[142:143], v16 offset:26112
  v_mfma_f32_16x16x32_bf16 v[32:35], v[56:59], v[60:63], 0
  ds_read_b128 v[132:135], v14 offset:24576
  ds_read_b128 v[136:139], v14 offset:26624
  v_mfma_f32_16x16x32_bf16 v[36:39], v[52:55], v[64:67], 0
  ds_read_b64_tr_b16 v[144:145], v17 offset:24576
  ds_read_b64_tr_b16 v[146:147], v17 offset:26112
  v_mfma_f32_16x16x32_bf16 v[40:43], v[56:59], v[64:67], 0
  ds_read_b64_tr_b16 v[148:149], v18 offset:24576
  ds_read_b64_tr_b16 v[150:151], v18 offset:26112
  v_mfma_f32_16x16x32_bf16 v[44:47], v[52:55], v[68:71], 0
  ds_read_b64_tr_b16 v[160:161], v16 offset:36864
  ds_read_b64_tr_b16 v[162:163], v16 offset:38400
  v_mfma_f32_16x16x32_bf16 v[48:51], v[56:59], v[68:71], 0
  ds_read_b128 v[152:155], v15 offset:24576
  ds_read_b128 v[156:159], v15 offset:26624
  v_mfma_f32_16x16x32_bf16 v[28:31], v[72:75], v[80:83], v[28:31]
  ds_read_b64_tr_b16 v[164:165], v17 offset:36864
  ds_read_b64_tr_b16 v[166:167], v17 offset:38400
  v_mfma_f32_16x16x32_bf16 v[32:35], v[76:79], v[80:83], v[32:35]
  ds_read_b64_tr_b16 v[168:169], v18 offset:36864
  ds_read_b64_tr_b16 v[170:171], v18 offset:38400
  v_mfma_f32_16x16x32_bf16 v[36:39], v[72:75], v[84:87], v[36:39]
  v_mfma_f32_16x16x32_bf16 v[40:43], v[76:79], v[84:87], v[40:43]
  v_mfma_f32_16x16x32_bf16 v[44:47], v[72:75], v[88:91], v[44:47]
  v_mfma_f32_16x16x32_bf16 v[48:51], v[76:79], v[88:91], v[48:51]
  s_waitcnt lgkmcnt(15)
  v_mfma_f32_16x16x32_bf16 v[28:31], v[92:95], v[100:103], v[28:31]
  v_mfma_f32_16x16x32_bf16 v[32:35], v[96:99], v[100:103], v[32:35]
  v_mfma_f32_16x16x32_bf16 v[36:39], v[92:95], v[104:107], v[36:39]
  v_mfma_f32_16x16x32_bf16 v[40:43], v[96:99], v[104:107], v[40:43]
  v_mfma_f32_16x16x32_bf16 v[44:47], v[92:95], v[108:111], v[44:47]
  v_mfma_f32_16x16x32_bf16 v[48:51], v[96:99], v[108:111], v[48:51]
  v_mfma_f32_16x16x32_bf16 v[28:31], v[112:115], v[120:123], v[28:31]
  v_mfma_f32_16x16x32_bf16 v[32:35], v[116:119], v[120:123], v[32:35]
  v_mfma_f32_16x16x32_bf16 v[36:39], v[112:115], v[124:127], v[36:39]
  v_mfma_f32_16x16x32_bf16 v[40:43], v[116:119], v[124:127], v[40:43]
  v_mfma_f32_16x16x32_bf16 v[44:47], v[112:115], v[128:131], v[44:47]
  v_mfma_f32_16x16x32_bf16 v[48:51], v[116:119], v[128:131], v[48:51]
  s_waitcnt lgkmcnt(0)
  s_barrier
  v_mfma_f32_16x16x32_bf16 v[28:31], v[132:135], v[140:143], v[28:31]
  ds_read_b64_tr_b16 v[180:181], v16 offset:49152
  ds_read_b64_tr_b16 v[182:183], v16 offset:50688
  ds_read_b128 v[172:175], v14 offset:28672
  v_mfma_f32_16x16x32_bf16 v[32:35], v[136:139], v[140:143], v[32:35]
  ds_read_b128 v[176:179], v14 offset:30720
  ds_read_b64_tr_b16 v[184:185], v17 offset:49152
  ds_read_b64_tr_b16 v[186:187], v17 offset:50688
  v_mfma_f32_16x16x32_bf16 v[36:39], v[132:135], v[144:147], v[36:39]
  ds_read_b64_tr_b16 v[188:189], v18 offset:49152
  ds_read_b64_tr_b16 v[190:191], v18 offset:50688
  ds_read_b64_tr_b16 v[200:201], v16 offset:61440
  v_mfma_f32_16x16x32_bf16 v[40:43], v[136:139], v[144:147], v[40:43]
  ds_read_b64_tr_b16 v[202:203], v16 offset:62976
  ds_read_b128 v[192:195], v15 offset:28672
  ds_read_b128 v[196:199], v15 offset:30720
  v_mfma_f32_16x16x32_bf16 v[44:47], v[132:135], v[148:151], v[44:47]
  ds_read_b64_tr_b16 v[204:205], v17 offset:61440
  ds_read_b64_tr_b16 v[206:207], v17 offset:62976
  ds_read_b64_tr_b16 v[208:209], v18 offset:61440
  v_mfma_f32_16x16x32_bf16 v[48:51], v[136:139], v[148:151], v[48:51]
  ds_read_b64_tr_b16 v[210:211], v18 offset:62976
  ds_read_b64_tr_b16 v[220:221], v19 offset:0
  ds_read_b64_tr_b16 v[222:223], v19 offset:1536
  v_mfma_f32_16x16x32_bf16 v[28:31], v[152:155], v[160:163], v[28:31]
  ds_read_b128 v[212:215], v14 offset:32768
  ds_read_b128 v[216:219], v14 offset:34816
  ds_read_b64_tr_b16 v[224:225], v20 offset:0
  v_mfma_f32_16x16x32_bf16 v[32:35], v[156:159], v[160:163], v[32:35]
  ds_read_b64_tr_b16 v[226:227], v20 offset:1536
  ds_read_b64_tr_b16 v[228:229], v21 offset:0
  ds_read_b64_tr_b16 v[230:231], v21 offset:1536
  v_mfma_f32_16x16x32_bf16 v[36:39], v[152:155], v[164:167], v[36:39]
  ds_read_b64_tr_b16 v[240:241], v19 offset:12288
  ds_read_b64_tr_b16 v[242:243], v19 offset:13824
  ds_read_b128 v[232:235], v15 offset:32768
  v_mfma_f32_16x16x32_bf16 v[40:43], v[156:159], v[164:167], v[40:43]
  ds_read_b128 v[236:239], v15 offset:34816
  ds_read_b64_tr_b16 v[244:245], v20 offset:12288
  ds_read_b64_tr_b16 v[246:247], v20 offset:13824
  v_mfma_f32_16x16x32_bf16 v[44:47], v[152:155], v[168:171], v[44:47]
  ds_read_b64_tr_b16 v[248:249], v21 offset:12288
  ds_read_b64_tr_b16 v[250:251], v21 offset:13824
  v_mfma_f32_16x16x32_bf16 v[48:51], v[156:159], v[168:171], v[48:51]
  s_waitcnt lgkmcnt(15)
  v_mfma_f32_16x16x32_bf16 v[28:31], v[172:175], v[180:183], v[28:31]
  ds_read_b128 v[52:55], v24 offset:0
  v_mfma_f32_16x16x32_bf16 v[32:35], v[176:179], v[180:183], v[32:35]
  ds_read_b128 v[56:59], v24 offset:1024
  v_mfma_f32_16x16x32_bf16 v[36:39], v[172:175], v[184:187], v[36:39]
  ds_read_b128 v[60:63], v24 offset:2048
  v_mfma_f32_16x16x32_bf16 v[40:43], v[176:179], v[184:187], v[40:43]
  ds_read_b128 v[64:67], v24 offset:3072
  v_mfma_f32_16x16x32_bf16 v[44:47], v[172:175], v[188:191], v[44:47]
  ds_read_b128 v[68:71], v24 offset:4096
  v_mfma_f32_16x16x32_bf16 v[48:51], v[176:179], v[188:191], v[48:51]
  ds_read_b128 v[72:75], v24 offset:5120
  v_mfma_f32_16x16x32_bf16 v[28:31], v[192:195], v[200:203], v[28:31]
  v_mfma_f32_16x16x32_bf16 v[32:35], v[196:199], v[200:203], v[32:35]
  v_mfma_f32_16x16x32_bf16 v[36:39], v[192:195], v[204:207], v[36:39]
  v_mfma_f32_16x16x32_bf16 v[40:43], v[196:199], v[204:207], v[40:43]
  v_mfma_f32_16x16x32_bf16 v[44:47], v[192:195], v[208:211], v[44:47]
  v_mfma_f32_16x16x32_bf16 v[48:51], v[196:199], v[208:211], v[48:51]
  s_waitcnt lgkmcnt(6)
  v_mfma_f32_16x16x32_bf16 v[28:31], v[212:215], v[220:223], v[28:31]
  v_mfma_f32_16x16x32_bf16 v[32:35], v[216:219], v[220:223], v[32:35]
  v_mfma_f32_16x16x32_bf16 v[36:39], v[212:215], v[224:227], v[36:39]
  v_mfma_f32_16x16x32_bf16 v[40:43], v[216:219], v[224:227], v[40:43]
  v_mfma_f32_16x16x32_bf16 v[44:47], v[212:215], v[228:231], v[44:47]
  v_mfma_f32_16x16x32_bf16 v[48:51], v[216:219], v[228:231], v[48:51]
  v_mfma_f32_16x16x32_bf16 v[28:31], v[232:235], v[240:243], v[28:31]
  v_mfma_f32_16x16x32_bf16 v[32:35], v[236:239], v[240:243], v[32:35]
  v_mfma_f32_16x16x32_bf16 v[36:39], v[232:235], v[244:247], v[36:39]
  v_mfma_f32_16x16x32_bf16 v[40:43], v[236:239], v[244:247], v[40:43]
  v_mfma_f32_16x16x32_bf16 v[44:47], v[232:235], v[248:251], v[44:47]
  v_mfma_f32_16x16x32_bf16 v[48:51], v[236:239], v[248:251], v[48:51]
  s_waitcnt lgkmcnt(0)
  s_nop 1
  v_pk_add_f32 v[28:29], v[28:29], v[52:53]
  v_pk_add_f32 v[30:31], v[30:31], v[54:55]
  v_pk_add_f32 v[32:33], v[32:33], v[56:57]
  v_pk_add_f32 v[34:35], v[34:35], v[58:59]
  v_pk_add_f32 v[36:37], v[36:37], v[60:61]
  v_pk_add_f32 v[38:39], v[38:39], v[62:63]
  v_pk_add_f32 v[40:41], v[40:41], v[64:65]
  v_pk_add_f32 v[42:43], v[42:43], v[66:67]
  v_pk_add_f32 v[44:45], v[44:45], v[68:69]
  v_pk_add_f32 v[46:47], v[46:47], v[70:71]
  v_pk_add_f32 v[48:49], v[48:49], v[72:73]
  v_pk_add_f32 v[50:51], v[50:51], v[74:75]
  v_pk_add_f32 v[92:93], v[28:29], v[36:37]
  v_pk_mul_f32 v[100:101], v[28:29], v[28:29]
  v_pk_add_f32 v[92:93], v[92:93], v[44:45]
  v_pk_fma_f32 v[100:101], v[36:37], v[36:37], v[100:101]
  v_pk_fma_f32 v[100:101], v[44:45], v[44:45], v[100:101]
  v_pk_add_f32 v[94:95], v[30:31], v[38:39]
  v_pk_mul_f32 v[102:103], v[30:31], v[30:31]
  v_pk_add_f32 v[94:95], v[94:95], v[46:47]
  v_pk_fma_f32 v[102:103], v[38:39], v[38:39], v[102:103]
  v_pk_fma_f32 v[102:103], v[46:47], v[46:47], v[102:103]
  v_pk_add_f32 v[96:97], v[32:33], v[40:41]
  v_pk_mul_f32 v[104:105], v[32:33], v[32:33]
  v_pk_add_f32 v[96:97], v[96:97], v[48:49]
  v_pk_fma_f32 v[104:105], v[40:41], v[40:41], v[104:105]
  v_pk_fma_f32 v[104:105], v[48:49], v[48:49], v[104:105]
  v_pk_add_f32 v[98:99], v[34:35], v[42:43]
  v_pk_mul_f32 v[106:107], v[34:35], v[34:35]
  v_pk_add_f32 v[98:99], v[98:99], v[50:51]
  v_pk_fma_f32 v[106:107], v[42:43], v[42:43], v[106:107]
  v_pk_fma_f32 v[106:107], v[50:51], v[50:51], v[106:107]
  v_add_f32_dpp v108, v92, v92 row_ror:8 row_mask:0xf bank_mask:0x3
  v_add_f32_dpp v109, v93, v93 row_ror:8 row_mask:0xf bank_mask:0x3
  v_add_f32_dpp v110, v94, v94 row_ror:8 row_mask:0xf bank_mask:0x3
  v_add_f32_dpp v111, v95, v95 row_ror:8 row_mask:0xf bank_mask:0x3
  v_add_f32_dpp v112, v100, v100 row_ror:8 row_mask:0xf bank_mask:0x3
  v_add_f32_dpp v113, v101, v101 row_ror:8 row_mask:0xf bank_mask:0x3
  v_add_f32_dpp v114, v102, v102 row_ror:8 row_mask:0xf bank_mask:0x3
  v_add_f32_dpp v115, v103, v103 row_ror:8 row_mask:0xf bank_mask:0x3
  v_add_f32_dpp v108, v96, v96 row_ror:8 row_mask:0xf bank_mask:0xc
  v_add_f32_dpp v109, v97, v97 row_ror:8 row_mask:0xf bank_mask:0xc
  v_add_f32_dpp v110, v98, v98 row_ror:8 row_mask:0xf bank_mask:0xc
  v_add_f32_dpp v111, v99, v99 row_ror:8 row_mask:0xf bank_mask:0xc
  v_add_f32_dpp v112, v104, v104 row_ror:8 row_mask:0xf bank_mask:0xc
  v_add_f32_dpp v113, v105, v105 row_ror:8 row_mask:0xf bank_mask:0xc
  v_add_f32_dpp v114, v106, v106 row_ror:8 row_mask:0xf bank_mask:0xc
  v_add_f32_dpp v115, v107, v107 row_ror:8 row_mask:0xf bank_mask:0xc
  v_add_f32_dpp v116, v108, v108 row_half_mirror row_mask:0xf bank_mask:0x5
  v_add_f32_dpp v117, v112, v112 row_half_mirror row_mask:0xf bank_mask:0x5
  v_add_f32_dpp v118, v109, v109 row_half_mirror row_mask:0xf bank_mask:0x5
  v_add_f32_dpp v119, v113, v113 row_half_mirror row_mask:0xf bank_mask:0x5
  v_add_f32_dpp v116, v110, v110 row_half_mirror row_mask:0xf bank_mask:0xa
  v_add_f32_dpp v117, v114, v114 row_half_mirror row_mask:0xf bank_mask:0xa
  v_add_f32_dpp v118, v111, v111 row_half_mirror row_mask:0xf bank_mask:0xa
  v_add_f32_dpp v119, v115, v115 row_half_mirror row_mask:0xf bank_mask:0xa
  v_add_f32_dpp v116, v116, v116 quad_perm:[1,0,3,2] row_mask:0xf bank_mask:0xf
  v_add_f32_dpp v117, v117, v117 quad_perm:[1,0,3,2] row_mask:0xf bank_mask:0xf
  v_add_f32_dpp v118, v118, v118 quad_perm:[1,0,3,2] row_mask:0xf bank_mask:0xf
  v_add_f32_dpp v119, v119, v119 quad_perm:[1,0,3,2] row_mask:0xf bank_mask:0xf
  v_add_f32_dpp v116, v116, v116 quad_perm:[2,3,0,1] row_mask:0xf bank_mask:0xf
  v_add_f32_dpp v117, v117, v117 quad_perm:[2,3,0,1] row_mask:0xf bank_mask:0xf
  v_add_f32_dpp v118, v118, v118 quad_perm:[2,3,0,1] row_mask:0xf bank_mask:0xf
  v_add_f32_dpp v119, v119, v119 quad_perm:[2,3,0,1] row_mask:0xf bank_mask:0xf
  ds_write_b128 v5, v[116:119]
  s_waitcnt lgkmcnt(0)
  s_barrier
  ds_read_b64 v[124:125], v7
  ds_read_b64 v[126:127], v7 offset:512
  s_mov_b32 s34, 0
  s_waitcnt lgkmcnt(0)
  v_pk_add_f32 v[124:125], v[124:125], v[126:127]
  v_mov_b32 v126, v124
  v_mov_b32 v127, v125
  s_cmp_lg_u32 s27, 0
  v_permlane32_swap_b32 v124, v126
  v_permlane32_swap_b32 v125, v127
  v_pk_add_f32 v[124:125], v[124:125], v[126:127]
  s_cbranch_scc1 L_nst_3123
  s_mov_b32 exec_hi, 0
  buffer_store_dwordx2 v[124:125], v22, s[8:11], 0 offen sc1
  s_mov_b32 exec_hi, -1
L_nst_3123:
  s_mul_i32 s37, s26, 12
  s_mul_i32 s38, s27, 3
  s_add_u32 s37, s37, s38
  s_mul_i32 s38, s25, 43008
  v_and_b32 v3, 7, v1
  v_lshrrev_b32 v2, 3, v1
  v_lshl_add_u32 v3, v3, 4, s38
  s_lshl_b32 s38, s37, 3
  v_add_u32 v2, s38, v2
  v_add_u32 v8, 4, v2
  v_mul_u32_u24 v8, 9363, v8
  v_lshrrev_b32 v8, 16, v8
  v_add3_u32 v8, v8, v2, 0
  v_lshl_add_u32 v8, v8, 7, v3
  v_add_u32 v9, 12, v2
  v_mul_u32_u24 v9, 9363, v9
  v_lshrrev_b32 v9, 16, v9
  v_add3_u32 v9, v9, v2, 0
  v_lshl_add_u32 v9, v9, 7, v3
  v_add_u32 v10, 20, v2
  v_mul_u32_u24 v10, 9363, v10
  v_lshrrev_b32 v10, 16, v10
  v_add3_u32 v10, v10, v2, 0
  v_lshl_add_u32 v10, v10, 7, v3
L_poll_3121:
  buffer_load_dwordx2 v[126:127], v23, s[8:11], 0 offen sc1
  s_add_u32 s34, s34, 1
  s_waitcnt vmcnt(0)
  v_max_u32 v128, v126, v127
  v_cmp_eq_u32 vcc, -1, v128
  s_cmp_gt_u32 s34, 262144
  s_cbranch_scc1 L_got_3122
  s_cbranch_vccnz L_poll_3121
L_got_3122:
  v_mov_b32 v128, v126
  v_mov_b32 v129, v127
  s_mov_b32 s58, 0x3ae38e39
  s_mov_b32 s59, 0x3ae38e39
  v_permlane32_swap_b32 v126, v128
  v_permlane32_swap_b32 v127, v129
  v_pk_add_f32 v[124:125], v[124:125], v[126:127]
  v_pk_add_f32 v[124:125], v[124:125], v[128:129]
  v_pk_mul_f32 v[124:125], v[124:125], s[58:59]
  s_mov_b32 s58, 0x3f800054
  v_mov_b32 v126, 0x2edbe6ff
  v_fma_f32 v125, -v124, v124, v125
  v_max_f32 v125, 0, v125
  v_fma_f32 v125, v125, s58, v126
  v_rsq_f32 v126, v125
  s_lshl_b32 s37, s27, 8
  s_add_u32 s37, s37, 160768
  v_lshl_add_u32 v2, v1, 2, s37
  v_mul_f32 v127, -v124, v126
  v_mul_f32 v125, v125, v126
  s_mov_b32 vcc_lo, 0
  s_mov_b32 vcc_hi, -1
  v_cndmask_b32 v126, v126, v127, vcc
  v_lshl_add_u32 v3, v6, 4, s37
  ds_write_b32 v2, v126
  ds_read_b128 v[92:95], v3 offset:0
  ds_read_b128 v[96:99], v3 offset:64
  ds_read_b128 v[100:103], v3 offset:128
  ds_read_b128 v[104:107], v3 offset:192
  s_add_u32 s20, s84, 33554432
  s_addc_u32 s21, s85, 0
  s_mov_b32 s22, 2752512
  s_mov_b32 s23, 0x20000
  s_or_b32 s37, s27, s26
  s_cbranch_scc1 L_ms_3124
  s_add_u32 s8, s84, 12582912
  s_addc_u32 s9, s85, 0
  s_mov_b32 s10, 16384
  s_mov_b32 s11, 0x20000
  s_lshl_b32 s37, s25, 8
  v_lshl_add_u32 v2, v1, 3, s37
  s_mov_b32 exec_hi, 0
  buffer_store_dwordx2 v[124:125], v2, s[8:11], 0 offen sc1
  s_mov_b32 exec_hi, -1
L_ms_3124:
  s_waitcnt lgkmcnt(0)
  v_pk_fma_f32 v[28:29], v[28:29], v[92:93], v[100:101]
  v_pk_fma_f32 v[30:31], v[30:31], v[94:95], v[102:103]
  v_pk_fma_f32 v[32:33], v[32:33], v[96:97], v[104:105]
  v_pk_fma_f32 v[34:35], v[34:35], v[98:99], v[106:107]
  v_cvt_pk_bf16_f32 v132, v28, v29
  v_cvt_pk_bf16_f32 v133, v30, v31
  v_cvt_pk_bf16_f32 v134, v32, v33
  v_cvt_pk_bf16_f32 v135, v34, v35
  buffer_store_dwordx4 v[132:135], v8, s[20:23], 0 offen offset:0 sc1
  v_pk_fma_f32 v[36:37], v[36:37], v[92:93], v[100:101]
  v_pk_fma_f32 v[38:39], v[38:39], v[94:95], v[102:103]
  v_pk_fma_f32 v[40:41], v[40:41], v[96:97], v[104:105]
  v_pk_fma_f32 v[42:43], v[42:43], v[98:99], v[106:107]
  v_cvt_pk_bf16_f32 v136, v36, v37
  v_cvt_pk_bf16_f32 v137, v38, v39
  v_cvt_pk_bf16_f32 v138, v40, v41
  v_cvt_pk_bf16_f32 v139, v42, v43
  buffer_store_dwordx4 v[136:139], v9, s[20:23], 0 offen offset:1024 sc1
  v_pk_fma_f32 v[44:45], v[44:45], v[92:93], v[100:101]
  v_pk_fma_f32 v[46:47], v[46:47], v[94:95], v[102:103]
  v_pk_fma_f32 v[48:49], v[48:49], v[96:97], v[104:105]
  v_pk_fma_f32 v[50:51], v[50:51], v[98:99], v[106:107]
  v_cvt_pk_bf16_f32 v140, v44, v45
  v_cvt_pk_bf16_f32 v141, v46, v47
  v_cvt_pk_bf16_f32 v142, v48, v49
  v_cvt_pk_bf16_f32 v143, v50, v51
  buffer_store_dwordx4 v[140:143], v10, s[20:23], 0 offen offset:2048 sc1
  s_waitcnt vmcnt(0)
  s_barrier
  s_branch L_cg3_3102
L_c2i_3082:
  v_lshlrev_b32 v2, 7, v0
  s_mov_b32 s8, s72
  s_mov_b32 s9, s73
  s_mov_b32 s10, 18874368
  s_mov_b32 s11, 0x20000
  s_mov_b32 s56, s76
  s_mov_b32 s57, s77
  s_mov_b32 s58, 18874368
  s_mov_b32 s59, 0x20000
  s_add_u32 s4, s2, -106
  s_mov_b32 s5, 1
  s_cmp_eq_u32 s5, 0
  s_cbranch_scc1 L_ple_3126
L_pl_3125:
  s_sub_u32 s6, s4, 288
  s_cbranch_scc0 L_pl2_3127
  s_lshl_b32 s6, s4, 16
  v_add_u32 v3, s6, v2
  buffer_load_dword v250, v3, s[8:11], 0 offen
  s_branch L_pl3_3128
L_pl2_3127:
  s_and_b32 s7, s6, 3
  s_mul_i32 s7, s7, 72
  s_lshr_b32 s6, s6, 2
  s_add_u32 s6, s6, s7
  s_lshl_b32 s6, s6, 16
  v_add_u32 v3, s6, v2
  buffer_load_dword v250, v3, s[56:59], 0 offen
L_pl3_3128:
  s_mov_b64 exec, -1
  s_add_u32 s4, s4, 64
  s_sub_u32 s5, s5, 1
  s_waitcnt vmcnt(0)
  s_cmp_lg_u32 s5, 0
  s_cbranch_scc1 L_pl_3125
L_ple_3126:
  v_lshlrev_b32 v2, 7, v0
  s_mov_b32 s8, s72
  s_mov_b32 s9, s73
  s_mov_b32 s10, 18874368
  s_mov_b32 s11, 0x20000
  s_mov_b32 s56, s76
  s_mov_b32 s57, s77
  s_mov_b32 s58, 18874368
  s_mov_b32 s59, 0x20000
  s_add_u32 s4, s2, -42
  s_mov_b32 s5, 1
  s_cmp_eq_u32 s5, 0
  s_cbranch_scc1 L_ple_3132
L_pl_3131:
  s_sub_u32 s6, s4, 288
  s_cbranch_scc0 L_pl2_3133
  s_lshl_b32 s6, s4, 16
  v_add_u32 v3, s6, v2
  buffer_load_dword v250, v3, s[8:11], 0 offen
  s_branch L_pl3_3134
L_pl2_3133:
  s_and_b32 s7, s6, 3
  s_mul_i32 s7, s7, 72
  s_lshr_b32 s6, s6, 2
  s_add_u32 s6, s6, s7
  s_lshl_b32 s6, s6, 16
  v_add_u32 v3, s6, v2
  buffer_load_dword v250, v3, s[56:59], 0 offen
L_pl3_3134:
  s_mov_b64 exec, -1
  s_add_u32 s4, s4, 64
  s_sub_u32 s5, s5, 1
  s_waitcnt vmcnt(0)
  s_cmp_lg_u32 s5, 0
  s_cbranch_scc1 L_pl_3131
L_ple_3132:
  v_lshlrev_b32 v2, 7, v0
  s_mov_b32 s8, s72
  s_mov_b32 s9, s73
  s_mov_b32 s10, 18874368
  s_mov_b32 s11, 0x20000
  s_mov_b32 s56, s76
  s_mov_b32 s57, s77
  s_mov_b32 s58, 18874368
  s_mov_b32 s59, 0x20000
  s_add_u32 s4, s2, 22
  s_cmp_lt_u32 s63, 27
  s_cselect_b32 s5, 2, 0
  s_cmp_eq_u32 s5, 0
  s_cbranch_scc1 L_ple_3138
L_pl_3137:
  s_sub_u32 s6, s4, 288
  s_cbranch_scc0 L_pl2_3139
  s_lshl_b32 s6, s4, 16
  v_add_u32 v3, s6, v2
  buffer_load_dword v250, v3, s[8:11], 0 offen
  s_branch L_pl3_3140
L_pl2_3139:
  s_and_b32 s7, s6, 3
  s_mul_i32 s7, s7, 72
  s_lshr_b32 s6, s6, 2
  s_add_u32 s6, s6, s7
  s_lshl_b32 s6, s6, 16
  v_add_u32 v3, s6, v2
  buffer_load_dword v250, v3, s[56:59], 0 offen
L_pl3_3140:
  s_mov_b64 exec, -1
  s_add_u32 s4, s4, 24
  s_sub_u32 s5, s5, 1
  s_waitcnt vmcnt(0)
  s_cmp_lg_u32 s5, 0
  s_cbranch_scc1 L_pl_3137
L_ple_3138:
  s_cmp_lt_u32 s63, 27
  s_cbranch_scc1 L_cg3_3102
  s_sub_u32 s4, s63, 27
  s_lshl_b32 s4, s4, 3
  s_add_u32 s4, s4, s62
  s_mul_i32 s4, s4, 196608
  s_add_u32 s5, s4, 196608
  v_lshlrev_b32 v2, 4, v0
  v_mov_b32 v4, -1
  v_mov_b32 v5, -1
  v_mov_b32 v6, -1
  v_mov_b32 v7, -1
  s_add_u32 s52, s84, 12599296
  s_addc_u32 s53, s85, 0
  s_mov_b32 s54, 7864320
  s_mov_b32 s55, 0x20000
L_ps_3143:
  buffer_store_dwordx4 v[4:7], v2, s[52:55], s4 offen sc1
  s_add_u32 s4, s4, 8192
  s_cmp_lt_u32 s4, s5
  s_cbranch_scc1 L_ps_3143
  v_lshlrev_b32 v2, 7, v0
  s_mov_b32 s8, s72
  s_mov_b32 s9, s73
  s_mov_b32 s10, 18874368
  s_mov_b32 s11, 0x20000
  s_mov_b32 s56, s76
  s_mov_b32 s57, s77
  s_mov_b32 s58, 18874368
  s_mov_b32 s59, 0x20000
  s_sub_u32 s4, 30, s63
  s_cselect_b32 s4, 4, s4
  s_lshl3_add_u32 s4, s4, s62
  s_add_u32 s4, s4, 262
  s_mov_b32 s5, 1
  s_cmp_eq_u32 s5, 0
  s_cbranch_scc1 L_ple_3145
L_pl_3144:
  s_sub_u32 s6, s4, 288
  s_cbranch_scc0 L_pl2_3146
  s_lshl_b32 s6, s4, 16
  v_add_u32 v3, s6, v2
  buffer_load_dword v250, v3, s[8:11], 0 offen
  s_branch L_pl3_3147
L_pl2_3146:
  s_and_b32 s7, s6, 3
  s_mul_i32 s7, s7, 72
  s_lshr_b32 s6, s6, 2
  s_add_u32 s6, s6, s7
  s_lshl_b32 s6, s6, 16
  v_add_u32 v3, s6, v2
  buffer_load_dword v250, v3, s[56:59], 0 offen
L_pl3_3147:
  s_mov_b64 exec, -1
  s_add_u32 s4, s4, 40
  s_sub_u32 s5, s5, 1
  s_waitcnt vmcnt(0)
  s_cmp_lg_u32 s5, 0
  s_cbranch_scc1 L_pl_3144
L_ple_3145:
  s_cmp_lg_u32 s3, 4
  s_cbranch_scc1 L_nw4_3150
  s_mov_b32 s52, s82
  s_mov_b32 s53, s83
  s_mov_b32 s54, 256
  s_mov_b32 s55, 0x20000
  v_lshlrev_b32 v2, 3, v1
  v_mov_b32 v3, 1
  s_mov_b32 exec_lo, 0xff
  s_mov_b32 exec_hi, 0
  s_mov_b32 s56, 0
L_poll_3151:
  buffer_load_dword v4, v2, s[52:55], 0 offen sc1
  s_add_u32 s56, s56, 1
  s_waitcnt vmcnt(0)
  v_cmp_ne_u32 vcc, v4, v3
  s_cmp_gt_u32 s56, 262144
  s_cbranch_scc1 L_got_3152
  s_cbranch_vccz L_got_3152
  s_sleep 1
  s_branch L_poll_3151
L_got_3152:
  s_mov_b64 exec, -1
L_nw4_3150:
  s_barrier
  s_cmp_lg_u32 s3, 4
  s_cbranch_scc1 L_nw4_3153
  s_add_u32 s52, s84, 20463616
  s_addc_u32 s53, s85, 0
  s_mov_b32 s54, 45056
  s_mov_b32 s55, 0x20000
  s_add_u32 s56, s62, 304
  s_lshl_b32 s56, s56, 7
  v_mul_u32_u24 v2, 0, v1
  v_mov_b32 v3, 1
  v_add_u32 v2, s56, v2
  s_mov_b64 exec, 1
  buffer_atomic_add v3, v2, s[52:55], 0 offen
  s_mov_b64 exec, -1
L_nw4_3153:
  v_lshlrev_b32 v2, 7, v0
  s_mov_b32 s8, s72
  s_mov_b32 s9, s73
  s_mov_b32 s10, 18874368
  s_mov_b32 s11, 0x20000
  s_mov_b32 s56, s76
  s_mov_b32 s57, s77
  s_mov_b32 s58, 18874368
  s_mov_b32 s59, 0x20000
  s_add_u32 s52, s84, 20463616
  s_addc_u32 s53, s85, 0
  s_mov_b32 s54, 45056
  s_mov_b32 s55, 0x20000
  s_add_u32 s4, s62, 312
  s_lshl_b32 s4, s4, 7
  v_mov_b32 v5, s4
  s_sub_u32 s4, 30, s63
  s_cselect_b32 s4, 4, s4
  s_lshl3_add_u32 s4, s4, s62
  s_add_u32 s4, s4, 302
  s_cmp_eq_u32 s63, 31
  s_cselect_b32 s5, 7, 7
  s_cmp_eq_u32 s5, 0
  s_cbranch_scc1 L_ple_3155
L_pl_3154:
  s_sub_u32 s6, s4, 288
  s_cbranch_scc0 L_pl2_3156
  s_lshl_b32 s6, s4, 16
  v_add_u32 v3, s6, v2
  buffer_load_dword v250, v3, s[8:11], 0 offen
  s_branch L_pl3_3157
L_pl2_3156:
  s_and_b32 s7, s6, 3
  s_mul_i32 s7, s7, 72
  s_lshr_b32 s6, s6, 2
  s_add_u32 s6, s6, s7
  s_lshl_b32 s6, s6, 16
  v_add_u32 v3, s6, v2
  buffer_load_dword v250, v3, s[56:59], 0 offen
L_pl3_3157:
  s_mov_b64 exec, -1
  buffer_load_dword v4, v5, s[52:55], 0 offen sc1
  s_add_u32 s4, s4, 40
  s_sub_u32 s5, s5, 1
  s_waitcnt vmcnt(0)
  v_readfirstlane_b32 s7, v4
  s_cmp_ge_u32 s4, 576
  s_cselect_b32 s5, 0, s5
  s_cmp_eq_u32 s7, 1
  s_cselect_b32 s5, 0, s5
  s_cmp_lg_u32 s5, 0
  s_cbranch_scc1 L_pl_3154
L_ple_3155:
  s_cmp_lg_u32 s3, 0
  s_cbranch_scc1 L_nw4_3160
  s_mov_b32 s52, s82
  s_mov_b32 s53, s83
  s_mov_b32 s54, 256
  s_mov_b32 s55, 0x20000
  v_lshlrev_b32 v2, 3, v1
  v_mov_b32 v3, 1
  s_mov_b32 exec_lo, 0xff
  s_mov_b32 exec_hi, 0
  s_mov_b32 s56, 0
L_poll_3161:
  buffer_load_dword v4, v2, s[52:55], 0 offen sc1
  s_add_u32 s56, s56, 1
  s_waitcnt vmcnt(0)
  v_cmp_ne_u32 vcc, v4, v3
  s_cmp_gt_u32 s56, 262144
  s_cbranch_scc1 L_got_3162
  s_cbranch_vccz L_got_3162
  s_sleep 1
  s_branch L_poll_3161
L_got_3162:
  s_mov_b64 exec, -1
  s_add_u32 s52, s84, 20463616
  s_addc_u32 s53, s85, 0
  s_mov_b32 s54, 45056
  s_mov_b32 s55, 0x20000
  s_lshl_b32 s56, s62, 11
  s_add_u32 s56, s56, 16384
  v_lshl_add_u32 v2, v1, 7, s56
  v_mov_b32 v3, 12
  s_mov_b32 exec_lo, 0xffff
  s_mov_b32 exec_hi, 0
  s_mov_b32 s56, 0
L_poll_3163:
  buffer_load_dword v4, v2, s[52:55], 0 offen sc1
  s_add_u32 s56, s56, 1
  s_waitcnt vmcnt(0)
  v_cmp_ne_u32 vcc, v4, v3
  s_cmp_gt_u32 s56, 262144
  s_cbranch_scc1 L_got_3164
  s_cbranch_vccz L_got_3164
  s_sleep 1
  s_branch L_poll_3163
L_got_3164:
  s_mov_b64 exec, -1
L_nw4_3160:
  s_barrier
  s_branch L_cg4_3103
L_cg3_3102:
L_p3c:
  s_mul_i32 s24, s62, 27
  s_add_u32 s24, s24, s63
  s_mul_i32 s25, s24, 43691
  s_lshr_b32 s25, s25, 18
  s_mul_i32 s36, s25, 6
  s_sub_u32 s26, s24, s36
  s_and_b32 s27, s3, 3
  s_bfe_u32 s28, s3, 0x10001
  s_and_b32 s29, s3, 1
  s_lshl_b32 s38, s25, 1
  v_lshrrev_b32 v3, 4, v1
  s_lshl_b32 s34, s28, 0
  s_add_u32 s38, s38, s34
  s_lshl_b32 s36, s38, 7
  v_lshl_add_u32 v2, v3, 3, s36
  s_mov_b32 s20, s74
  s_mov_b32 s21, s75
  s_mov_b32 s22, 9216
  s_mov_b32 s23, 0x20000
  buffer_load_dwordx2 v[124:125], v2, s[20:23], 0 offen offset:0
  buffer_load_dwordx2 v[126:127], v2, s[20:23], 0 offen offset:32
  buffer_load_dwordx2 v[128:129], v2, s[20:23], 0 offen offset:64
  buffer_load_dwordx2 v[130:131], v2, s[20:23], 0 offen offset:96
  s_add_u32 s16, s84, 37748736
  s_addc_u32 s17, s85, 0
  s_mov_b32 s18, 6193152
  s_mov_b32 s19, 0x20000
  v_bfe_u32 v2, v1, 2, 2
  v_lshlrev_b32 v2, 6, v2
  v_lshl_add_u32 v2, v3, 10, v2
  v_and_b32 v4, 3, v1
  v_lshl_add_u32 v2, v4, 3, v2
  s_lshl_b32 s36, s28, 9
  v_add_u32 v2, s36, v2
  v_and_b32 v3, 1, v3
  v_lshl_add_u32 v8, v3, 5, v2
  v_xor_b32 v9, 32, v8
  s_mul_i32 s36, s29, 3072
  s_add_u32 s36, s36, 16384
  v_lshl_add_u32 v10, v1, 4, s36
  s_mul_i32 s36, s26, 6
  s_mul_i32 s34, s29, 3
  s_add_u32 s36, s36, s34
  s_lshl_b32 s32, s38, 1
  s_mul_i32 s34, s32, 43008
  v_and_b32 v3, 7, v1
  v_lshrrev_b32 v2, 3, v1
  v_lshl_add_u32 v3, v3, 4, s34
  s_lshl_b32 s34, s36, 3
  v_add_u32 v2, s34, v2
  v_add_u32 v14, 4, v2
  v_mul_u32_u24 v14, 9363, v14
  v_lshrrev_b32 v14, 16, v14
  v_add3_u32 v14, v14, v2, 0
  v_lshl_add_u32 v14, v14, 7, v3
  v_add_u32 v15, 12, v2
  v_mul_u32_u24 v15, 9363, v15
  v_lshrrev_b32 v15, 16, v15
  v_add3_u32 v15, v15, v2, 0
  v_lshl_add_u32 v15, v15, 7, v3
  v_add_u32 v16, 20, v2
  v_mul_u32_u24 v16, 9363, v16
  v_lshrrev_b32 v16, 16, v16
  v_add3_u32 v16, v16, v2, 0
  v_lshl_add_u32 v16, v16, 7, v3
  s_mov_b32 s32, 0
  s_mov_b32 s34, 0
  v_mov_b32 v11, v8
  v_mov_b32 v12, v9
  v_mov_b32 v13, v10
  v_mov_b32 v36, 0
  v_mov_b32 v37, 0
  v_mov_b32 v38, 0
  v_mov_b32 v39, 0
  v_mov_b32 v40, 0
  v_mov_b32 v41, 0
  v_mov_b32 v42, 0
  v_mov_b32 v43, 0
  v_mov_b32 v44, 0
  v_mov_b32 v45, 0
  v_mov_b32 v46, 0
  v_mov_b32 v47, 0
  v_mov_b32 v48, 0
  v_mov_b32 v49, 0
  v_mov_b32 v50, 0
  v_mov_b32 v51, 0
  v_mov_b32 v64, 0
  v_mov_b32 v65, 0
  v_mov_b32 v66, 0
  v_mov_b32 v67, 0
  v_mov_b32 v68, 0
  v_mov_b32 v69, 0
  v_mov_b32 v70, 0
  v_mov_b32 v71, 0
  v_mov_b32 v72, 0
  v_mov_b32 v73, 0
  v_mov_b32 v74, 0
  v_mov_b32 v75, 0
  s_waitcnt vmcnt(0)
  v_lshlrev_b32 v76, 16, v124
  v_and_b32 v77, 0xffff0000, v124
  v_lshlrev_b32 v78, 16, v125
  v_and_b32 v79, 0xffff0000, v125
  v_lshlrev_b32 v80, 16, v124
  v_and_b32 v81, 0xffff0000, v124
  v_lshlrev_b32 v82, 16, v125
  v_and_b32 v83, 0xffff0000, v125
  v_lshlrev_b32 v84, 16, v124
  v_and_b32 v85, 0xffff0000, v124
  v_lshlrev_b32 v86, 16, v125
  v_and_b32 v87, 0xffff0000, v125
  v_lshlrev_b32 v88, 16, v126
  v_and_b32 v89, 0xffff0000, v126
  v_lshlrev_b32 v90, 16, v127
  v_and_b32 v91, 0xffff0000, v127
  v_lshlrev_b32 v92, 16, v126
  v_and_b32 v93, 0xffff0000, v126
  v_lshlrev_b32 v94, 16, v127
  v_and_b32 v95, 0xffff0000, v127
  v_lshlrev_b32 v96, 16, v126
  v_and_b32 v97, 0xffff0000, v126
  v_lshlrev_b32 v98, 16, v127
  v_and_b32 v99, 0xffff0000, v127
  v_lshlrev_b32 v100, 16, v128
  v_and_b32 v101, 0xffff0000, v128
  v_lshlrev_b32 v102, 16, v129
  v_and_b32 v103, 0xffff0000, v129
  v_lshlrev_b32 v104, 16, v128
  v_and_b32 v105, 0xffff0000, v128
  v_lshlrev_b32 v106, 16, v129
  v_and_b32 v107, 0xffff0000, v129
  v_lshlrev_b32 v108, 16, v128
  v_and_b32 v109, 0xffff0000, v128
  v_lshlrev_b32 v110, 16, v129
  v_and_b32 v111, 0xffff0000, v129
  v_lshlrev_b32 v112, 16, v130
  v_and_b32 v113, 0xffff0000, v130
  v_lshlrev_b32 v114, 16, v131
  v_and_b32 v115, 0xffff0000, v131
  v_lshlrev_b32 v116, 16, v130
  v_and_b32 v117, 0xffff0000, v130
  v_lshlrev_b32 v118, 16, v131
  v_and_b32 v119, 0xffff0000, v131
  v_lshlrev_b32 v120, 16, v130
  v_and_b32 v121, 0xffff0000, v130
  v_lshlrev_b32 v122, 16, v131
  v_and_b32 v123, 0xffff0000, v131
  s_cmp_eq_u32 s63, 5
  s_cselect_b32 s44, 27, 99
  s_cmp_eq_u32 s3, 3
  s_cselect_b32 s44, s44, 99
  s_cmp_lg_u32 s3, 0
  s_cbranch_scc1 L_nw4_3166
  s_add_u32 s52, s84, 20463616
  s_addc_u32 s53, s85, 0
  s_mov_b32 s54, 45056
  s_mov_b32 s55, 0x20000
  s_lshl_b32 s56, s62, 11
  s_add_u32 s56, s56, 16384
  v_lshl_add_u32 v2, v1, 7, s56
  v_mov_b32 v3, 12
  s_mov_b32 exec_lo, 0xffff
  s_mov_b32 exec_hi, 0
  s_mov_b32 s56, 0
L_poll_3167:
  buffer_load_dword v4, v2, s[52:55], 0 offen sc1
  s_add_u32 s56, s56, 1
  s_waitcnt vmcnt(0)
  v_cmp_ne_u32 vcc, v4, v3
  s_cmp_gt_u32 s56, 262144
  s_cbranch_scc1 L_got_3168
  s_and_b32 s57, vcc_lo, 771
  s_cbranch_scc0 L_got_3168
  s_sleep 1
  s_branch L_poll_3167
L_got_3168:
  s_mov_b64 exec, -1
L_nw4_3166:
  s_barrier
  s_cmp_lg_u32 s3, 0
  s_cbranch_scc1 L_nw4_3169
  s_mov_b32 exec_lo, 0xffff
  s_mov_b32 exec_hi, 0
  v_cmp_ne_u32 vcc, v4, v3
  s_mov_b64 exec, -1
  s_cbranch_vccz L_gotb_3170
  s_add_u32 s52, s84, 20463616
  s_addc_u32 s53, s85, 0
  s_mov_b32 s54, 45056
  s_mov_b32 s55, 0x20000
  s_mov_b32 exec_lo, 0xffff
  s_mov_b32 exec_hi, 0
  s_mov_b32 s56, 0
L_poll_3171:
  buffer_load_dword v4, v2, s[52:55], 0 offen sc1
  s_add_u32 s56, s56, 1
  s_waitcnt vmcnt(0)
  v_cmp_ne_u32 vcc, v4, v3
  s_cmp_gt_u32 s56, 262144
  s_cbranch_scc1 L_got_3172
  s_cbranch_vccz L_got_3172
  s_sleep 1
  s_branch L_poll_3171
L_got_3172:
  s_mov_b64 exec, -1
L_gotb_3170:
L_nw4_3169:
  .p2align 6
L_k_3173:
  s_waitcnt lgkmcnt(0)
  s_barrier
  v_mfma_f32_16x16x32_bf16 v[76:79], v[36:39], v[64:67], v[76:79]
  ds_read_b64_tr_b16 v[20:21], v11 offset:0
  ds_read_b64_tr_b16 v[22:23], v11 offset:4096
  v_mfma_f32_16x16x32_bf16 v[80:83], v[36:39], v[68:71], v[80:83]
  ds_read_b128 v[52:55], v13 offset:0
  ds_read_b128 v[56:59], v13 offset:1024
  v_mfma_f32_16x16x32_bf16 v[84:87], v[36:39], v[72:75], v[84:87]
  ds_read_b128 v[60:63], v13 offset:2048
  ds_read_b64_tr_b16 v[24:25], v12 offset:0
  v_mfma_f32_16x16x32_bf16 v[88:91], v[40:43], v[64:67], v[88:91]
  ds_read_b64_tr_b16 v[26:27], v12 offset:4096
  ds_read_b64_tr_b16 v[28:29], v11 offset:256
  v_mfma_f32_16x16x32_bf16 v[92:95], v[40:43], v[68:71], v[92:95]
  ds_read_b64_tr_b16 v[30:31], v11 offset:4352
  ds_read_b64_tr_b16 v[32:33], v12 offset:256
  v_mfma_f32_16x16x32_bf16 v[96:99], v[40:43], v[72:75], v[96:99]
  ds_read_b64_tr_b16 v[34:35], v12 offset:4352
  v_mfma_f32_16x16x32_bf16 v[100:103], v[44:47], v[64:67], v[100:103]
  s_cmp_lg_u32 s34, s44
  s_cbranch_scc1 L_nab_3165
  s_add_u32 s52, s84, 20463616
  s_addc_u32 s53, s85, 0
  s_mov_b32 s54, 45056
  s_mov_b32 s55, 0x20000
  s_add_u32 s45, s62, 312
  s_lshl_b32 s45, s45, 7
  v_mov_b32 v2, s45
  v_mov_b32 v3, 1
  s_mov_b64 exec, 1
  buffer_store_dword v3, v2, s[52:55], 0 offen sc1
  s_mov_b64 exec, -1
L_nab_3165:
  v_mfma_f32_16x16x32_bf16 v[104:107], v[44:47], v[68:71], v[104:107]
  v_mfma_f32_16x16x32_bf16 v[108:111], v[44:47], v[72:75], v[108:111]
  v_mfma_f32_16x16x32_bf16 v[112:115], v[48:51], v[64:67], v[112:115]
  v_mfma_f32_16x16x32_bf16 v[116:119], v[48:51], v[68:71], v[116:119]
  v_mfma_f32_16x16x32_bf16 v[120:123], v[48:51], v[72:75], v[120:123]
  s_waitcnt lgkmcnt(0)
  v_mfma_f32_16x16x32_bf16 v[76:79], v[20:23], v[52:55], v[76:79]
  ds_read_b64_tr_b16 v[36:37], v11 offset:8192
  ds_read_b64_tr_b16 v[38:39], v11 offset:12288
  v_mfma_f32_16x16x32_bf16 v[80:83], v[20:23], v[56:59], v[80:83]
  ds_read_b128 v[64:67], v13 offset:6144
  ds_read_b128 v[68:71], v13 offset:7168
  v_mfma_f32_16x16x32_bf16 v[84:87], v[20:23], v[60:63], v[84:87]
  ds_read_b128 v[72:75], v13 offset:8192
  ds_read_b64_tr_b16 v[40:41], v12 offset:8192
  v_mfma_f32_16x16x32_bf16 v[88:91], v[24:27], v[52:55], v[88:91]
  ds_read_b64_tr_b16 v[42:43], v12 offset:12288
  ds_read_b64_tr_b16 v[44:45], v11 offset:8448
  v_mfma_f32_16x16x32_bf16 v[92:95], v[24:27], v[56:59], v[92:95]
  ds_read_b64_tr_b16 v[46:47], v11 offset:12544
  ds_read_b64_tr_b16 v[48:49], v12 offset:8448
  v_mfma_f32_16x16x32_bf16 v[96:99], v[24:27], v[60:63], v[96:99]
  ds_read_b64_tr_b16 v[50:51], v12 offset:12544
  s_add_u32 s32, s32, 28672
  v_mfma_f32_16x16x32_bf16 v[100:103], v[28:31], v[52:55], v[100:103]
  s_cmp_eq_u32 s32, 143360
  s_cselect_b32 s32, 0, s32
  v_mfma_f32_16x16x32_bf16 v[104:107], v[28:31], v[56:59], v[104:107]
  v_add_u32 v11, s32, v8
  v_add_u32 v12, s32, v9
  v_mfma_f32_16x16x32_bf16 v[108:111], v[28:31], v[60:63], v[108:111]
  v_add_u32 v13, s32, v10
  s_add_u32 s34, s34, 1
  v_mfma_f32_16x16x32_bf16 v[112:115], v[32:35], v[52:55], v[112:115]
  s_cmp_lt_u32 s34, 32
  v_mfma_f32_16x16x32_bf16 v[116:119], v[32:35], v[56:59], v[116:119]
  v_mfma_f32_16x16x32_bf16 v[120:123], v[32:35], v[60:63], v[120:123]
  s_cbranch_scc1 L_k_3173
L_p3e:
  s_waitcnt lgkmcnt(0)
  s_barrier
  v_mfma_f32_16x16x32_bf16 v[76:79], v[36:39], v[64:67], v[76:79]
  v_mfma_f32_16x16x32_bf16 v[80:83], v[36:39], v[68:71], v[80:83]
  v_mfma_f32_16x16x32_bf16 v[84:87], v[36:39], v[72:75], v[84:87]
  v_mfma_f32_16x16x32_bf16 v[88:91], v[40:43], v[64:67], v[88:91]
  v_mfma_f32_16x16x32_bf16 v[92:95], v[40:43], v[68:71], v[92:95]
  v_mfma_f32_16x16x32_bf16 v[96:99], v[40:43], v[72:75], v[96:99]
  v_mfma_f32_16x16x32_bf16 v[100:103], v[44:47], v[64:67], v[100:103]
  v_mfma_f32_16x16x32_bf16 v[104:107], v[44:47], v[68:71], v[104:107]
  v_mfma_f32_16x16x32_bf16 v[108:111], v[44:47], v[72:75], v[108:111]
  v_mfma_f32_16x16x32_bf16 v[112:115], v[48:51], v[64:67], v[112:115]
  v_mfma_f32_16x16x32_bf16 v[116:119], v[48:51], v[68:71], v[116:119]
  v_mfma_f32_16x16x32_bf16 v[120:123], v[48:51], v[72:75], v[120:123]
  s_mov_b32 s42, 0xbdd2d3e8
  s_mov_b32 s43, 0xbdd2d3e8
  v_mov_b32 v20, 0xc0135761
  v_mov_b32 v21, 0xc0135761
  s_mov_b32 s36, 43008
  v_pk_mul_f32 v[124:125], v[76:77], v[76:77]
  v_pk_mul_f32 v[126:127], v[78:79], v[78:79]
  v_pk_mul_f32 v[128:129], v[88:89], v[88:89]
  v_pk_mul_f32 v[130:131], v[90:91], v[90:91]
  v_pk_fma_f32 v[124:125], v[124:125], s[42:43], v[20:21]
  v_pk_fma_f32 v[126:127], v[126:127], s[42:43], v[20:21]
  v_pk_fma_f32 v[128:129], v[128:129], s[42:43], v[20:21]
  v_pk_fma_f32 v[130:131], v[130:131], s[42:43], v[20:21]
  v_pk_mul_f32 v[124:125], v[124:125], v[76:77]
  v_pk_mul_f32 v[126:127], v[126:127], v[78:79]
  v_pk_mul_f32 v[128:129], v[128:129], v[88:89]
  v_pk_mul_f32 v[130:131], v[130:131], v[90:91]
  v_exp_f32 v124, v124
  v_exp_f32 v125, v125
  v_exp_f32 v126, v126
  v_exp_f32 v127, v127
  v_exp_f32 v128, v128
  v_exp_f32 v129, v129
  v_exp_f32 v130, v130
  v_exp_f32 v131, v131
  v_pk_add_f32 v[124:125], v[124:125], 1.0 op_sel_hi:[1,0]
  v_pk_add_f32 v[126:127], v[126:127], 1.0 op_sel_hi:[1,0]
  v_pk_add_f32 v[128:129], v[128:129], 1.0 op_sel_hi:[1,0]
  v_pk_add_f32 v[130:131], v[130:131], 1.0 op_sel_hi:[1,0]
  v_rcp_f32 v124, v124
  v_rcp_f32 v125, v125
  v_rcp_f32 v126, v126
  v_rcp_f32 v127, v127
  v_rcp_f32 v128, v128
  v_rcp_f32 v129, v129
  v_rcp_f32 v130, v130
  v_rcp_f32 v131, v131
  v_pk_mul_f32 v[124:125], v[124:125], v[76:77]
  v_pk_mul_f32 v[126:127], v[126:127], v[78:79]
  v_pk_mul_f32 v[128:129], v[128:129], v[88:89]
  v_pk_mul_f32 v[130:131], v[130:131], v[90:91]
  v_cvt_pk_bf16_f32 v132, v124, v125
  v_cvt_pk_bf16_f32 v133, v126, v127
  v_cvt_pk_bf16_f32 v134, v128, v129
  v_cvt_pk_bf16_f32 v135, v130, v131
  buffer_store_dwordx4 v[132:135], v14, s[16:19], 0 offen offset:0 sc1
  v_pk_mul_f32 v[136:137], v[80:81], v[80:81]
  v_pk_mul_f32 v[138:139], v[82:83], v[82:83]
  v_pk_mul_f32 v[140:141], v[92:93], v[92:93]
  v_pk_mul_f32 v[142:143], v[94:95], v[94:95]
  v_pk_fma_f32 v[136:137], v[136:137], s[42:43], v[20:21]
  v_pk_fma_f32 v[138:139], v[138:139], s[42:43], v[20:21]
  v_pk_fma_f32 v[140:141], v[140:141], s[42:43], v[20:21]
  v_pk_fma_f32 v[142:143], v[142:143], s[42:43], v[20:21]
  v_pk_mul_f32 v[136:137], v[136:137], v[80:81]
  v_pk_mul_f32 v[138:139], v[138:139], v[82:83]
  v_pk_mul_f32 v[140:141], v[140:141], v[92:93]
  v_pk_mul_f32 v[142:143], v[142:143], v[94:95]
  v_exp_f32 v136, v136
  v_exp_f32 v137, v137
  v_exp_f32 v138, v138
  v_exp_f32 v139, v139
  v_exp_f32 v140, v140
  v_exp_f32 v141, v141
  v_exp_f32 v142, v142
  v_exp_f32 v143, v143
  v_pk_add_f32 v[136:137], v[136:137], 1.0 op_sel_hi:[1,0]
  v_pk_add_f32 v[138:139], v[138:139], 1.0 op_sel_hi:[1,0]
  v_pk_add_f32 v[140:141], v[140:141], 1.0 op_sel_hi:[1,0]
  v_pk_add_f32 v[142:143], v[142:143], 1.0 op_sel_hi:[1,0]
  v_rcp_f32 v136, v136
  v_rcp_f32 v137, v137
  v_rcp_f32 v138, v138
  v_rcp_f32 v139, v139
  v_rcp_f32 v140, v140
  v_rcp_f32 v141, v141
  v_rcp_f32 v142, v142
  v_rcp_f32 v143, v143
  v_pk_mul_f32 v[136:137], v[136:137], v[80:81]
  v_pk_mul_f32 v[138:139], v[138:139], v[82:83]
  v_pk_mul_f32 v[140:141], v[140:141], v[92:93]
  v_pk_mul_f32 v[142:143], v[142:143], v[94:95]
  v_cvt_pk_bf16_f32 v144, v136, v137
  v_cvt_pk_bf16_f32 v145, v138, v139
  v_cvt_pk_bf16_f32 v146, v140, v141
  v_cvt_pk_bf16_f32 v147, v142, v143
  buffer_store_dwordx4 v[144:147], v15, s[16:19], 0 offen offset:1024 sc1
  v_pk_mul_f32 v[124:125], v[84:85], v[84:85]
  v_pk_mul_f32 v[126:127], v[86:87], v[86:87]
  v_pk_mul_f32 v[128:129], v[96:97], v[96:97]
  v_pk_mul_f32 v[130:131], v[98:99], v[98:99]
  v_pk_fma_f32 v[124:125], v[124:125], s[42:43], v[20:21]
  v_pk_fma_f32 v[126:127], v[126:127], s[42:43], v[20:21]
  v_pk_fma_f32 v[128:129], v[128:129], s[42:43], v[20:21]
  v_pk_fma_f32 v[130:131], v[130:131], s[42:43], v[20:21]
  v_pk_mul_f32 v[124:125], v[124:125], v[84:85]
  v_pk_mul_f32 v[126:127], v[126:127], v[86:87]
  v_pk_mul_f32 v[128:129], v[128:129], v[96:97]
  v_pk_mul_f32 v[130:131], v[130:131], v[98:99]
  v_exp_f32 v124, v124
  v_exp_f32 v125, v125
  v_exp_f32 v126, v126
  v_exp_f32 v127, v127
  v_exp_f32 v128, v128
  v_exp_f32 v129, v129
  v_exp_f32 v130, v130
  v_exp_f32 v131, v131
  v_pk_add_f32 v[124:125], v[124:125], 1.0 op_sel_hi:[1,0]
  v_pk_add_f32 v[126:127], v[126:127], 1.0 op_sel_hi:[1,0]
  v_pk_add_f32 v[128:129], v[128:129], 1.0 op_sel_hi:[1,0]
  v_pk_add_f32 v[130:131], v[130:131], 1.0 op_sel_hi:[1,0]
  v_rcp_f32 v124, v124
  v_rcp_f32 v125, v125
  v_rcp_f32 v126, v126
  v_rcp_f32 v127, v127
  v_rcp_f32 v128, v128
  v_rcp_f32 v129, v129
  v_rcp_f32 v130, v130
  v_rcp_f32 v131, v131
  v_pk_mul_f32 v[124:125], v[124:125], v[84:85]
  v_pk_mul_f32 v[126:127], v[126:127], v[86:87]
  v_pk_mul_f32 v[128:129], v[128:129], v[96:97]
  v_pk_mul_f32 v[130:131], v[130:131], v[98:99]
  v_cvt_pk_bf16_f32 v132, v124, v125
  v_cvt_pk_bf16_f32 v133, v126, v127
  v_cvt_pk_bf16_f32 v134, v128, v129
  v_cvt_pk_bf16_f32 v135, v130, v131
  buffer_store_dwordx4 v[132:135], v16, s[16:19], 0 offen offset:2048 sc1
  v_pk_mul_f32 v[136:137], v[100:101], v[100:101]
  v_pk_mul_f32 v[138:139], v[102:103], v[102:103]
  v_pk_mul_f32 v[140:141], v[112:113], v[112:113]
  v_pk_mul_f32 v[142:143], v[114:115], v[114:115]
  v_pk_fma_f32 v[136:137], v[136:137], s[42:43], v[20:21]
  v_pk_fma_f32 v[138:139], v[138:139], s[42:43], v[20:21]
  v_pk_fma_f32 v[140:141], v[140:141], s[42:43], v[20:21]
  v_pk_fma_f32 v[142:143], v[142:143], s[42:43], v[20:21]
  v_pk_mul_f32 v[136:137], v[136:137], v[100:101]
  v_pk_mul_f32 v[138:139], v[138:139], v[102:103]
  v_pk_mul_f32 v[140:141], v[140:141], v[112:113]
  v_pk_mul_f32 v[142:143], v[142:143], v[114:115]
  v_exp_f32 v136, v136
  v_exp_f32 v137, v137
  v_exp_f32 v138, v138
  v_exp_f32 v139, v139
  v_exp_f32 v140, v140
  v_exp_f32 v141, v141
  v_exp_f32 v142, v142
  v_exp_f32 v143, v143
  v_pk_add_f32 v[136:137], v[136:137], 1.0 op_sel_hi:[1,0]
  v_pk_add_f32 v[138:139], v[138:139], 1.0 op_sel_hi:[1,0]
  v_pk_add_f32 v[140:141], v[140:141], 1.0 op_sel_hi:[1,0]
  v_pk_add_f32 v[142:143], v[142:143], 1.0 op_sel_hi:[1,0]
  v_rcp_f32 v136, v136
  v_rcp_f32 v137, v137
  v_rcp_f32 v138, v138
  v_rcp_f32 v139, v139
  v_rcp_f32 v140, v140
  v_rcp_f32 v141, v141
  v_rcp_f32 v142, v142
  v_rcp_f32 v143, v143
  v_pk_mul_f32 v[136:137], v[136:137], v[100:101]
  v_pk_mul_f32 v[138:139], v[138:139], v[102:103]
  v_pk_mul_f32 v[140:141], v[140:141], v[112:113]
  v_pk_mul_f32 v[142:143], v[142:143], v[114:115]
  v_cvt_pk_bf16_f32 v144, v136, v137
  v_cvt_pk_bf16_f32 v145, v138, v139
  v_cvt_pk_bf16_f32 v146, v140, v141
  v_cvt_pk_bf16_f32 v147, v142, v143
  buffer_store_dwordx4 v[144:147], v14, s[16:19], s36 offen offset:0 sc1
  v_pk_mul_f32 v[124:125], v[104:105], v[104:105]
  v_pk_mul_f32 v[126:127], v[106:107], v[106:107]
  v_pk_mul_f32 v[128:129], v[116:117], v[116:117]
  v_pk_mul_f32 v[130:131], v[118:119], v[118:119]
  v_pk_fma_f32 v[124:125], v[124:125], s[42:43], v[20:21]
  v_pk_fma_f32 v[126:127], v[126:127], s[42:43], v[20:21]
  v_pk_fma_f32 v[128:129], v[128:129], s[42:43], v[20:21]
  v_pk_fma_f32 v[130:131], v[130:131], s[42:43], v[20:21]
  v_pk_mul_f32 v[124:125], v[124:125], v[104:105]
  v_pk_mul_f32 v[126:127], v[126:127], v[106:107]
  v_pk_mul_f32 v[128:129], v[128:129], v[116:117]
  v_pk_mul_f32 v[130:131], v[130:131], v[118:119]
  v_exp_f32 v124, v124
  v_exp_f32 v125, v125
  v_exp_f32 v126, v126
  v_exp_f32 v127, v127
  v_exp_f32 v128, v128
  v_exp_f32 v129, v129
  v_exp_f32 v130, v130
  v_exp_f32 v131, v131
  v_pk_add_f32 v[124:125], v[124:125], 1.0 op_sel_hi:[1,0]
  v_pk_add_f32 v[126:127], v[126:127], 1.0 op_sel_hi:[1,0]
  v_pk_add_f32 v[128:129], v[128:129], 1.0 op_sel_hi:[1,0]
  v_pk_add_f32 v[130:131], v[130:131], 1.0 op_sel_hi:[1,0]
  v_rcp_f32 v124, v124
  v_rcp_f32 v125, v125
  v_rcp_f32 v126, v126
  v_rcp_f32 v127, v127
  v_rcp_f32 v128, v128
  v_rcp_f32 v129, v129
  v_rcp_f32 v130, v130
  v_rcp_f32 v131, v131
  v_pk_mul_f32 v[124:125], v[124:125], v[104:105]
  v_pk_mul_f32 v[126:127], v[126:127], v[106:107]
  v_pk_mul_f32 v[128:129], v[128:129], v[116:117]
  v_pk_mul_f32 v[130:131], v[130:131], v[118:119]
  v_cvt_pk_bf16_f32 v132, v124, v125
  v_cvt_pk_bf16_f32 v133, v126, v127
  v_cvt_pk_bf16_f32 v134, v128, v129
  v_cvt_pk_bf16_f32 v135, v130, v131
  buffer_store_dwordx4 v[132:135], v15, s[16:19], s36 offen offset:1024 sc1
  v_pk_mul_f32 v[136:137], v[108:109], v[108:109]
  v_pk_mul_f32 v[138:139], v[110:111], v[110:111]
  v_pk_mul_f32 v[140:141], v[120:121], v[120:121]
  v_pk_mul_f32 v[142:143], v[122:123], v[122:123]
  v_pk_fma_f32 v[136:137], v[136:137], s[42:43], v[20:21]
  v_pk_fma_f32 v[138:139], v[138:139], s[42:43], v[20:21]
  v_pk_fma_f32 v[140:141], v[140:141], s[42:43], v[20:21]
  v_pk_fma_f32 v[142:143], v[142:143], s[42:43], v[20:21]
  v_pk_mul_f32 v[136:137], v[136:137], v[108:109]
  v_pk_mul_f32 v[138:139], v[138:139], v[110:111]
  v_pk_mul_f32 v[140:141], v[140:141], v[120:121]
  v_pk_mul_f32 v[142:143], v[142:143], v[122:123]
  v_exp_f32 v136, v136
  v_exp_f32 v137, v137
  v_exp_f32 v138, v138
  v_exp_f32 v139, v139
  v_exp_f32 v140, v140
  v_exp_f32 v141, v141
  v_exp_f32 v142, v142
  v_exp_f32 v143, v143
  v_pk_add_f32 v[136:137], v[136:137], 1.0 op_sel_hi:[1,0]
  v_pk_add_f32 v[138:139], v[138:139], 1.0 op_sel_hi:[1,0]
  v_pk_add_f32 v[140:141], v[140:141], 1.0 op_sel_hi:[1,0]
  v_pk_add_f32 v[142:143], v[142:143], 1.0 op_sel_hi:[1,0]
  v_rcp_f32 v136, v136
  v_rcp_f32 v137, v137
  v_rcp_f32 v138, v138
  v_rcp_f32 v139, v139
  v_rcp_f32 v140, v140
  v_rcp_f32 v141, v141
  v_rcp_f32 v142, v142
  v_rcp_f32 v143, v143
  v_pk_mul_f32 v[136:137], v[136:137], v[108:109]
  v_pk_mul_f32 v[138:139], v[138:139], v[110:111]
  v_pk_mul_f32 v[140:141], v[140:141], v[120:121]
  v_pk_mul_f32 v[142:143], v[142:143], v[122:123]
  v_cvt_pk_bf16_f32 v144, v136, v137
  v_cvt_pk_bf16_f32 v145, v138, v139
  v_cvt_pk_bf16_f32 v146, v140, v141
  v_cvt_pk_bf16_f32 v147, v142, v143
  buffer_store_dwordx4 v[144:147], v16, s[16:19], s36 offen offset:2048 sc1
  s_waitcnt vmcnt(0)
  s_barrier
L_cg4_3103:
  s_bfe_u32 s24, s2, 0x20001
  s_and_b32 s25, s2, 1
  s_lshl_b32 s25, s25, 3
  s_lshr_b32 s35, s2, 5
  s_add_u32 s25, s25, s35
  s_bfe_u32 s26, s2, 0x20003
  s_and_b32 s27, s3, 3
  s_mov_b32 s32, 0
  s_mov_b32 s33, 0
  s_lshr_b32 s38, s24, 1
  s_and_b32 s39, s24, 1
  s_mul_i32 s39, s39, 5
  v_lshrrev_b32 v3, 4, v1
  v_and_b32 v4, 15, v1
  s_lshl_b32 s35, s25, 2
  s_add_u32 s35, s35, s27
  s_lshl_b32 s36, s35, 1
  s_add_u32 s36, s36, s38
  s_lshl_b32 s36, s36, 4
  v_add_u32 v4, s36, v4
  s_mul_i32 s36, s26, 9
  s_add_u32 s36, s36, s39
  s_mul_i32 s31, s35, 43008
  v_and_b32 v49, 7, v1
  v_lshrrev_b32 v2, 3, v1
  v_lshl_add_u32 v49, v49, 4, s31
  s_lshl_b32 s31, s36, 3
  v_add_u32 v2, s31, v2
  v_add_u32 v24, 4, v2
  v_mul_u32_u24 v24, 9363, v24
  v_lshrrev_b32 v24, 16, v24
  v_add3_u32 v24, v24, v2, 0
  v_lshl_add_u32 v24, v24, 7, v49
  v_add_u32 v28, 12, v2
  v_mul_u32_u24 v28, 9363, v28
  v_lshrrev_b32 v28, 16, v28
  v_add3_u32 v28, v28, v2, 8
  v_lshl_add_u32 v28, v28, 7, v49
  v_add_u32 v32, 20, v2
  v_mul_u32_u24 v32, 9363, v32
  v_lshrrev_b32 v32, 16, v32
  v_add3_u32 v32, v32, v2, 16
  v_lshl_add_u32 v32, v32, 7, v49
  v_add_u32 v36, 28, v2
  v_mul_u32_u24 v36, 9363, v36
  v_lshrrev_b32 v36, 16, v36
  v_add3_u32 v36, v36, v2, 24
  v_lshl_add_u32 v36, v36, 7, v49
  v_add_u32 v40, 36, v2
  v_mul_u32_u24 v40, 9363, v40
  v_lshrrev_b32 v40, 16, v40
  v_add3_u32 v40, v40, v2, 32
  v_lshl_add_u32 v40, v40, 7, v49
  s_add_u32 s44, s84, 12582912
  s_addc_u32 s45, s85, 0
  s_mov_b32 s46, 16384
  s_mov_b32 s47, 0x20000
  v_lshlrev_b32 v2, 3, v4
  buffer_load_dwordx2 v[18:19], v2, s[44:47], 0 offen sc1
  s_mov_b32 s20, s78
  s_mov_b32 s21, s79
  s_mov_b32 s22, 4096
  s_mov_b32 s23, 0x20000
  v_lshlrev_b32 v2, 1, v4
  buffer_load_ushort v20, v2, s[20:23], 0 offen
  s_add_u32 s12, s84, 33554432
  s_addc_u32 s13, s85, 0
  s_mov_b32 s14, 2752512
  s_mov_b32 s15, 0x20000
  s_mov_b32 s20, s80
  s_mov_b32 s21, s81
  s_mov_b32 s22, 2359296
  s_mov_b32 s23, 0x20000
  s_add_u32 s16, s84, 12599296
  s_addc_u32 s17, s85, 0
  s_mov_b32 s18, 7864320
  s_mov_b32 s19, 0x20000
  v_mul_u32_u24 v16, 1152, v4
  s_mul_i32 s35, s26, 288
  s_lshl_b32 s36, s39, 5
  s_add_u32 s35, s35, s36
  v_add_u32 v16, s35, v16
  v_lshl_add_u32 v17, v3, 3, v16
  v_and_b32 v2, 1, v3
  v_lshl_add_u32 v16, v2, 5, v16
  v_lshrrev_b32 v2, 1, v3
  v_lshl_add_u32 v16, v2, 4, v16
  s_lshl_b32 s35, s25, 2
  s_add_u32 s35, s35, s26
  s_mul_i32 s35, s35, 48
  s_add_u32 s35, s35, s27
  s_mul_i32 s35, s35, 2560
  v_lshl_add_u32 v14, v1, 4, s35
  s_mul_i32 s36, s24, 30720
  v_add_u32 v15, s36, v14
  v_lshlrev_b32 v8, 4, v1
  v_bfe_u32 v2, v1, 2, 2
  v_lshlrev_b32 v2, 6, v2
  v_lshl_add_u32 v2, v3, 10, v2
  v_and_b32 v4, 3, v1
  v_lshl_add_u32 v2, v4, 3, v2
  s_lshl_b32 s35, s27, 8
  v_add_u32 v2, s35, v2
  v_and_b32 v4, 1, v3
  v_lshl_add_u32 v9, v4, 5, v2
  v_xor_b32 v10, 32, v9
  v_mov_b32 v11, v8
  v_mov_b32 v12, v9
  v_mov_b32 v13, v10
  s_mov_b32 s31, 0
  v_and_b32 v2, 15, v1
  v_lshlrev_b32 v3, 2, v3
  v_sub_u32 v2, v2, v3
  v_mov_b32 v4, 0x3f80
  v_cmp_eq_u32 s[48:49], 0, v2
  v_cmp_eq_u32 s[50:51], 2, v2
  v_cmp_eq_u32 s[52:53], 1, v2
  v_cmp_eq_u32 s[54:55], 3, v2
  v_mov_b32 v3, 0x3f800000
  v_cndmask_b32 v208, 0, v4, s[48:49]
  v_cndmask_b32 v209, 0, v4, s[50:51]
  v_cndmask_b32 v208, v208, v3, s[52:53]
  v_cndmask_b32 v209, v209, v3, s[54:55]
  v_mov_b32 v206, 0
  v_mov_b32 v207, 0
  v_mov_b32 v210, 0
  v_mov_b32 v211, 0
  v_mov_b32 v124, 0
  v_mov_b32 v125, 0
  v_mov_b32 v126, 0
  v_mov_b32 v127, 0
  v_mov_b32 v128, 0
  v_mov_b32 v129, 0
  v_mov_b32 v130, 0
  v_mov_b32 v131, 0
  v_mov_b32 v80, 0
  v_mov_b32 v81, 0
  v_mov_b32 v82, 0
  v_mov_b32 v83, 0
  v_mov_b32 v84, 0
  v_mov_b32 v85, 0
  v_mov_b32 v86, 0
  v_mov_b32 v87, 0
  v_mov_b32 v88, 0
  v_mov_b32 v89, 0
  v_mov_b32 v90, 0
  v_mov_b32 v91, 0
  v_mov_b32 v92, 0
  v_mov_b32 v93, 0
  v_mov_b32 v94, 0
  v_mov_b32 v95, 0
  v_mov_b32 v96, 0
  v_mov_b32 v97, 0
  v_mov_b32 v98, 0
  v_mov_b32 v99, 0
  v_mov_b32 v100, 0
  v_mov_b32 v101, 0
  v_mov_b32 v102, 0
  v_mov_b32 v103, 0
  v_mov_b32 v104, 0
  v_mov_b32 v105, 0
  v_mov_b32 v106, 0
  v_mov_b32 v107, 0
  v_mov_b32 v108, 0
  v_mov_b32 v109, 0
  v_mov_b32 v110, 0
  v_mov_b32 v111, 0
  v_mov_b32 v112, 0
  v_mov_b32 v113, 0
  v_mov_b32 v114, 0
  v_mov_b32 v115, 0
  v_mov_b32 v132, 0
  v_mov_b32 v133, 0
  v_mov_b32 v134, 0
  v_mov_b32 v135, 0
  v_mov_b32 v136, 0
  v_mov_b32 v137, 0
  v_mov_b32 v138, 0
  v_mov_b32 v139, 0
  v_mov_b32 v140, 0
  v_mov_b32 v141, 0
  v_mov_b32 v142, 0
  v_mov_b32 v143, 0
  v_mov_b32 v144, 0
  v_mov_b32 v145, 0
  v_mov_b32 v146, 0
  v_mov_b32 v147, 0
  v_mov_b32 v148, 0
  v_mov_b32 v149, 0
  v_mov_b32 v150, 0
  v_mov_b32 v151, 0
  v_mov_b32 v152, 0
  v_mov_b32 v153, 0
  v_mov_b32 v154, 0
  v_mov_b32 v155, 0
  v_mov_b32 v156, 0
  v_mov_b32 v157, 0
  v_mov_b32 v158, 0
  v_mov_b32 v159, 0
  v_mov_b32 v160, 0
  v_mov_b32 v161, 0
  v_mov_b32 v162, 0
  v_mov_b32 v163, 0
  v_mov_b32 v164, 0
  v_mov_b32 v165, 0
  v_mov_b32 v166, 0
  v_mov_b32 v167, 0
  v_mov_b32 v168, 0
  v_mov_b32 v169, 0
  v_mov_b32 v170, 0
  v_mov_b32 v171, 0
  v_mov_b32 v172, 0
  v_mov_b32 v173, 0
  v_mov_b32 v174, 0
  v_mov_b32 v175, 0
  v_mov_b32 v176, 0
  v_mov_b32 v177, 0
  v_mov_b32 v178, 0
  v_mov_b32 v179, 0
  v_mov_b32 v180, 0
  v_mov_b32 v181, 0
  v_mov_b32 v182, 0
  v_mov_b32 v183, 0
  v_mov_b32 v184, 0
  v_mov_b32 v185, 0
  v_mov_b32 v186, 0
  v_mov_b32 v187, 0
  v_mov_b32 v188, 0
  v_mov_b32 v189, 0
  v_mov_b32 v190, 0
  v_mov_b32 v191, 0
  v_mov_b32 v192, 0
  v_mov_b32 v193, 0
  v_mov_b32 v194, 0
  v_mov_b32 v195, 0
  v_mov_b32 v196, 0
  v_mov_b32 v197, 0
  v_mov_b32 v198, 0
  v_mov_b32 v199, 0
  v_mov_b32 v200, 0
  v_mov_b32 v201, 0
  v_mov_b32 v202, 0
  v_mov_b32 v203, 0
  s_cmp_lg_u32 s3, 0
  s_cbranch_scc1 L_nw4_3174
  s_add_u32 s52, s84, 20463616
  s_addc_u32 s53, s85, 0
  s_mov_b32 s54, 45056
  s_mov_b32 s55, 0x20000
  s_and_b32 s56, s2, 1
  s_mul_i32 s58, s56, 24
  s_mul_i32 s56, s26, 3
  s_lshr_b32 s56, s56, 1
  s_mul_i32 s57, s24, 6
  s_add_u32 s56, s56, s57
  s_add_u32 s56, s56, s58
  s_add_u32 s56, s56, 256
  v_cmp_gt_u32 vcc, 2, v1
  v_add_u32 v2, s56, v1
  v_add_u32 v4, 302, v1
  v_cndmask_b32 v2, v4, v2, vcc
  v_mov_b32 v3, 5
  v_mov_b32 v5, 0x207
  v_cndmask_b32 v3, v3, v5, vcc
  v_lshlrev_b32 v2, 7, v2
  s_mov_b32 exec_lo, 0x3ff
  s_mov_b32 exec_hi, 0
  s_mov_b32 s56, 0
L_poll_3175:
  buffer_load_dword v4, v2, s[52:55], 0 offen sc1
  s_add_u32 s56, s56, 1
  s_waitcnt vmcnt(0)
  v_and_b32 v5, 65280, v4
  v_cmp_ne_u32 vcc, 512, v5
  s_cmp_gt_u32 s56, 262144
  s_cbranch_scc1 L_got_3176
  s_and_b32 s57, vcc_lo, 3
  s_cbranch_scc0 L_got_3176
  s_sleep 1
  s_branch L_poll_3175
L_got_3176:
  s_mov_b64 exec, -1
L_nw4_3174:
  s_barrier
  s_cmp_lg_u32 s3, 0
  s_cbranch_scc1 L_nw4_3177
  s_mov_b32 exec_lo, 0x3ff
  s_mov_b32 exec_hi, 0
  v_cmp_ne_u32 vcc, v4, v3
  s_mov_b64 exec, -1
  s_cbranch_vccz L_gotb_3178
  s_add_u32 s52, s84, 20463616
  s_addc_u32 s53, s85, 0
  s_mov_b32 s54, 45056
  s_mov_b32 s55, 0x20000
  s_mov_b32 exec_lo, 0x3ff
  s_mov_b32 exec_hi, 0
  s_mov_b32 s56, 0
L_poll_3179:
  buffer_load_dword v4, v2, s[52:55], 0 offen sc1
  s_add_u32 s56, s56, 1
  s_waitcnt vmcnt(0)
  v_cmp_ne_u32 vcc, v4, v3
  s_cmp_gt_u32 s56, 262144
  s_cbranch_scc1 L_got_3180
  s_cbranch_vccz L_got_3180
  s_sleep 1
  s_branch L_poll_3179
L_got_3180:
  s_mov_b64 exec, -1
L_gotb_3178:
L_nw4_3177:
  .p2align 6
L_k_3181:
  s_waitcnt lgkmcnt(0)
  s_barrier
  v_mfma_f32_16x16x32_bf16 v[132:135], v[80:83], v[124:127], v[132:135]
  ds_read_b64_tr_b16 v[116:117], v12 offset:18432
  v_mfma_f32_16x16x32_bf16 v[168:171], v[80:83], v[128:131], v[168:171]
  ds_read_b64_tr_b16 v[118:119], v12 offset:22528
  v_mfma_f32_16x16x32_bf16 v[136:139], v[84:87], v[124:127], v[136:139]
  ds_read_b64_tr_b16 v[120:121], v13 offset:18432
  v_mfma_f32_16x16x32_bf16 v[172:175], v[84:87], v[128:131], v[172:175]
  ds_read_b64_tr_b16 v[122:123], v13 offset:22528
  v_mfma_f32_16x16x32_bf16 v[140:143], v[88:91], v[124:127], v[140:143]
  ds_read_b128 v[44:47], v11 offset:0
  v_mfma_f32_16x16x32_bf16 v[176:179], v[88:91], v[128:131], v[176:179]
  ds_read_b128 v[48:51], v11 offset:1024
  v_mfma_f32_16x16x32_bf16 v[144:147], v[92:95], v[124:127], v[144:147]
  ds_read_b128 v[52:55], v11 offset:2048
  v_mfma_f32_16x16x32_bf16 v[180:183], v[92:95], v[128:131], v[180:183]
  ds_read_b128 v[56:59], v11 offset:3072
  v_mfma_f32_16x16x32_bf16 v[148:151], v[96:99], v[124:127], v[148:151]
  ds_read_b128 v[60:63], v11 offset:4096
  v_mfma_f32_16x16x32_bf16 v[184:187], v[96:99], v[128:131], v[184:187]
  ds_read_b128 v[64:67], v11 offset:5120
  v_mfma_f32_16x16x32_bf16 v[152:155], v[100:103], v[124:127], v[152:155]
  ds_read_b128 v[68:71], v11 offset:6144
  v_mfma_f32_16x16x32_bf16 v[188:191], v[100:103], v[128:131], v[188:191]
  ds_read_b128 v[72:75], v11 offset:7168
  v_mfma_f32_16x16x32_bf16 v[156:159], v[104:107], v[124:127], v[156:159]
  ds_read_b128 v[76:79], v11 offset:8192
  v_mfma_f32_16x16x32_bf16 v[192:195], v[104:107], v[128:131], v[192:195]
  v_mfma_f32_16x16x32_bf16 v[160:163], v[108:111], v[124:127], v[160:163]
  v_mfma_f32_16x16x32_bf16 v[196:199], v[108:111], v[128:131], v[196:199]
  v_mfma_f32_16x16x32_bf16 v[164:167], v[112:115], v[124:127], v[164:167]
  v_mfma_f32_16x16x32_bf16 v[200:203], v[112:115], v[128:131], v[200:203]
  s_waitcnt lgkmcnt(0)
  v_mfma_f32_16x16x32_bf16 v[132:135], v[44:47], v[116:119], v[132:135]
  ds_read_b64_tr_b16 v[124:125], v12 offset:26624
  v_mfma_f32_16x16x32_bf16 v[168:171], v[44:47], v[120:123], v[168:171]
  ds_read_b64_tr_b16 v[126:127], v12 offset:30720
  v_mfma_f32_16x16x32_bf16 v[136:139], v[48:51], v[116:119], v[136:139]
  ds_read_b64_tr_b16 v[128:129], v13 offset:26624
  v_mfma_f32_16x16x32_bf16 v[172:175], v[48:51], v[120:123], v[172:175]
  ds_read_b64_tr_b16 v[130:131], v13 offset:30720
  v_mfma_f32_16x16x32_bf16 v[140:143], v[52:55], v[116:119], v[140:143]
  ds_read_b128 v[80:83], v11 offset:9216
  v_mfma_f32_16x16x32_bf16 v[176:179], v[52:55], v[120:123], v[176:179]
  ds_read_b128 v[84:87], v11 offset:10240
  v_mfma_f32_16x16x32_bf16 v[144:147], v[56:59], v[116:119], v[144:147]
  ds_read_b128 v[88:91], v11 offset:11264
  v_mfma_f32_16x16x32_bf16 v[180:183], v[56:59], v[120:123], v[180:183]
  ds_read_b128 v[92:95], v11 offset:12288
  v_mfma_f32_16x16x32_bf16 v[148:151], v[60:63], v[116:119], v[148:151]
  ds_read_b128 v[96:99], v11 offset:13312
  v_mfma_f32_16x16x32_bf16 v[184:187], v[60:63], v[120:123], v[184:187]
  ds_read_b128 v[100:103], v11 offset:14336
  v_mfma_f32_16x16x32_bf16 v[152:155], v[64:67], v[116:119], v[152:155]
  ds_read_b128 v[104:107], v11 offset:15360
  v_mfma_f32_16x16x32_bf16 v[188:191], v[64:67], v[120:123], v[188:191]
  ds_read_b128 v[108:111], v11 offset:16384
  v_mfma_f32_16x16x32_bf16 v[156:159], v[68:71], v[116:119], v[156:159]
  ds_read_b128 v[112:115], v11 offset:17408
  v_mfma_f32_16x16x32_bf16 v[192:195], v[68:71], v[120:123], v[192:195]
  s_add_u32 s31, s31, 34816
  s_cmp_eq_u32 s31, 139264
  v_mfma_f32_16x16x32_bf16 v[160:163], v[72:75], v[116:119], v[160:163]
  s_cselect_b32 s31, 0, s31
  s_add_u32 s33, s33, 1
  v_mfma_f32_16x16x32_bf16 v[196:199], v[72:75], v[120:123], v[196:199]
  v_add_u32 v11, s31, v8
  v_add_u32 v12, s31, v9
  v_mfma_f32_16x16x32_bf16 v[164:167], v[76:79], v[116:119], v[164:167]
  v_add_u32 v13, s31, v10
  s_cmp_lt_u32 s33, 14
  v_mfma_f32_16x16x32_bf16 v[200:203], v[76:79], v[120:123], v[200:203]
  s_cbranch_scc1 L_k_3181
L_p4e:
  v_add_u32 v11, 69632, v8
  v_add_u32 v12, 88064, v9
  v_add_u32 v9, 18432, v9
  v_add_u32 v13, 88064, v10
  v_add_u32 v10, 18432, v10
  s_cmp_eq_u32 s24, 1
  s_cbranch_scc1 L_q1_3184
  s_cmp_eq_u32 s24, 2
  s_cbranch_scc1 L_q2_3185
  s_cmp_eq_u32 s24, 3
  s_cbranch_scc1 L_q3_3186
L_q0_3183:
L_x0:
  v_lshlrev_b32 v2, 3, v1
  v_sub_u32 v3, v15, v2
  v_sub_u32 v2, v14, v2
  s_mov_b32 s35, 51200
  s_mov_b32 s36, 71680
  s_mov_b32 s31, 92160
  s_waitcnt lgkmcnt(0)
  s_barrier
  v_mfma_f32_16x16x32_bf16 v[132:135], v[80:83], v[124:127], v[132:135]
  v_mfma_f32_16x16x32_bf16 v[168:171], v[80:83], v[128:131], v[168:171]
  v_mfma_f32_16x16x32_bf16 v[136:139], v[84:87], v[124:127], v[136:139]
  v_mfma_f32_16x16x32_bf16 v[172:175], v[84:87], v[128:131], v[172:175]
  v_mfma_f32_16x16x32_bf16 v[140:143], v[88:91], v[124:127], v[140:143]
  v_mfma_f32_16x16x32_bf16 v[176:179], v[88:91], v[128:131], v[176:179]
  v_mfma_f32_16x16x32_bf16 v[144:147], v[92:95], v[124:127], v[144:147]
  v_mfma_f32_16x16x32_bf16 v[180:183], v[92:95], v[128:131], v[180:183]
  v_mfma_f32_16x16x32_bf16 v[148:151], v[96:99], v[124:127], v[148:151]
  ds_read_b64_tr_b16 v[116:117], v13 offset:0
  ds_read_b64_tr_b16 v[118:119], v13 offset:4096
  v_mfma_f32_16x16x32_bf16 v[184:187], v[96:99], v[128:131], v[184:187]
  ds_read_b128 v[44:47], v11 offset:5120
  ds_read_b64_tr_b16 v[120:121], v12 offset:0
  ds_read_b64_tr_b16 v[122:123], v12 offset:4096
  v_mfma_f32_16x16x32_bf16 v[152:155], v[100:103], v[124:127], v[152:155]
  ds_read_b128 v[48:51], v11 offset:6144
  v_mfma_f32_16x16x32_bf16 v[188:191], v[100:103], v[128:131], v[188:191]
  v_mfma_f32_16x16x32_bf16 v[156:159], v[104:107], v[124:127], v[156:159]
  ds_read_b128 v[52:55], v11 offset:7168
  v_mfma_f32_16x16x32_bf16 v[192:195], v[104:107], v[128:131], v[192:195]
  v_mfma_f32_16x16x32_bf16 v[160:163], v[108:111], v[124:127], v[160:163]
  ds_read_b128 v[56:59], v11 offset:8192
  v_mfma_f32_16x16x32_bf16 v[196:199], v[108:111], v[128:131], v[196:199]
  v_mfma_f32_16x16x32_bf16 v[164:167], v[112:115], v[124:127], v[164:167]
  ds_read_b64_tr_b16 v[212:213], v13 offset:8192
  ds_read_b64_tr_b16 v[214:215], v13 offset:12288
  v_mfma_f32_16x16x32_bf16 v[200:203], v[112:115], v[128:131], v[200:203]
  ds_read_b128 v[60:63], v11 offset:14336
  ds_read_b64_tr_b16 v[216:217], v12 offset:8192
  ds_read_b64_tr_b16 v[218:219], v12 offset:12288
  s_waitcnt lgkmcnt(10)
  v_mfma_f32_16x16x32_bf16 v[188:191], v[44:47], v[116:119], v[188:191]
  ds_read_b128 v[64:67], v11 offset:15360
  s_waitcnt lgkmcnt(9)
  v_mfma_f32_16x16x32_bf16 v[152:155], v[44:47], v[120:123], v[152:155]
  s_waitcnt lgkmcnt(8)
  v_mfma_f32_16x16x32_bf16 v[192:195], v[48:51], v[116:119], v[192:195]
  ds_read_b128 v[68:71], v11 offset:16384
  v_mfma_f32_16x16x32_bf16 v[156:159], v[48:51], v[120:123], v[156:159]
  s_waitcnt lgkmcnt(8)
  v_mfma_f32_16x16x32_bf16 v[196:199], v[52:55], v[116:119], v[196:199]
  ds_read_b128 v[72:75], v11 offset:17408
  v_mfma_f32_16x16x32_bf16 v[160:163], v[52:55], v[120:123], v[160:163]
  s_waitcnt lgkmcnt(8)
  v_mfma_f32_16x16x32_bf16 v[200:203], v[56:59], v[116:119], v[200:203]
  s_barrier
  ds_read_b64_tr_b16 v[220:221], v13 offset:34816
  ds_read_b64_tr_b16 v[222:223], v13 offset:38912
  v_mfma_f32_16x16x32_bf16 v[164:167], v[56:59], v[120:123], v[164:167]
  ds_read_b128 v[76:79], v11 offset:39936
  ds_read_b64_tr_b16 v[224:225], v12 offset:34816
  ds_read_b64_tr_b16 v[226:227], v12 offset:38912
  s_waitcnt lgkmcnt(10)
  v_mfma_f32_16x16x32_bf16 v[188:191], v[60:63], v[212:215], v[188:191]
  ds_read_b128 v[240:243], v11 offset:40960
  s_waitcnt lgkmcnt(9)
  v_mfma_f32_16x16x32_bf16 v[152:155], v[60:63], v[216:219], v[152:155]
  s_waitcnt lgkmcnt(8)
  v_mfma_f32_16x16x32_bf16 v[192:195], v[64:67], v[212:215], v[192:195]
  ds_read_b128 v[244:247], v11 offset:41984
  v_mfma_f32_16x16x32_bf16 v[156:159], v[64:67], v[216:219], v[156:159]
  s_waitcnt lgkmcnt(8)
  v_mfma_f32_16x16x32_bf16 v[196:199], v[68:71], v[212:215], v[196:199]
  ds_read_b128 v[80:83], v11 offset:43008
  v_mfma_f32_16x16x32_bf16 v[160:163], v[68:71], v[216:219], v[160:163]
  s_waitcnt lgkmcnt(8)
  v_mfma_f32_16x16x32_bf16 v[200:203], v[72:75], v[212:215], v[200:203]
  ds_read_b64_tr_b16 v[124:125], v13 offset:43008
  ds_read_b64_tr_b16 v[126:127], v13 offset:47104
  v_mfma_f32_16x16x32_bf16 v[164:167], v[72:75], v[216:219], v[164:167]
  ds_read_b128 v[84:87], v11 offset:49152
  ds_read_b64_tr_b16 v[128:129], v12 offset:43008
  ds_read_b64_tr_b16 v[130:131], v12 offset:47104
  s_waitcnt lgkmcnt(10)
  v_mfma_f32_16x16x32_bf16 v[188:191], v[76:79], v[220:223], v[188:191]
  ds_read_b128 v[88:91], v11 offset:50176
  s_waitcnt lgkmcnt(9)
  v_mfma_f32_16x16x32_bf16 v[152:155], v[76:79], v[224:227], v[152:155]
  s_waitcnt lgkmcnt(8)
  v_mfma_f32_16x16x32_bf16 v[192:195], v[240:243], v[220:223], v[192:195]
  ds_read_b128 v[92:95], v11 offset:51200
  v_mfma_f32_16x16x32_bf16 v[156:159], v[240:243], v[224:227], v[156:159]
  s_waitcnt lgkmcnt(8)
  v_mfma_f32_16x16x32_bf16 v[196:199], v[244:247], v[220:223], v[196:199]
  ds_read_b128 v[96:99], v11 offset:52224
  v_mfma_f32_16x16x32_bf16 v[160:163], v[244:247], v[224:227], v[160:163]
  s_waitcnt lgkmcnt(8)
  v_mfma_f32_16x16x32_bf16 v[200:203], v[80:83], v[220:223], v[200:203]
  s_barrier
  ds_read_b64_tr_b16 v[116:117], v10 offset:0
  ds_read_b64_tr_b16 v[118:119], v10 offset:4096
  v_mfma_f32_16x16x32_bf16 v[164:167], v[80:83], v[224:227], v[164:167]
  ds_read_b128 v[100:103], v8 offset:5120
  ds_read_b64_tr_b16 v[120:121], v9 offset:0
  ds_read_b64_tr_b16 v[122:123], v9 offset:4096
  s_waitcnt lgkmcnt(10)
  v_mfma_f32_16x16x32_bf16 v[188:191], v[84:87], v[124:127], v[188:191]
  ds_read_b128 v[104:107], v8 offset:6144
  s_waitcnt lgkmcnt(9)
  v_mfma_f32_16x16x32_bf16 v[152:155], v[84:87], v[128:131], v[152:155]
  buffer_load_dwordx4 v[24:27], v24, s[12:15], 0 offen sc1
  s_waitcnt lgkmcnt(8)
  v_mfma_f32_16x16x32_bf16 v[192:195], v[88:91], v[124:127], v[192:195]
  ds_read_b128 v[108:111], v8 offset:7168
  v_mfma_f32_16x16x32_bf16 v[156:159], v[88:91], v[128:131], v[156:159]
  s_waitcnt lgkmcnt(8)
  v_mfma_f32_16x16x32_bf16 v[196:199], v[92:95], v[124:127], v[196:199]
  buffer_load_dwordx4 v[28:31], v28, s[12:15], 0 offen sc1
  ds_read_b128 v[112:115], v8 offset:8192
  v_mfma_f32_16x16x32_bf16 v[160:163], v[92:95], v[128:131], v[160:163]
  s_waitcnt lgkmcnt(8)
  v_mfma_f32_16x16x32_bf16 v[200:203], v[96:99], v[124:127], v[200:203]
  ds_read_b64_tr_b16 v[212:213], v10 offset:8192
  ds_read_b64_tr_b16 v[214:215], v10 offset:12288
  v_mfma_f32_16x16x32_bf16 v[164:167], v[96:99], v[128:131], v[164:167]
  buffer_load_dwordx4 v[32:35], v32, s[12:15], 0 offen sc1
  ds_read_b128 v[44:47], v8 offset:14336
  ds_read_b64_tr_b16 v[216:217], v9 offset:8192
  ds_read_b64_tr_b16 v[218:219], v9 offset:12288
  s_waitcnt lgkmcnt(10)
  v_mfma_f32_16x16x32_bf16 v[188:191], v[100:103], v[116:119], v[188:191]
  ds_read_b128 v[48:51], v8 offset:15360
  s_waitcnt lgkmcnt(9)
  v_mfma_f32_16x16x32_bf16 v[152:155], v[100:103], v[120:123], v[152:155]
  s_waitcnt lgkmcnt(8)
  v_mfma_f32_16x16x32_bf16 v[192:195], v[104:107], v[116:119], v[192:195]
  buffer_load_dwordx4 v[36:39], v36, s[12:15], 0 offen sc1
  ds_read_b128 v[52:55], v8 offset:16384
  v_mfma_f32_16x16x32_bf16 v[156:159], v[104:107], v[120:123], v[156:159]
  s_waitcnt lgkmcnt(8)
  v_mfma_f32_16x16x32_bf16 v[196:199], v[108:111], v[116:119], v[196:199]
  ds_read_b128 v[56:59], v8 offset:17408
  v_mfma_f32_16x16x32_bf16 v[160:163], v[108:111], v[120:123], v[160:163]
  buffer_load_dwordx4 v[40:43], v40, s[12:15], 0 offen sc1
  s_waitcnt lgkmcnt(8)
  v_mfma_f32_16x16x32_bf16 v[200:203], v[112:115], v[116:119], v[200:203]
  ds_read_b64_tr_b16 v[220:221], v13 offset:0
  ds_read_b64_tr_b16 v[222:223], v13 offset:4096
  v_mfma_f32_16x16x32_bf16 v[164:167], v[112:115], v[120:123], v[164:167]
  ds_read_b128 v[60:63], v11 offset:0
  ds_read_b64_tr_b16 v[224:225], v12 offset:0
  ds_read_b64_tr_b16 v[226:227], v12 offset:4096
  s_waitcnt lgkmcnt(10)
  v_mfma_f32_16x16x32_bf16 v[188:191], v[44:47], v[212:215], v[188:191]
  ds_read_b128 v[64:67], v11 offset:1024
  s_waitcnt lgkmcnt(9)
  v_mfma_f32_16x16x32_bf16 v[152:155], v[44:47], v[216:219], v[152:155]
  s_waitcnt lgkmcnt(8)
  v_mfma_f32_16x16x32_bf16 v[192:195], v[48:51], v[212:215], v[192:195]
  ds_read_b128 v[68:71], v11 offset:2048
  v_mfma_f32_16x16x32_bf16 v[156:159], v[48:51], v[216:219], v[156:159]
  s_waitcnt lgkmcnt(8)
  v_mfma_f32_16x16x32_bf16 v[196:199], v[52:55], v[212:215], v[196:199]
  ds_read_b128 v[72:75], v11 offset:3072
  v_mfma_f32_16x16x32_bf16 v[160:163], v[52:55], v[216:219], v[160:163]
  s_waitcnt lgkmcnt(8)
  v_mfma_f32_16x16x32_bf16 v[200:203], v[56:59], v[212:215], v[200:203]
  ds_read_b128 v[76:79], v11 offset:4096
  v_mfma_f32_16x16x32_bf16 v[164:167], v[56:59], v[216:219], v[164:167]
  s_waitcnt lgkmcnt(6)
  v_mfma_f32_16x16x32_bf16 v[168:171], v[60:63], v[220:223], v[168:171]
  ds_read_b64_tr_b16 v[124:125], v13 offset:8192
  ds_read_b64_tr_b16 v[126:127], v13 offset:12288
  s_waitcnt lgkmcnt(6)
  v_mfma_f32_16x16x32_bf16 v[132:135], v[60:63], v[224:227], v[132:135]
  ds_read_b128 v[240:243], v11 offset:9216
  ds_read_b64_tr_b16 v[128:129], v12 offset:8192
  ds_read_b64_tr_b16 v[130:131], v12 offset:12288
  s_waitcnt lgkmcnt(8)
  v_mfma_f32_16x16x32_bf16 v[172:175], v[64:67], v[220:223], v[172:175]
  ds_read_b128 v[244:247], v11 offset:10240
  v_mfma_f32_16x16x32_bf16 v[136:139], v[64:67], v[224:227], v[136:139]
  s_waitcnt lgkmcnt(8)
  v_mfma_f32_16x16x32_bf16 v[176:179], v[68:71], v[220:223], v[176:179]
  ds_read_b128 v[80:83], v11 offset:11264
  v_mfma_f32_16x16x32_bf16 v[140:143], v[68:71], v[224:227], v[140:143]
  s_waitcnt lgkmcnt(8)
  v_mfma_f32_16x16x32_bf16 v[180:183], v[72:75], v[220:223], v[180:183]
  ds_read_b128 v[84:87], v11 offset:12288
  v_mfma_f32_16x16x32_bf16 v[144:147], v[72:75], v[224:227], v[144:147]
  s_waitcnt lgkmcnt(8)
  v_mfma_f32_16x16x32_bf16 v[184:187], v[76:79], v[220:223], v[184:187]
  ds_read_b128 v[88:91], v11 offset:13312
  v_mfma_f32_16x16x32_bf16 v[148:151], v[76:79], v[224:227], v[148:151]
  s_waitcnt lgkmcnt(6)
  v_mfma_f32_16x16x32_bf16 v[168:171], v[240:243], v[124:127], v[168:171]
  s_barrier
  ds_read_b64_tr_b16 v[116:117], v10 offset:34816
  ds_read_b64_tr_b16 v[118:119], v10 offset:38912
  s_waitcnt lgkmcnt(6)
  v_mfma_f32_16x16x32_bf16 v[132:135], v[240:243], v[128:131], v[132:135]
  ds_read_b128 v[92:95], v8 offset:39936
  ds_read_b64_tr_b16 v[120:121], v9 offset:34816
  ds_read_b64_tr_b16 v[122:123], v9 offset:38912
  s_waitcnt lgkmcnt(8)
  v_mfma_f32_16x16x32_bf16 v[172:175], v[244:247], v[124:127], v[172:175]
  ds_read_b64_tr_b16 v[212:213], v10 offset:43008
  ds_read_b64_tr_b16 v[214:215], v10 offset:47104
  v_mfma_f32_16x16x32_bf16 v[136:139], v[244:247], v[128:131], v[136:139]
  ds_read_b128 v[96:99], v8 offset:49152
  ds_read_b64_tr_b16 v[216:217], v9 offset:43008
  ds_read_b64_tr_b16 v[218:219], v9 offset:47104
  s_waitcnt lgkmcnt(12)
  v_mfma_f32_16x16x32_bf16 v[176:179], v[80:83], v[124:127], v[176:179]
  ds_read_b128 v[100:103], v8 offset:40960
  v_mfma_f32_16x16x32_bf16 v[140:143], v[80:83], v[128:131], v[140:143]
  s_waitcnt lgkmcnt(12)
  v_mfma_f32_16x16x32_bf16 v[180:183], v[84:87], v[124:127], v[180:183]
  ds_read_b128 v[104:107], v8 offset:50176
  v_mfma_f32_16x16x32_bf16 v[144:147], v[84:87], v[128:131], v[144:147]
  s_waitcnt lgkmcnt(12)
  v_mfma_f32_16x16x32_bf16 v[184:187], v[88:91], v[124:127], v[184:187]
  ds_read_b128 v[108:111], v8 offset:41984
  v_mfma_f32_16x16x32_bf16 v[148:151], v[88:91], v[128:131], v[148:151]
  s_waitcnt lgkmcnt(10)
  v_mfma_f32_16x16x32_bf16 v[188:191], v[92:95], v[116:119], v[188:191]
  ds_read_b128 v[112:115], v8 offset:51200
  s_waitcnt lgkmcnt(9)
  v_mfma_f32_16x16x32_bf16 v[152:155], v[92:95], v[120:123], v[152:155]
  s_waitcnt lgkmcnt(6)
  v_mfma_f32_16x16x32_bf16 v[188:191], v[96:99], v[212:215], v[188:191]
  ds_read_b128 v[44:47], v8 offset:43008
  s_waitcnt lgkmcnt(5)
  v_mfma_f32_16x16x32_bf16 v[152:155], v[96:99], v[216:219], v[152:155]
  s_waitcnt lgkmcnt(4)
  v_mfma_f32_16x16x32_bf16 v[192:195], v[100:103], v[116:119], v[192:195]
  ds_read_b128 v[48:51], v8 offset:52224
  v_mfma_f32_16x16x32_bf16 v[156:159], v[100:103], v[120:123], v[156:159]
  s_waitcnt lgkmcnt(4)
  v_mfma_f32_16x16x32_bf16 v[192:195], v[104:107], v[212:215], v[192:195]
  ds_read_b64_tr_b16 v[220:221], v13 offset:34816
  ds_read_b64_tr_b16 v[222:223], v13 offset:38912
  v_mfma_f32_16x16x32_bf16 v[156:159], v[104:107], v[216:219], v[156:159]
  ds_read_b128 v[52:55], v11 offset:34816
  ds_read_b64_tr_b16 v[224:225], v12 offset:34816
  ds_read_b64_tr_b16 v[226:227], v12 offset:38912
  s_waitcnt lgkmcnt(8)
  v_mfma_f32_16x16x32_bf16 v[196:199], v[108:111], v[116:119], v[196:199]
  ds_read_b128 v[56:59], v11 offset:35840
  v_cvt_pk_bf16_f32 v228, v188, v189
  v_cvt_pk_bf16_f32 v229, v190, v191
  v_mfma_f32_16x16x32_bf16 v[160:163], v[108:111], v[120:123], v[160:163]
  v_cvt_pk_bf16_f32 v230, v192, v193
  v_cvt_pk_bf16_f32 v231, v194, v195
  buffer_store_dwordx4 v[228:231], v14, s[16:19], s31 offen offset:0 sc1
  s_waitcnt lgkmcnt(8)
  v_mfma_f32_16x16x32_bf16 v[196:199], v[112:115], v[212:215], v[196:199]
  ds_read_b128 v[60:63], v11 offset:36864
  v_cvt_pk_bf16_f32 v232, v152, v153
  v_cvt_pk_bf16_f32 v233, v154, v155
  v_mfma_f32_16x16x32_bf16 v[160:163], v[112:115], v[216:219], v[160:163]
  v_cvt_pk_bf16_f32 v234, v156, v157
  v_cvt_pk_bf16_f32 v235, v158, v159
  s_waitcnt lgkmcnt(8)
  v_mfma_f32_16x16x32_bf16 v[200:203], v[44:47], v[116:119], v[200:203]
  ds_read_b128 v[64:67], v11 offset:37888
  v_mfma_f32_16x16x32_bf16 v[164:167], v[44:47], v[120:123], v[164:167]
  s_waitcnt lgkmcnt(8)
  v_mfma_f32_16x16x32_bf16 v[200:203], v[48:51], v[212:215], v[200:203]
  ds_read_b128 v[68:71], v11 offset:38912
  v_mfma_f32_16x16x32_bf16 v[164:167], v[48:51], v[216:219], v[164:167]
  buffer_store_dwordx4 v[232:235], v14, s[16:19], s35 offen offset:0 sc1
  s_waitcnt lgkmcnt(6)
  v_mfma_f32_16x16x32_bf16 v[168:171], v[52:55], v[220:223], v[168:171]
  ds_read_b64_tr_b16 v[124:125], v13 offset:43008
  ds_read_b64_tr_b16 v[126:127], v13 offset:47104
  s_waitcnt lgkmcnt(6)
  v_mfma_f32_16x16x32_bf16 v[132:135], v[52:55], v[224:227], v[132:135]
  ds_read_b128 v[72:75], v11 offset:44032
  ds_read_b64_tr_b16 v[128:129], v12 offset:43008
  ds_read_b64_tr_b16 v[130:131], v12 offset:47104
  v_cvt_pk_bf16_f32 v236, v196, v197
  v_cvt_pk_bf16_f32 v237, v198, v199
  s_waitcnt lgkmcnt(8)
  v_mfma_f32_16x16x32_bf16 v[172:175], v[56:59], v[220:223], v[172:175]
  ds_read_b128 v[76:79], v11 offset:45056
  v_cvt_pk_bf16_f32 v238, v200, v201
  v_cvt_pk_bf16_f32 v239, v202, v203
  v_mfma_f32_16x16x32_bf16 v[136:139], v[56:59], v[224:227], v[136:139]
  s_waitcnt lgkmcnt(8)
  v_mfma_f32_16x16x32_bf16 v[176:179], v[60:63], v[220:223], v[176:179]
  ds_read_b128 v[240:243], v11 offset:46080
  v_mfma_f32_16x16x32_bf16 v[140:143], v[60:63], v[224:227], v[140:143]
  buffer_store_dwordx4 v[236:239], v14, s[16:19], s31 offen offset:1024 sc1
  v_cvt_pk_bf16_f32 v228, v160, v161
  v_cvt_pk_bf16_f32 v229, v162, v163
  s_waitcnt lgkmcnt(8)
  v_mfma_f32_16x16x32_bf16 v[180:183], v[64:67], v[220:223], v[180:183]
  ds_read_b128 v[244:247], v11 offset:47104
  v_cvt_pk_bf16_f32 v230, v164, v165
  v_cvt_pk_bf16_f32 v231, v166, v167
  v_mfma_f32_16x16x32_bf16 v[144:147], v[64:67], v[224:227], v[144:147]
  s_waitcnt lgkmcnt(8)
  v_mfma_f32_16x16x32_bf16 v[184:187], v[68:71], v[220:223], v[184:187]
  ds_read_b128 v[80:83], v11 offset:48128
  v_mfma_f32_16x16x32_bf16 v[148:151], v[68:71], v[224:227], v[148:151]
  s_waitcnt lgkmcnt(6)
  v_mfma_f32_16x16x32_bf16 v[168:171], v[72:75], v[124:127], v[168:171]
  ds_read_b64_tr_b16 v[116:117], v10 offset:0
  ds_read_b64_tr_b16 v[118:119], v10 offset:4096
  s_waitcnt lgkmcnt(6)
  v_mfma_f32_16x16x32_bf16 v[132:135], v[72:75], v[128:131], v[132:135]
  ds_read_b128 v[84:87], v8 offset:0
  ds_read_b128 v[88:91], v8 offset:1024
  buffer_store_dwordx4 v[228:231], v14, s[16:19], s35 offen offset:1024 sc1
  s_waitcnt lgkmcnt(7)
  v_mfma_f32_16x16x32_bf16 v[172:175], v[76:79], v[124:127], v[172:175]
  ds_read_b64_tr_b16 v[120:121], v10 offset:8192
  ds_read_b64_tr_b16 v[122:123], v10 offset:12288
  v_mfma_f32_16x16x32_bf16 v[136:139], v[76:79], v[128:131], v[136:139]
  ds_read_b128 v[92:95], v8 offset:9216
  ds_read_b128 v[96:99], v8 offset:10240
  s_waitcnt lgkmcnt(10)
  v_mfma_f32_16x16x32_bf16 v[176:179], v[240:243], v[124:127], v[176:179]
  ds_read_b64_tr_b16 v[212:213], v10 offset:34816
  ds_read_b64_tr_b16 v[214:215], v10 offset:38912
  v_mfma_f32_16x16x32_bf16 v[140:143], v[240:243], v[128:131], v[140:143]
  ds_read_b128 v[100:103], v8 offset:34816
  ds_read_b128 v[104:107], v8 offset:35840
  s_waitcnt lgkmcnt(13)
  v_mfma_f32_16x16x32_bf16 v[180:183], v[244:247], v[124:127], v[180:183]
  ds_read_b64_tr_b16 v[216:217], v10 offset:43008
  ds_read_b64_tr_b16 v[218:219], v10 offset:47104
  v_mfma_f32_16x16x32_bf16 v[144:147], v[244:247], v[128:131], v[144:147]
  ds_read_b128 v[108:111], v8 offset:44032
  ds_read_b128 v[112:115], v8 offset:45056
  s_waitcnt lgkmcnt(15)
  v_mfma_f32_16x16x32_bf16 v[184:187], v[80:83], v[124:127], v[184:187]
  ds_read_b128 v[44:47], v8 offset:2048
  v_mfma_f32_16x16x32_bf16 v[148:151], v[80:83], v[128:131], v[148:151]
  ds_read_b128 v[48:51], v8 offset:3072
  s_waitcnt lgkmcnt(15)
  v_mfma_f32_16x16x32_bf16 v[168:171], v[84:87], v[116:119], v[168:171]
  ds_read_b128 v[52:55], v8 offset:4096
  s_waitcnt lgkmcnt(15)
  v_mfma_f32_16x16x32_bf16 v[172:175], v[88:91], v[116:119], v[172:175]
  ds_read_b128 v[56:59], v8 offset:11264
  s_waitcnt lgkmcnt(13)
  v_mfma_f32_16x16x32_bf16 v[168:171], v[92:95], v[120:123], v[168:171]
  ds_read_b128 v[60:63], v8 offset:12288
  s_waitcnt lgkmcnt(13)
  v_mfma_f32_16x16x32_bf16 v[172:175], v[96:99], v[120:123], v[172:175]
  ds_read_b128 v[64:67], v8 offset:13312
  s_waitcnt lgkmcnt(11)
  v_mfma_f32_16x16x32_bf16 v[168:171], v[100:103], v[212:215], v[168:171]
  ds_read_b128 v[68:71], v8 offset:36864
  s_waitcnt lgkmcnt(11)
  v_mfma_f32_16x16x32_bf16 v[172:175], v[104:107], v[212:215], v[172:175]
  ds_read_b128 v[72:75], v8 offset:37888
  s_waitcnt lgkmcnt(9)
  v_mfma_f32_16x16x32_bf16 v[168:171], v[108:111], v[216:219], v[168:171]
  ds_read_b128 v[76:79], v8 offset:38912
  s_waitcnt lgkmcnt(9)
  v_mfma_f32_16x16x32_bf16 v[172:175], v[112:115], v[216:219], v[172:175]
  ds_read_b128 v[240:243], v8 offset:46080
  s_waitcnt lgkmcnt(9)
  v_mfma_f32_16x16x32_bf16 v[176:179], v[44:47], v[116:119], v[176:179]
  ds_read_b128 v[244:247], v8 offset:47104
  s_waitcnt lgkmcnt(9)
  v_mfma_f32_16x16x32_bf16 v[180:183], v[48:51], v[116:119], v[180:183]
  ds_read_b128 v[80:83], v8 offset:48128
  s_waitcnt lgkmcnt(9)
  v_mfma_f32_16x16x32_bf16 v[184:187], v[52:55], v[116:119], v[184:187]
  ds_read_b64_tr_b16 v[220:221], v9 offset:0
  ds_read_b64_tr_b16 v[222:223], v9 offset:4096
  v_cvt_pk_bf16_f32 v232, v168, v169
  v_cvt_pk_bf16_f32 v233, v170, v171
  s_waitcnt lgkmcnt(10)
  v_mfma_f32_16x16x32_bf16 v[176:179], v[56:59], v[120:123], v[176:179]
  v_cvt_pk_bf16_f32 v234, v172, v173
  v_cvt_pk_bf16_f32 v235, v174, v175
  buffer_store_dwordx4 v[232:235], v14, s[16:19], s36 offen offset:0 sc1
  s_waitcnt lgkmcnt(9)
  v_mfma_f32_16x16x32_bf16 v[180:183], v[60:63], v[120:123], v[180:183]
  s_waitcnt lgkmcnt(8)
  v_mfma_f32_16x16x32_bf16 v[184:187], v[64:67], v[120:123], v[184:187]
  s_waitcnt lgkmcnt(7)
  v_mfma_f32_16x16x32_bf16 v[176:179], v[68:71], v[212:215], v[176:179]
  s_waitcnt lgkmcnt(6)
  v_mfma_f32_16x16x32_bf16 v[180:183], v[72:75], v[212:215], v[180:183]
  ds_read_b64_tr_b16 v[224:225], v9 offset:8192
  ds_read_b64_tr_b16 v[226:227], v9 offset:12288
  s_waitcnt lgkmcnt(7)
  v_mfma_f32_16x16x32_bf16 v[184:187], v[76:79], v[212:215], v[184:187]
  s_waitcnt lgkmcnt(6)
  v_mfma_f32_16x16x32_bf16 v[176:179], v[240:243], v[216:219], v[176:179]
  s_waitcnt lgkmcnt(5)
  v_mfma_f32_16x16x32_bf16 v[180:183], v[244:247], v[216:219], v[180:183]
  s_waitcnt lgkmcnt(4)
  v_mfma_f32_16x16x32_bf16 v[184:187], v[80:83], v[216:219], v[184:187]
  s_waitcnt lgkmcnt(2)
  v_mfma_f32_16x16x32_bf16 v[132:135], v[84:87], v[220:223], v[132:135]
  ds_read_b64_tr_b16 v[124:125], v9 offset:34816
  ds_read_b64_tr_b16 v[126:127], v9 offset:38912
  v_mfma_f32_16x16x32_bf16 v[136:139], v[88:91], v[220:223], v[136:139]
  v_mfma_f32_16x16x32_bf16 v[140:143], v[44:47], v[220:223], v[140:143]
  v_cvt_pk_bf16_f32 v236, v176, v177
  v_cvt_pk_bf16_f32 v237, v178, v179
  v_mfma_f32_16x16x32_bf16 v[144:147], v[48:51], v[220:223], v[144:147]
  v_cvt_pk_bf16_f32 v238, v180, v181
  v_cvt_pk_bf16_f32 v239, v182, v183
  buffer_store_dwordx4 v[236:239], v14, s[16:19], s36 offen offset:1024 sc1
  v_mfma_f32_16x16x32_bf16 v[148:151], v[52:55], v[220:223], v[148:151]
  v_cvt_pk_bf16_f32 v228, v184, v185
  v_cvt_pk_bf16_f32 v229, v186, v187
  buffer_store_dwordx2 v[228:229], v2, s[16:19], s36 offen offset:2048 sc1
  s_waitcnt lgkmcnt(2)
  v_mfma_f32_16x16x32_bf16 v[132:135], v[92:95], v[224:227], v[132:135]
  ds_read_b64_tr_b16 v[128:129], v9 offset:43008
  ds_read_b64_tr_b16 v[130:131], v9 offset:47104
  v_mfma_f32_16x16x32_bf16 v[136:139], v[96:99], v[224:227], v[136:139]
  v_mfma_f32_16x16x32_bf16 v[140:143], v[56:59], v[224:227], v[140:143]
  v_mfma_f32_16x16x32_bf16 v[144:147], v[60:63], v[224:227], v[144:147]
  v_mfma_f32_16x16x32_bf16 v[148:151], v[64:67], v[224:227], v[148:151]
  s_waitcnt lgkmcnt(2)
  v_mfma_f32_16x16x32_bf16 v[132:135], v[100:103], v[124:127], v[132:135]
  v_mfma_f32_16x16x32_bf16 v[136:139], v[104:107], v[124:127], v[136:139]
  v_mfma_f32_16x16x32_bf16 v[140:143], v[68:71], v[124:127], v[140:143]
  v_mfma_f32_16x16x32_bf16 v[144:147], v[72:75], v[124:127], v[144:147]
  v_mfma_f32_16x16x32_bf16 v[148:151], v[76:79], v[124:127], v[148:151]
  s_waitcnt lgkmcnt(0)
  v_mfma_f32_16x16x32_bf16 v[132:135], v[108:111], v[128:131], v[132:135]
  v_mfma_f32_16x16x32_bf16 v[136:139], v[112:115], v[128:131], v[136:139]
  v_mfma_f32_16x16x32_bf16 v[140:143], v[240:243], v[128:131], v[140:143]
  v_mfma_f32_16x16x32_bf16 v[144:147], v[244:247], v[128:131], v[144:147]
  v_mfma_f32_16x16x32_bf16 v[148:151], v[80:83], v[128:131], v[148:151]
  s_waitcnt vmcnt(7)
  v_mfma_f32_16x16x32_bf16 v[80:83], v[24:27], v[208:211], 0
  v_mfma_f32_16x16x32_bf16 v[84:87], v[28:31], v[208:211], 0
  v_mfma_f32_16x16x32_bf16 v[88:91], v[32:35], v[208:211], 0
  v_mfma_f32_16x16x32_bf16 v[92:95], v[36:39], v[208:211], 0
  v_mfma_f32_16x16x32_bf16 v[96:99], v[40:43], v[208:211], 0
  v_lshlrev_b32 v20, 16, v20
  v_add_f32 v20, v20, v18
  s_mov_b32 s37, 0
  v_mul_u32_u24 v4, 10224, v1
  v_add_u32 v4, v4, v15
  s_waitcnt vmcnt(0)
L_p0_3191:
  s_mov_b64 exec, 7
L_p1_3189:
  buffer_load_dword v2, v4, s[16:19], 0 offen offset:2552 sc1
  s_add_u32 s37, s37, 1
  s_waitcnt vmcnt(0)
  v_cmp_eq_u32 vcc, -1, v2
  s_cmp_gt_u32 s37, 262144
  s_cbranch_scc1 L_g1_3190
  s_cbranch_vccz L_g1_3190
  s_sleep 6
  s_branch L_p1_3189
L_g1_3190:
  s_mov_b64 exec, -1
L_poll_3187:
  s_mov_b32 s35, 0
  buffer_load_dwordx4 v[44:47], v15, s[16:19], s35 offen offset:0 sc1
  buffer_load_dwordx4 v[48:51], v15, s[16:19], s35 offen offset:1024 sc1
  buffer_load_dwordx2 v[52:53], v3, s[16:19], s35 offen offset:2048 sc1
  s_mov_b32 s35, 10240
  buffer_load_dwordx4 v[56:59], v15, s[16:19], s35 offen offset:0 sc1
  buffer_load_dwordx4 v[60:63], v15, s[16:19], s35 offen offset:1024 sc1
  buffer_load_dwordx2 v[64:65], v3, s[16:19], s35 offen offset:2048 sc1
  s_mov_b32 s35, 20480
  buffer_load_dwordx4 v[68:71], v15, s[16:19], s35 offen offset:0 sc1
  buffer_load_dwordx4 v[72:75], v15, s[16:19], s35 offen offset:1024 sc1
  buffer_load_dwordx2 v[76:77], v3, s[16:19], s35 offen offset:2048 sc1
  s_add_u32 s37, s37, 1
  s_waitcnt vmcnt(0)
  v_max3_u32 v2, v44, v45, v46
  v_max3_u32 v2, v2, v47, v48
  v_max3_u32 v2, v2, v49, v50
  v_max3_u32 v2, v2, v51, v52
  v_max3_u32 v2, v2, v53, v56
  v_max3_u32 v2, v2, v57, v58
  v_max3_u32 v2, v2, v59, v60
  v_max3_u32 v2, v2, v61, v62
  v_max3_u32 v2, v2, v63, v64
  v_max3_u32 v2, v2, v65, v68
  v_max3_u32 v2, v2, v69, v70
  v_max3_u32 v2, v2, v71, v72
  v_max3_u32 v2, v2, v73, v74
  v_max3_u32 v2, v2, v75, v76
  v_max_u32 v2, v2, v77
  v_cmp_eq_u32 vcc, -1, v2
  s_cmp_gt_u32 s37, 262144
  s_cbranch_scc1 L_got_3188
  s_cbranch_vccz L_got_3188
  s_sleep 6
  s_branch L_poll_3187
L_got_3188:
  v_fma_f32 v80, v80, v19, v20
  v_fma_f32 v81, v81, v19, v20
  v_fma_f32 v82, v82, v19, v20
  v_fma_f32 v83, v83, v19, v20
  v_add_f32 v132, v132, v80
  v_add_f32 v133, v133, v81
  v_add_f32 v134, v134, v82
  v_add_f32 v135, v135, v83
  v_lshlrev_b32 v2, 16, v44
  v_and_b32 v44, 0xffff0000, v44
  v_add_f32 v132, v132, v2
  v_add_f32 v133, v133, v44
  v_lshlrev_b32 v2, 16, v45
  v_and_b32 v45, 0xffff0000, v45
  v_add_f32 v134, v134, v2
  v_add_f32 v135, v135, v45
  v_lshlrev_b32 v2, 16, v56
  v_and_b32 v56, 0xffff0000, v56
  v_add_f32 v132, v132, v2
  v_add_f32 v133, v133, v56
  v_lshlrev_b32 v2, 16, v57
  v_and_b32 v57, 0xffff0000, v57
  v_add_f32 v134, v134, v2
  v_add_f32 v135, v135, v57
  v_lshlrev_b32 v2, 16, v68
  v_and_b32 v68, 0xffff0000, v68
  v_add_f32 v132, v132, v2
  v_add_f32 v133, v133, v68
  v_lshlrev_b32 v2, 16, v69
  v_and_b32 v69, 0xffff0000, v69
  v_add_f32 v134, v134, v2
  v_add_f32 v135, v135, v69
  v_cvt_pk_bf16_f32 v24, v132, v133
  v_cvt_pk_bf16_f32 v25, v134, v135
  v_fma_f32 v84, v84, v19, v20
  v_fma_f32 v85, v85, v19, v20
  v_fma_f32 v86, v86, v19, v20
  v_fma_f32 v87, v87, v19, v20
  v_add_f32 v136, v136, v84
  v_add_f32 v137, v137, v85
  v_add_f32 v138, v138, v86
  v_add_f32 v139, v139, v87
  v_lshlrev_b32 v2, 16, v46
  v_and_b32 v46, 0xffff0000, v46
  v_add_f32 v136, v136, v2
  v_add_f32 v137, v137, v46
  v_lshlrev_b32 v2, 16, v47
  v_and_b32 v47, 0xffff0000, v47
  v_add_f32 v138, v138, v2
  v_add_f32 v139, v139, v47
  v_lshlrev_b32 v2, 16, v58
  v_and_b32 v58, 0xffff0000, v58
  v_add_f32 v136, v136, v2
  v_add_f32 v137, v137, v58
  v_lshlrev_b32 v2, 16, v59
  v_and_b32 v59, 0xffff0000, v59
  v_add_f32 v138, v138, v2
  v_add_f32 v139, v139, v59
  v_lshlrev_b32 v2, 16, v70
  v_and_b32 v70, 0xffff0000, v70
  v_add_f32 v136, v136, v2
  v_add_f32 v137, v137, v70
  v_lshlrev_b32 v2, 16, v71
  v_and_b32 v71, 0xffff0000, v71
  v_add_f32 v138, v138, v2
  v_add_f32 v139, v139, v71
  v_cvt_pk_bf16_f32 v26, v136, v137
  v_cvt_pk_bf16_f32 v27, v138, v139
  s_nop 0
  v_permlane16_swap_b32 v24, v26
  v_permlane16_swap_b32 v25, v27
  buffer_store_dwordx4 v[24:27], v16, s[20:23], 0 offen offset:0
  v_fma_f32 v88, v88, v19, v20
  v_fma_f32 v89, v89, v19, v20
  v_fma_f32 v90, v90, v19, v20
  v_fma_f32 v91, v91, v19, v20
  v_add_f32 v140, v140, v88
  v_add_f32 v141, v141, v89
  v_add_f32 v142, v142, v90
  v_add_f32 v143, v143, v91
  v_lshlrev_b32 v2, 16, v48
  v_and_b32 v48, 0xffff0000, v48
  v_add_f32 v140, v140, v2
  v_add_f32 v141, v141, v48
  v_lshlrev_b32 v2, 16, v49
  v_and_b32 v49, 0xffff0000, v49
  v_add_f32 v142, v142, v2
  v_add_f32 v143, v143, v49
  v_lshlrev_b32 v2, 16, v60
  v_and_b32 v60, 0xffff0000, v60
  v_add_f32 v140, v140, v2
  v_add_f32 v141, v141, v60
  v_lshlrev_b32 v2, 16, v61
  v_and_b32 v61, 0xffff0000, v61
  v_add_f32 v142, v142, v2
  v_add_f32 v143, v143, v61
  v_lshlrev_b32 v2, 16, v72
  v_and_b32 v72, 0xffff0000, v72
  v_add_f32 v140, v140, v2
  v_add_f32 v141, v141, v72
  v_lshlrev_b32 v2, 16, v73
  v_and_b32 v73, 0xffff0000, v73
  v_add_f32 v142, v142, v2
  v_add_f32 v143, v143, v73
  v_cvt_pk_bf16_f32 v28, v140, v141
  v_cvt_pk_bf16_f32 v29, v142, v143
  v_fma_f32 v92, v92, v19, v20
  v_fma_f32 v93, v93, v19, v20
  v_fma_f32 v94, v94, v19, v20
  v_fma_f32 v95, v95, v19, v20
  v_add_f32 v144, v144, v92
  v_add_f32 v145, v145, v93
  v_add_f32 v146, v146, v94
  v_add_f32 v147, v147, v95
  v_lshlrev_b32 v2, 16, v50
  v_and_b32 v50, 0xffff0000, v50
  v_add_f32 v144, v144, v2
  v_add_f32 v145, v145, v50
  v_lshlrev_b32 v2, 16, v51
  v_and_b32 v51, 0xffff0000, v51
  v_add_f32 v146, v146, v2
  v_add_f32 v147, v147, v51
  v_lshlrev_b32 v2, 16, v62
  v_and_b32 v62, 0xffff0000, v62
  v_add_f32 v144, v144, v2
  v_add_f32 v145, v145, v62
  v_lshlrev_b32 v2, 16, v63
  v_and_b32 v63, 0xffff0000, v63
  v_add_f32 v146, v146, v2
  v_add_f32 v147, v147, v63
  v_lshlrev_b32 v2, 16, v74
  v_and_b32 v74, 0xffff0000, v74
  v_add_f32 v144, v144, v2
  v_add_f32 v145, v145, v74
  v_lshlrev_b32 v2, 16, v75
  v_and_b32 v75, 0xffff0000, v75
  v_add_f32 v146, v146, v2
  v_add_f32 v147, v147, v75
  v_cvt_pk_bf16_f32 v30, v144, v145
  v_cvt_pk_bf16_f32 v31, v146, v147
  s_nop 0
  v_permlane16_swap_b32 v28, v30
  v_permlane16_swap_b32 v29, v31
  buffer_store_dwordx4 v[28:31], v16, s[20:23], 0 offen offset:64
  v_fma_f32 v96, v96, v19, v20
  v_fma_f32 v97, v97, v19, v20
  v_fma_f32 v98, v98, v19, v20
  v_fma_f32 v99, v99, v19, v20
  v_add_f32 v148, v148, v96
  v_add_f32 v149, v149, v97
  v_add_f32 v150, v150, v98
  v_add_f32 v151, v151, v99
  v_lshlrev_b32 v2, 16, v52
  v_and_b32 v52, 0xffff0000, v52
  v_add_f32 v148, v148, v2
  v_add_f32 v149, v149, v52
  v_lshlrev_b32 v2, 16, v53
  v_and_b32 v53, 0xffff0000, v53
  v_add_f32 v150, v150, v2
  v_add_f32 v151, v151, v53
  v_lshlrev_b32 v2, 16, v64
  v_and_b32 v64, 0xffff0000, v64
  v_add_f32 v148, v148, v2
  v_add_f32 v149, v149, v64
  v_lshlrev_b32 v2, 16, v65
  v_and_b32 v65, 0xffff0000, v65
  v_add_f32 v150, v150, v2
  v_add_f32 v151, v151, v65
  v_lshlrev_b32 v2, 16, v76
  v_and_b32 v76, 0xffff0000, v76
  v_add_f32 v148, v148, v2
  v_add_f32 v149, v149, v76
  v_lshlrev_b32 v2, 16, v77
  v_and_b32 v77, 0xffff0000, v77
  v_add_f32 v150, v150, v2
  v_add_f32 v151, v151, v77
  v_cvt_pk_bf16_f32 v32, v148, v149
  v_cvt_pk_bf16_f32 v33, v150, v151
  buffer_store_dwordx2 v[32:33], v17, s[20:23], 0 offen offset:128
  s_endpgm
L_q1_3184:
L_x1:
  v_lshlrev_b32 v2, 3, v1
  v_sub_u32 v3, v15, v2
  v_sub_u32 v2, v14, v2
  s_mov_b32 s35, 0
  s_mov_b32 s36, 81920
  s_mov_b32 s31, 102400
  s_waitcnt lgkmcnt(0)
  s_barrier
  v_mfma_f32_16x16x32_bf16 v[132:135], v[80:83], v[124:127], v[132:135]
  v_mfma_f32_16x16x32_bf16 v[168:171], v[80:83], v[128:131], v[168:171]
  v_mfma_f32_16x16x32_bf16 v[136:139], v[84:87], v[124:127], v[136:139]
  v_mfma_f32_16x16x32_bf16 v[172:175], v[84:87], v[128:131], v[172:175]
  v_mfma_f32_16x16x32_bf16 v[140:143], v[88:91], v[124:127], v[140:143]
  v_mfma_f32_16x16x32_bf16 v[176:179], v[88:91], v[128:131], v[176:179]
  v_mfma_f32_16x16x32_bf16 v[144:147], v[92:95], v[124:127], v[144:147]
  v_mfma_f32_16x16x32_bf16 v[180:183], v[92:95], v[128:131], v[180:183]
  v_mfma_f32_16x16x32_bf16 v[148:151], v[96:99], v[124:127], v[148:151]
  ds_read_b64_tr_b16 v[116:117], v13 offset:0
  ds_read_b64_tr_b16 v[118:119], v13 offset:4096
  v_mfma_f32_16x16x32_bf16 v[184:187], v[96:99], v[128:131], v[184:187]
  ds_read_b128 v[44:47], v11 offset:0
  ds_read_b64_tr_b16 v[120:121], v12 offset:0
  ds_read_b64_tr_b16 v[122:123], v12 offset:4096
  v_mfma_f32_16x16x32_bf16 v[152:155], v[100:103], v[124:127], v[152:155]
  ds_read_b128 v[48:51], v11 offset:1024
  v_mfma_f32_16x16x32_bf16 v[188:191], v[100:103], v[128:131], v[188:191]
  v_mfma_f32_16x16x32_bf16 v[156:159], v[104:107], v[124:127], v[156:159]
  ds_read_b128 v[52:55], v11 offset:2048
  v_mfma_f32_16x16x32_bf16 v[192:195], v[104:107], v[128:131], v[192:195]
  v_mfma_f32_16x16x32_bf16 v[160:163], v[108:111], v[124:127], v[160:163]
  ds_read_b128 v[56:59], v11 offset:3072
  v_mfma_f32_16x16x32_bf16 v[196:199], v[108:111], v[128:131], v[196:199]
  v_mfma_f32_16x16x32_bf16 v[164:167], v[112:115], v[124:127], v[164:167]
  ds_read_b128 v[60:63], v11 offset:4096
  v_mfma_f32_16x16x32_bf16 v[200:203], v[112:115], v[128:131], v[200:203]
  s_waitcnt lgkmcnt(6)
  v_mfma_f32_16x16x32_bf16 v[168:171], v[44:47], v[116:119], v[168:171]
  ds_read_b64_tr_b16 v[212:213], v13 offset:8192
  ds_read_b64_tr_b16 v[214:215], v13 offset:12288
  s_waitcnt lgkmcnt(6)
  v_mfma_f32_16x16x32_bf16 v[132:135], v[44:47], v[120:123], v[132:135]
  ds_read_b128 v[64:67], v11 offset:9216
  ds_read_b64_tr_b16 v[216:217], v12 offset:8192
  ds_read_b64_tr_b16 v[218:219], v12 offset:12288
  s_waitcnt lgkmcnt(8)
  v_mfma_f32_16x16x32_bf16 v[172:175], v[48:51], v[116:119], v[172:175]
  ds_read_b128 v[68:71], v11 offset:10240
  v_mfma_f32_16x16x32_bf16 v[136:139], v[48:51], v[120:123], v[136:139]
  s_waitcnt lgkmcnt(8)
  v_mfma_f32_16x16x32_bf16 v[176:179], v[52:55], v[116:119], v[176:179]
  ds_read_b128 v[72:75], v11 offset:11264
  v_mfma_f32_16x16x32_bf16 v[140:143], v[52:55], v[120:123], v[140:143]
  s_waitcnt lgkmcnt(8)
  v_mfma_f32_16x16x32_bf16 v[180:183], v[56:59], v[116:119], v[180:183]
  ds_read_b128 v[76:79], v11 offset:12288
  v_mfma_f32_16x16x32_bf16 v[144:147], v[56:59], v[120:123], v[144:147]
  s_waitcnt lgkmcnt(8)
  v_mfma_f32_16x16x32_bf16 v[184:187], v[60:63], v[116:119], v[184:187]
  ds_read_b128 v[240:243], v11 offset:13312
  v_mfma_f32_16x16x32_bf16 v[148:151], v[60:63], v[120:123], v[148:151]
  s_waitcnt lgkmcnt(6)
  v_mfma_f32_16x16x32_bf16 v[168:171], v[64:67], v[212:215], v[168:171]
  s_barrier
  ds_read_b64_tr_b16 v[220:221], v13 offset:34816
  ds_read_b64_tr_b16 v[222:223], v13 offset:38912
  s_waitcnt lgkmcnt(6)
  v_mfma_f32_16x16x32_bf16 v[132:135], v[64:67], v[216:219], v[132:135]
  ds_read_b128 v[244:247], v11 offset:34816
  ds_read_b64_tr_b16 v[224:225], v12 offset:34816
  ds_read_b64_tr_b16 v[226:227], v12 offset:38912
  s_waitcnt lgkmcnt(8)
  v_mfma_f32_16x16x32_bf16 v[172:175], v[68:71], v[212:215], v[172:175]
  ds_read_b128 v[80:83], v11 offset:35840
  v_mfma_f32_16x16x32_bf16 v[136:139], v[68:71], v[216:219], v[136:139]
  s_waitcnt lgkmcnt(8)
  v_mfma_f32_16x16x32_bf16 v[176:179], v[72:75], v[212:215], v[176:179]
  ds_read_b128 v[84:87], v11 offset:36864
  v_mfma_f32_16x16x32_bf16 v[140:143], v[72:75], v[216:219], v[140:143]
  s_waitcnt lgkmcnt(8)
  v_mfma_f32_16x16x32_bf16 v[180:183], v[76:79], v[212:215], v[180:183]
  ds_read_b128 v[88:91], v11 offset:37888
  v_mfma_f32_16x16x32_bf16 v[144:147], v[76:79], v[216:219], v[144:147]
  s_waitcnt lgkmcnt(8)
  v_mfma_f32_16x16x32_bf16 v[184:187], v[240:243], v[212:215], v[184:187]
  ds_read_b128 v[92:95], v11 offset:38912
  v_mfma_f32_16x16x32_bf16 v[148:151], v[240:243], v[216:219], v[148:151]
  s_waitcnt lgkmcnt(6)
  v_mfma_f32_16x16x32_bf16 v[168:171], v[244:247], v[220:223], v[168:171]
  ds_read_b64_tr_b16 v[124:125], v13 offset:43008
  ds_read_b64_tr_b16 v[126:127], v13 offset:47104
  s_waitcnt lgkmcnt(6)
  v_mfma_f32_16x16x32_bf16 v[132:135], v[244:247], v[224:227], v[132:135]
  ds_read_b128 v[96:99], v11 offset:44032
  ds_read_b64_tr_b16 v[128:129], v12 offset:43008
  ds_read_b64_tr_b16 v[130:131], v12 offset:47104
  s_waitcnt lgkmcnt(8)
  v_mfma_f32_16x16x32_bf16 v[172:175], v[80:83], v[220:223], v[172:175]
  ds_read_b128 v[100:103], v11 offset:45056
  v_mfma_f32_16x16x32_bf16 v[136:139], v[80:83], v[224:227], v[136:139]
  s_waitcnt lgkmcnt(8)
  v_mfma_f32_16x16x32_bf16 v[176:179], v[84:87], v[220:223], v[176:179]
  ds_read_b128 v[104:107], v11 offset:46080
  v_mfma_f32_16x16x32_bf16 v[140:143], v[84:87], v[224:227], v[140:143]
  s_waitcnt lgkmcnt(8)
  v_mfma_f32_16x16x32_bf16 v[180:183], v[88:91], v[220:223], v[180:183]
  ds_read_b128 v[108:111], v11 offset:47104
  v_mfma_f32_16x16x32_bf16 v[144:147], v[88:91], v[224:227], v[144:147]
  s_waitcnt lgkmcnt(8)
  v_mfma_f32_16x16x32_bf16 v[184:187], v[92:95], v[220:223], v[184:187]
  ds_read_b128 v[112:115], v11 offset:48128
  v_mfma_f32_16x16x32_bf16 v[148:151], v[92:95], v[224:227], v[148:151]
  s_waitcnt lgkmcnt(6)
  v_mfma_f32_16x16x32_bf16 v[168:171], v[96:99], v[124:127], v[168:171]
  s_barrier
  ds_read_b64_tr_b16 v[116:117], v10 offset:0
  ds_read_b64_tr_b16 v[118:119], v10 offset:4096
  s_waitcnt lgkmcnt(6)
  v_mfma_f32_16x16x32_bf16 v[132:135], v[96:99], v[128:131], v[132:135]
  ds_read_b128 v[44:47], v8 offset:0
  ds_read_b64_tr_b16 v[120:121], v9 offset:0
  ds_read_b64_tr_b16 v[122:123], v9 offset:4096
  s_waitcnt lgkmcnt(8)
  v_mfma_f32_16x16x32_bf16 v[172:175], v[100:103], v[124:127], v[172:175]
  ds_read_b128 v[48:51], v8 offset:1024
  v_mfma_f32_16x16x32_bf16 v[136:139], v[100:103], v[128:131], v[136:139]
  buffer_load_dwordx4 v[24:27], v24, s[12:15], 0 offen sc1
  s_waitcnt lgkmcnt(8)
  v_mfma_f32_16x16x32_bf16 v[176:179], v[104:107], v[124:127], v[176:179]
  ds_read_b128 v[52:55], v8 offset:2048
  v_mfma_f32_16x16x32_bf16 v[140:143], v[104:107], v[128:131], v[140:143]
  s_waitcnt lgkmcnt(8)
  v_mfma_f32_16x16x32_bf16 v[180:183], v[108:111], v[124:127], v[180:183]
  buffer_load_dwordx4 v[28:31], v28, s[12:15], 0 offen sc1
  ds_read_b128 v[56:59], v8 offset:3072
  v_mfma_f32_16x16x32_bf16 v[144:147], v[108:111], v[128:131], v[144:147]
  s_waitcnt lgkmcnt(8)
  v_mfma_f32_16x16x32_bf16 v[184:187], v[112:115], v[124:127], v[184:187]
  ds_read_b128 v[60:63], v8 offset:4096
  v_mfma_f32_16x16x32_bf16 v[148:151], v[112:115], v[128:131], v[148:151]
  buffer_load_dwordx4 v[32:35], v32, s[12:15], 0 offen sc1
  s_waitcnt lgkmcnt(6)
  v_mfma_f32_16x16x32_bf16 v[168:171], v[44:47], v[116:119], v[168:171]
  ds_read_b64_tr_b16 v[212:213], v10 offset:8192
  ds_read_b64_tr_b16 v[214:215], v10 offset:12288
  s_waitcnt lgkmcnt(6)
  v_mfma_f32_16x16x32_bf16 v[132:135], v[44:47], v[120:123], v[132:135]
  ds_read_b128 v[64:67], v8 offset:9216
  ds_read_b64_tr_b16 v[216:217], v9 offset:8192
  ds_read_b64_tr_b16 v[218:219], v9 offset:12288
  s_waitcnt lgkmcnt(8)
  v_mfma_f32_16x16x32_bf16 v[172:175], v[48:51], v[116:119], v[172:175]
  buffer_load_dwordx4 v[36:39], v36, s[12:15], 0 offen sc1
  ds_read_b128 v[68:71], v8 offset:10240
  v_mfma_f32_16x16x32_bf16 v[136:139], v[48:51], v[120:123], v[136:139]
  s_waitcnt lgkmcnt(8)
  v_mfma_f32_16x16x32_bf16 v[176:179], v[52:55], v[116:119], v[176:179]
  ds_read_b128 v[72:75], v8 offset:11264
  v_mfma_f32_16x16x32_bf16 v[140:143], v[52:55], v[120:123], v[140:143]
  buffer_load_dwordx4 v[40:43], v40, s[12:15], 0 offen sc1
  s_waitcnt lgkmcnt(8)
  v_mfma_f32_16x16x32_bf16 v[180:183], v[56:59], v[116:119], v[180:183]
  ds_read_b128 v[76:79], v8 offset:12288
  v_mfma_f32_16x16x32_bf16 v[144:147], v[56:59], v[120:123], v[144:147]
  s_waitcnt lgkmcnt(8)
  v_mfma_f32_16x16x32_bf16 v[184:187], v[60:63], v[116:119], v[184:187]
  ds_read_b128 v[240:243], v8 offset:13312
  v_mfma_f32_16x16x32_bf16 v[148:151], v[60:63], v[120:123], v[148:151]
  s_waitcnt lgkmcnt(6)
  v_mfma_f32_16x16x32_bf16 v[168:171], v[64:67], v[212:215], v[168:171]
  ds_read_b64_tr_b16 v[220:221], v13 offset:0
  ds_read_b64_tr_b16 v[222:223], v13 offset:4096
  s_waitcnt lgkmcnt(6)
  v_mfma_f32_16x16x32_bf16 v[132:135], v[64:67], v[216:219], v[132:135]
  ds_read_b128 v[244:247], v11 offset:5120
  ds_read_b64_tr_b16 v[224:225], v12 offset:0
  ds_read_b64_tr_b16 v[226:227], v12 offset:4096
  s_waitcnt lgkmcnt(8)
  v_mfma_f32_16x16x32_bf16 v[172:175], v[68:71], v[212:215], v[172:175]
  ds_read_b128 v[80:83], v11 offset:6144
  v_mfma_f32_16x16x32_bf16 v[136:139], v[68:71], v[216:219], v[136:139]
  s_waitcnt lgkmcnt(8)
  v_mfma_f32_16x16x32_bf16 v[176:179], v[72:75], v[212:215], v[176:179]
  ds_read_b128 v[84:87], v11 offset:7168
  v_mfma_f32_16x16x32_bf16 v[140:143], v[72:75], v[216:219], v[140:143]
  s_waitcnt lgkmcnt(8)
  v_mfma_f32_16x16x32_bf16 v[180:183], v[76:79], v[212:215], v[180:183]
  ds_read_b128 v[88:91], v11 offset:8192
  v_mfma_f32_16x16x32_bf16 v[144:147], v[76:79], v[216:219], v[144:147]
  s_waitcnt lgkmcnt(8)
  v_mfma_f32_16x16x32_bf16 v[184:187], v[240:243], v[212:215], v[184:187]
  ds_read_b64_tr_b16 v[124:125], v13 offset:8192
  ds_read_b64_tr_b16 v[126:127], v13 offset:12288
  v_mfma_f32_16x16x32_bf16 v[148:151], v[240:243], v[216:219], v[148:151]
  ds_read_b128 v[92:95], v11 offset:14336
  ds_read_b64_tr_b16 v[128:129], v12 offset:8192
  ds_read_b64_tr_b16 v[130:131], v12 offset:12288
  s_waitcnt lgkmcnt(10)
  v_mfma_f32_16x16x32_bf16 v[188:191], v[244:247], v[220:223], v[188:191]
  ds_read_b128 v[96:99], v11 offset:15360
  s_waitcnt lgkmcnt(9)
  v_mfma_f32_16x16x32_bf16 v[152:155], v[244:247], v[224:227], v[152:155]
  s_waitcnt lgkmcnt(8)
  v_mfma_f32_16x16x32_bf16 v[192:195], v[80:83], v[220:223], v[192:195]
  ds_read_b128 v[100:103], v11 offset:16384
  v_mfma_f32_16x16x32_bf16 v[156:159], v[80:83], v[224:227], v[156:159]
  s_waitcnt lgkmcnt(8)
  v_mfma_f32_16x16x32_bf16 v[196:199], v[84:87], v[220:223], v[196:199]
  ds_read_b128 v[104:107], v11 offset:17408
  v_mfma_f32_16x16x32_bf16 v[160:163], v[84:87], v[224:227], v[160:163]
  s_waitcnt lgkmcnt(8)
  v_mfma_f32_16x16x32_bf16 v[200:203], v[88:91], v[220:223], v[200:203]
  s_barrier
  ds_read_b64_tr_b16 v[116:117], v10 offset:34816
  ds_read_b64_tr_b16 v[118:119], v10 offset:38912
  v_mfma_f32_16x16x32_bf16 v[164:167], v[88:91], v[224:227], v[164:167]
  ds_read_b128 v[108:111], v8 offset:34816
  ds_read_b64_tr_b16 v[120:121], v9 offset:34816
  ds_read_b64_tr_b16 v[122:123], v9 offset:38912
  s_waitcnt lgkmcnt(10)
  v_mfma_f32_16x16x32_bf16 v[188:191], v[92:95], v[124:127], v[188:191]
  ds_read_b64_tr_b16 v[212:213], v10 offset:43008
  ds_read_b64_tr_b16 v[214:215], v10 offset:47104
  s_waitcnt lgkmcnt(10)
  v_mfma_f32_16x16x32_bf16 v[152:155], v[92:95], v[128:131], v[152:155]
  ds_read_b128 v[112:115], v8 offset:44032
  ds_read_b64_tr_b16 v[216:217], v9 offset:43008
  ds_read_b64_tr_b16 v[218:219], v9 offset:47104
  s_waitcnt lgkmcnt(12)
  v_mfma_f32_16x16x32_bf16 v[192:195], v[96:99], v[124:127], v[192:195]
  ds_read_b128 v[44:47], v8 offset:35840
  v_mfma_f32_16x16x32_bf16 v[156:159], v[96:99], v[128:131], v[156:159]
  s_waitcnt lgkmcnt(12)
  v_mfma_f32_16x16x32_bf16 v[196:199], v[100:103], v[124:127], v[196:199]
  ds_read_b128 v[48:51], v8 offset:45056
  v_mfma_f32_16x16x32_bf16 v[160:163], v[100:103], v[128:131], v[160:163]
  s_waitcnt lgkmcnt(12)
  v_mfma_f32_16x16x32_bf16 v[200:203], v[104:107], v[124:127], v[200:203]
  ds_read_b128 v[52:55], v8 offset:36864
  v_mfma_f32_16x16x32_bf16 v[164:167], v[104:107], v[128:131], v[164:167]
  s_waitcnt lgkmcnt(10)
  v_mfma_f32_16x16x32_bf16 v[168:171], v[108:111], v[116:119], v[168:171]
  ds_read_b128 v[56:59], v8 offset:46080
  s_waitcnt lgkmcnt(9)
  v_mfma_f32_16x16x32_bf16 v[132:135], v[108:111], v[120:123], v[132:135]
  s_waitcnt lgkmcnt(6)
  v_mfma_f32_16x16x32_bf16 v[168:171], v[112:115], v[212:215], v[168:171]
  ds_read_b128 v[60:63], v8 offset:37888
  s_waitcnt lgkmcnt(5)
  v_mfma_f32_16x16x32_bf16 v[132:135], v[112:115], v[216:219], v[132:135]
  s_waitcnt lgkmcnt(4)
  v_mfma_f32_16x16x32_bf16 v[172:175], v[44:47], v[116:119], v[172:175]
  ds_read_b128 v[64:67], v8 offset:47104
  v_mfma_f32_16x16x32_bf16 v[136:139], v[44:47], v[120:123], v[136:139]
  s_waitcnt lgkmcnt(4)
  v_mfma_f32_16x16x32_bf16 v[172:175], v[48:51], v[212:215], v[172:175]
  ds_read_b128 v[68:71], v8 offset:38912
  v_mfma_f32_16x16x32_bf16 v[136:139], v[48:51], v[216:219], v[136:139]
  s_waitcnt lgkmcnt(4)
  v_mfma_f32_16x16x32_bf16 v[176:179], v[52:55], v[116:119], v[176:179]
  ds_read_b128 v[72:75], v8 offset:48128
  v_mfma_f32_16x16x32_bf16 v[140:143], v[52:55], v[120:123], v[140:143]
  s_waitcnt lgkmcnt(4)
  v_mfma_f32_16x16x32_bf16 v[176:179], v[56:59], v[212:215], v[176:179]
  ds_read_b64_tr_b16 v[220:221], v13 offset:34816
  ds_read_b64_tr_b16 v[222:223], v13 offset:38912
  v_cvt_pk_bf16_f32 v228, v168, v169
  v_cvt_pk_bf16_f32 v229, v170, v171
  v_mfma_f32_16x16x32_bf16 v[140:143], v[56:59], v[216:219], v[140:143]
  ds_read_b128 v[76:79], v11 offset:39936
  ds_read_b64_tr_b16 v[224:225], v12 offset:34816
  ds_read_b64_tr_b16 v[226:227], v12 offset:38912
  v_cvt_pk_bf16_f32 v230, v172, v173
  v_cvt_pk_bf16_f32 v231, v174, v175
  buffer_store_dwordx4 v[228:231], v14, s[16:19], s36 offen offset:0 sc1
  s_waitcnt lgkmcnt(8)
  v_mfma_f32_16x16x32_bf16 v[180:183], v[60:63], v[116:119], v[180:183]
  ds_read_b128 v[240:243], v11 offset:40960
  v_cvt_pk_bf16_f32 v232, v132, v133
  v_cvt_pk_bf16_f32 v233, v134, v135
  v_mfma_f32_16x16x32_bf16 v[144:147], v[60:63], v[120:123], v[144:147]
  v_cvt_pk_bf16_f32 v234, v136, v137
  v_cvt_pk_bf16_f32 v235, v138, v139
  s_waitcnt lgkmcnt(8)
  v_mfma_f32_16x16x32_bf16 v[180:183], v[64:67], v[212:215], v[180:183]
  ds_read_b128 v[244:247], v11 offset:41984
  v_mfma_f32_16x16x32_bf16 v[144:147], v[64:67], v[216:219], v[144:147]
  s_waitcnt lgkmcnt(8)
  v_mfma_f32_16x16x32_bf16 v[184:187], v[68:71], v[116:119], v[184:187]
  ds_read_b128 v[80:83], v11 offset:43008
  v_mfma_f32_16x16x32_bf16 v[148:151], v[68:71], v[120:123], v[148:151]
  buffer_store_dwordx4 v[232:235], v14, s[16:19], s35 offen offset:0 sc1
  s_waitcnt lgkmcnt(8)
  v_mfma_f32_16x16x32_bf16 v[184:187], v[72:75], v[212:215], v[184:187]
  ds_read_b64_tr_b16 v[124:125], v13 offset:43008
  ds_read_b64_tr_b16 v[126:127], v13 offset:47104
  v_cvt_pk_bf16_f32 v236, v176, v177
  v_cvt_pk_bf16_f32 v237, v178, v179
  v_mfma_f32_16x16x32_bf16 v[148:151], v[72:75], v[216:219], v[148:151]
  ds_read_b128 v[84:87], v11 offset:49152
  ds_read_b64_tr_b16 v[128:129], v12 offset:43008
  ds_read_b64_tr_b16 v[130:131], v12 offset:47104
  v_cvt_pk_bf16_f32 v238, v180, v181
  v_cvt_pk_bf16_f32 v239, v182, v183
  s_waitcnt lgkmcnt(10)
  v_mfma_f32_16x16x32_bf16 v[188:191], v[76:79], v[220:223], v[188:191]
  ds_read_b128 v[88:91], v11 offset:50176
  s_waitcnt lgkmcnt(9)
  v_mfma_f32_16x16x32_bf16 v[152:155], v[76:79], v[224:227], v[152:155]
  s_waitcnt lgkmcnt(8)
  v_mfma_f32_16x16x32_bf16 v[192:195], v[240:243], v[220:223], v[192:195]
  ds_read_b128 v[92:95], v11 offset:51200
  v_mfma_f32_16x16x32_bf16 v[156:159], v[240:243], v[224:227], v[156:159]
  buffer_store_dwordx4 v[236:239], v14, s[16:19], s36 offen offset:1024 sc1
  v_cvt_pk_bf16_f32 v228, v140, v141
  v_cvt_pk_bf16_f32 v229, v142, v143
  s_waitcnt lgkmcnt(8)
  v_mfma_f32_16x16x32_bf16 v[196:199], v[244:247], v[220:223], v[196:199]
  ds_read_b128 v[96:99], v11 offset:52224
  v_cvt_pk_bf16_f32 v230, v144, v145
  v_cvt_pk_bf16_f32 v231, v146, v147
  v_mfma_f32_16x16x32_bf16 v[160:163], v[244:247], v[224:227], v[160:163]
  s_waitcnt lgkmcnt(8)
  v_mfma_f32_16x16x32_bf16 v[200:203], v[80:83], v[220:223], v[200:203]
  ds_read_b64_tr_b16 v[116:117], v10 offset:0
  ds_read_b64_tr_b16 v[118:119], v10 offset:4096
  v_mfma_f32_16x16x32_bf16 v[164:167], v[80:83], v[224:227], v[164:167]
  ds_read_b128 v[100:103], v8 offset:5120
  ds_read_b128 v[104:107], v8 offset:6144
  s_waitcnt lgkmcnt(9)
  v_mfma_f32_16x16x32_bf16 v[188:191], v[84:87], v[124:127], v[188:191]
  ds_read_b64_tr_b16 v[120:121], v10 offset:8192
  ds_read_b64_tr_b16 v[122:123], v10 offset:12288
  s_waitcnt lgkmcnt(9)
  v_mfma_f32_16x16x32_bf16 v[152:155], v[84:87], v[128:131], v[152:155]
  ds_read_b128 v[108:111], v8 offset:14336
  ds_read_b128 v[112:115], v8 offset:15360
  buffer_store_dwordx4 v[228:231], v14, s[16:19], s35 offen offset:1024 sc1
  v_cvt_pk_bf16_f32 v232, v184, v185
  v_cvt_pk_bf16_f32 v233, v186, v187
  s_waitcnt lgkmcnt(10)
  v_mfma_f32_16x16x32_bf16 v[192:195], v[88:91], v[124:127], v[192:195]
  ds_read_b64_tr_b16 v[212:213], v10 offset:34816
  ds_read_b64_tr_b16 v[214:215], v10 offset:38912
  v_mfma_f32_16x16x32_bf16 v[156:159], v[88:91], v[128:131], v[156:159]
  ds_read_b128 v[44:47], v8 offset:39936
  ds_read_b128 v[48:51], v8 offset:40960
  s_waitcnt lgkmcnt(13)
  v_mfma_f32_16x16x32_bf16 v[196:199], v[92:95], v[124:127], v[196:199]
  ds_read_b64_tr_b16 v[216:217], v10 offset:43008
  ds_read_b64_tr_b16 v[218:219], v10 offset:47104
  v_mfma_f32_16x16x32_bf16 v[160:163], v[92:95], v[128:131], v[160:163]
  ds_read_b128 v[52:55], v8 offset:49152
  ds_read_b128 v[56:59], v8 offset:50176
  s_waitcnt lgkmcnt(15)
  v_mfma_f32_16x16x32_bf16 v[200:203], v[96:99], v[124:127], v[200:203]
  ds_read_b128 v[60:63], v8 offset:7168
  v_mfma_f32_16x16x32_bf16 v[164:167], v[96:99], v[128:131], v[164:167]
  ds_read_b128 v[64:67], v8 offset:8192
  buffer_store_dwordx2 v[232:233], v2, s[16:19], s36 offen offset:2048 sc1
  v_cvt_pk_bf16_f32 v236, v148, v149
  v_cvt_pk_bf16_f32 v237, v150, v151
  s_waitcnt lgkmcnt(15)
  v_mfma_f32_16x16x32_bf16 v[188:191], v[100:103], v[116:119], v[188:191]
  ds_read_b128 v[68:71], v8 offset:16384
  s_waitcnt lgkmcnt(15)
  v_mfma_f32_16x16x32_bf16 v[192:195], v[104:107], v[116:119], v[192:195]
  ds_read_b128 v[72:75], v8 offset:17408
  s_waitcnt lgkmcnt(13)
  v_mfma_f32_16x16x32_bf16 v[188:191], v[108:111], v[120:123], v[188:191]
  ds_read_b128 v[76:79], v8 offset:41984
  s_waitcnt lgkmcnt(13)
  v_mfma_f32_16x16x32_bf16 v[192:195], v[112:115], v[120:123], v[192:195]
  ds_read_b128 v[240:243], v8 offset:43008
  s_waitcnt lgkmcnt(11)
  v_mfma_f32_16x16x32_bf16 v[188:191], v[44:47], v[212:215], v[188:191]
  ds_read_b128 v[244:247], v8 offset:51200
  s_waitcnt lgkmcnt(11)
  v_mfma_f32_16x16x32_bf16 v[192:195], v[48:51], v[212:215], v[192:195]
  ds_read_b128 v[80:83], v8 offset:52224
  buffer_store_dwordx2 v[236:237], v2, s[16:19], s35 offen offset:2048 sc1
  s_waitcnt lgkmcnt(9)
  v_mfma_f32_16x16x32_bf16 v[188:191], v[52:55], v[216:219], v[188:191]
  ds_read_b64_tr_b16 v[220:221], v9 offset:0
  ds_read_b64_tr_b16 v[222:223], v9 offset:4096
  s_waitcnt lgkmcnt(10)
  v_mfma_f32_16x16x32_bf16 v[192:195], v[56:59], v[216:219], v[192:195]
  s_waitcnt lgkmcnt(9)
  v_mfma_f32_16x16x32_bf16 v[196:199], v[60:63], v[116:119], v[196:199]
  s_waitcnt lgkmcnt(8)
  v_mfma_f32_16x16x32_bf16 v[200:203], v[64:67], v[116:119], v[200:203]
  s_waitcnt lgkmcnt(7)
  v_mfma_f32_16x16x32_bf16 v[196:199], v[68:71], v[120:123], v[196:199]
  ds_read_b64_tr_b16 v[224:225], v9 offset:8192
  ds_read_b64_tr_b16 v[226:227], v9 offset:12288
  v_cvt_pk_bf16_f32 v228, v188, v189
  v_cvt_pk_bf16_f32 v229, v190, v191
  s_waitcnt lgkmcnt(8)
  v_mfma_f32_16x16x32_bf16 v[200:203], v[72:75], v[120:123], v[200:203]
  v_cvt_pk_bf16_f32 v230, v192, v193
  v_cvt_pk_bf16_f32 v231, v194, v195
  buffer_store_dwordx4 v[228:231], v14, s[16:19], s31 offen offset:0 sc1
  s_waitcnt lgkmcnt(7)
  v_mfma_f32_16x16x32_bf16 v[196:199], v[76:79], v[212:215], v[196:199]
  s_waitcnt lgkmcnt(6)
  v_mfma_f32_16x16x32_bf16 v[200:203], v[240:243], v[212:215], v[200:203]
  s_waitcnt lgkmcnt(5)
  v_mfma_f32_16x16x32_bf16 v[196:199], v[244:247], v[216:219], v[196:199]
  ds_read_b64_tr_b16 v[124:125], v9 offset:34816
  ds_read_b64_tr_b16 v[126:127], v9 offset:38912
  s_waitcnt lgkmcnt(6)
  v_mfma_f32_16x16x32_bf16 v[200:203], v[80:83], v[216:219], v[200:203]
  s_waitcnt lgkmcnt(4)
  v_mfma_f32_16x16x32_bf16 v[152:155], v[100:103], v[220:223], v[152:155]
  v_mfma_f32_16x16x32_bf16 v[156:159], v[104:107], v[220:223], v[156:159]
  v_mfma_f32_16x16x32_bf16 v[160:163], v[60:63], v[220:223], v[160:163]
  ds_read_b64_tr_b16 v[128:129], v9 offset:43008
  ds_read_b64_tr_b16 v[130:131], v9 offset:47104
  v_mfma_f32_16x16x32_bf16 v[164:167], v[64:67], v[220:223], v[164:167]
  s_waitcnt lgkmcnt(4)
  v_mfma_f32_16x16x32_bf16 v[152:155], v[108:111], v[224:227], v[152:155]
  v_cvt_pk_bf16_f32 v232, v196, v197
  v_cvt_pk_bf16_f32 v233, v198, v199
  v_mfma_f32_16x16x32_bf16 v[156:159], v[112:115], v[224:227], v[156:159]
  v_cvt_pk_bf16_f32 v234, v200, v201
  v_cvt_pk_bf16_f32 v235, v202, v203
  buffer_store_dwordx4 v[232:235], v14, s[16:19], s31 offen offset:1024 sc1
  v_mfma_f32_16x16x32_bf16 v[160:163], v[68:71], v[224:227], v[160:163]
  v_mfma_f32_16x16x32_bf16 v[164:167], v[72:75], v[224:227], v[164:167]
  s_waitcnt lgkmcnt(2)
  v_mfma_f32_16x16x32_bf16 v[152:155], v[44:47], v[124:127], v[152:155]
  v_mfma_f32_16x16x32_bf16 v[156:159], v[48:51], v[124:127], v[156:159]
  v_mfma_f32_16x16x32_bf16 v[160:163], v[76:79], v[124:127], v[160:163]
  v_mfma_f32_16x16x32_bf16 v[164:167], v[240:243], v[124:127], v[164:167]
  s_waitcnt lgkmcnt(0)
  v_mfma_f32_16x16x32_bf16 v[152:155], v[52:55], v[128:131], v[152:155]
  v_mfma_f32_16x16x32_bf16 v[156:159], v[56:59], v[128:131], v[156:159]
  v_mfma_f32_16x16x32_bf16 v[160:163], v[244:247], v[128:131], v[160:163]
  v_mfma_f32_16x16x32_bf16 v[164:167], v[80:83], v[128:131], v[164:167]
  s_waitcnt vmcnt(8)
  v_mfma_f32_16x16x32_bf16 v[80:83], v[24:27], v[208:211], 0
  v_mfma_f32_16x16x32_bf16 v[84:87], v[28:31], v[208:211], 0
  v_mfma_f32_16x16x32_bf16 v[88:91], v[32:35], v[208:211], 0
  v_mfma_f32_16x16x32_bf16 v[92:95], v[36:39], v[208:211], 0
  v_lshlrev_b32 v20, 16, v20
  v_add_f32 v20, v20, v18
  s_mov_b32 s37, 0
  v_mul_u32_u24 v4, 10224, v1
  v_add_u32 v4, v4, v15
  s_waitcnt vmcnt(0)
L_p0_3196:
  s_mov_b64 exec, 7
L_p1_3194:
  buffer_load_dword v2, v4, s[16:19], 0 offen offset:2044 sc1
  s_add_u32 s37, s37, 1
  s_waitcnt vmcnt(0)
  v_cmp_eq_u32 vcc, -1, v2
  s_cmp_gt_u32 s37, 262144
  s_cbranch_scc1 L_g1_3195
  s_cbranch_vccz L_g1_3195
  s_sleep 6
  s_branch L_p1_3194
L_g1_3195:
  s_mov_b64 exec, -1
L_poll_3192:
  s_mov_b32 s35, 0
  buffer_load_dwordx4 v[44:47], v15, s[16:19], s35 offen offset:0 sc1
  buffer_load_dwordx4 v[48:51], v15, s[16:19], s35 offen offset:1024 sc1
  s_mov_b32 s35, 10240
  buffer_load_dwordx4 v[56:59], v15, s[16:19], s35 offen offset:0 sc1
  buffer_load_dwordx4 v[60:63], v15, s[16:19], s35 offen offset:1024 sc1
  s_mov_b32 s35, 20480
  buffer_load_dwordx4 v[68:71], v15, s[16:19], s35 offen offset:0 sc1
  buffer_load_dwordx4 v[72:75], v15, s[16:19], s35 offen offset:1024 sc1
  s_add_u32 s37, s37, 1
  s_waitcnt vmcnt(0)
  v_max3_u32 v2, v44, v45, v46
  v_max3_u32 v2, v2, v47, v48
  v_max3_u32 v2, v2, v49, v50
  v_max3_u32 v2, v2, v51, v56
  v_max3_u32 v2, v2, v57, v58
  v_max3_u32 v2, v2, v59, v60
  v_max3_u32 v2, v2, v61, v62
  v_max3_u32 v2, v2, v63, v68
  v_max3_u32 v2, v2, v69, v70
  v_max3_u32 v2, v2, v71, v72
  v_max3_u32 v2, v2, v73, v74
  v_max_u32 v2, v2, v75
  v_cmp_eq_u32 vcc, -1, v2
  s_cmp_gt_u32 s37, 262144
  s_cbranch_scc1 L_got_3193
  s_cbranch_vccz L_got_3193
  s_sleep 6
  s_branch L_poll_3192
L_got_3193:
  v_fma_f32 v80, v80, v19, v20
  v_fma_f32 v81, v81, v19, v20
  v_fma_f32 v82, v82, v19, v20
  v_fma_f32 v83, v83, v19, v20
  v_add_f32 v152, v152, v80
  v_add_f32 v153, v153, v81
  v_add_f32 v154, v154, v82
  v_add_f32 v155, v155, v83
  v_lshlrev_b32 v2, 16, v44
  v_and_b32 v44, 0xffff0000, v44
  v_add_f32 v152, v152, v2
  v_add_f32 v153, v153, v44
  v_lshlrev_b32 v2, 16, v45
  v_and_b32 v45, 0xffff0000, v45
  v_add_f32 v154, v154, v2
  v_add_f32 v155, v155, v45
  v_lshlrev_b32 v2, 16, v56
  v_and_b32 v56, 0xffff0000, v56
  v_add_f32 v152, v152, v2
  v_add_f32 v153, v153, v56
  v_lshlrev_b32 v2, 16, v57
  v_and_b32 v57, 0xffff0000, v57
  v_add_f32 v154, v154, v2
  v_add_f32 v155, v155, v57
  v_lshlrev_b32 v2, 16, v68
  v_and_b32 v68, 0xffff0000, v68
  v_add_f32 v152, v152, v2
  v_add_f32 v153, v153, v68
  v_lshlrev_b32 v2, 16, v69
  v_and_b32 v69, 0xffff0000, v69
  v_add_f32 v154, v154, v2
  v_add_f32 v155, v155, v69
  v_cvt_pk_bf16_f32 v24, v152, v153
  v_cvt_pk_bf16_f32 v25, v154, v155
  v_fma_f32 v84, v84, v19, v20
  v_fma_f32 v85, v85, v19, v20
  v_fma_f32 v86, v86, v19, v20
  v_fma_f32 v87, v87, v19, v20
  v_add_f32 v156, v156, v84
  v_add_f32 v157, v157, v85
  v_add_f32 v158, v158, v86
  v_add_f32 v159, v159, v87
  v_lshlrev_b32 v2, 16, v46
  v_and_b32 v46, 0xffff0000, v46
  v_add_f32 v156, v156, v2
  v_add_f32 v157, v157, v46
  v_lshlrev_b32 v2, 16, v47
  v_and_b32 v47, 0xffff0000, v47
  v_add_f32 v158, v158, v2
  v_add_f32 v159, v159, v47
  v_lshlrev_b32 v2, 16, v58
  v_and_b32 v58, 0xffff0000, v58
  v_add_f32 v156, v156, v2
  v_add_f32 v157, v157, v58
  v_lshlrev_b32 v2, 16, v59
  v_and_b32 v59, 0xffff0000, v59
  v_add_f32 v158, v158, v2
  v_add_f32 v159, v159, v59
  v_lshlrev_b32 v2, 16, v70
  v_and_b32 v70, 0xffff0000, v70
  v_add_f32 v156, v156, v2
  v_add_f32 v157, v157, v70
  v_lshlrev_b32 v2, 16, v71
  v_and_b32 v71, 0xffff0000, v71
  v_add_f32 v158, v158, v2
  v_add_f32 v159, v159, v71
  v_cvt_pk_bf16_f32 v26, v156, v157
  v_cvt_pk_bf16_f32 v27, v158, v159
  s_nop 0
  v_permlane16_swap_b32 v24, v26
  v_permlane16_swap_b32 v25, v27
  buffer_store_dwordx4 v[24:27], v16, s[20:23], 0 offen offset:0
  v_fma_f32 v88, v88, v19, v20
  v_fma_f32 v89, v89, v19, v20
  v_fma_f32 v90, v90, v19, v20
  v_fma_f32 v91, v91, v19, v20
  v_add_f32 v160, v160, v88
  v_add_f32 v161, v161, v89
  v_add_f32 v162, v162, v90
  v_add_f32 v163, v163, v91
  v_lshlrev_b32 v2, 16, v48
  v_and_b32 v48, 0xffff0000, v48
  v_add_f32 v160, v160, v2
  v_add_f32 v161, v161, v48
  v_lshlrev_b32 v2, 16, v49
  v_and_b32 v49, 0xffff0000, v49
  v_add_f32 v162, v162, v2
  v_add_f32 v163, v163, v49
  v_lshlrev_b32 v2, 16, v60
  v_and_b32 v60, 0xffff0000, v60
  v_add_f32 v160, v160, v2
  v_add_f32 v161, v161, v60
  v_lshlrev_b32 v2, 16, v61
  v_and_b32 v61, 0xffff0000, v61
  v_add_f32 v162, v162, v2
  v_add_f32 v163, v163, v61
  v_lshlrev_b32 v2, 16, v72
  v_and_b32 v72, 0xffff0000, v72
  v_add_f32 v160, v160, v2
  v_add_f32 v161, v161, v72
  v_lshlrev_b32 v2, 16, v73
  v_and_b32 v73, 0xffff0000, v73
  v_add_f32 v162, v162, v2
  v_add_f32 v163, v163, v73
  v_cvt_pk_bf16_f32 v28, v160, v161
  v_cvt_pk_bf16_f32 v29, v162, v163
  v_fma_f32 v92, v92, v19, v20
  v_fma_f32 v93, v93, v19, v20
  v_fma_f32 v94, v94, v19, v20
  v_fma_f32 v95, v95, v19, v20
  v_add_f32 v164, v164, v92
  v_add_f32 v165, v165, v93
  v_add_f32 v166, v166, v94
  v_add_f32 v167, v167, v95
  v_lshlrev_b32 v2, 16, v50
  v_and_b32 v50, 0xffff0000, v50
  v_add_f32 v164, v164, v2
  v_add_f32 v165, v165, v50
  v_lshlrev_b32 v2, 16, v51
  v_and_b32 v51, 0xffff0000, v51
  v_add_f32 v166, v166, v2
  v_add_f32 v167, v167, v51
  v_lshlrev_b32 v2, 16, v62
  v_and_b32 v62, 0xffff0000, v62
  v_add_f32 v164, v164, v2
  v_add_f32 v165, v165, v62
  v_lshlrev_b32 v2, 16, v63
  v_and_b32 v63, 0xffff0000, v63
  v_add_f32 v166, v166, v2
  v_add_f32 v167, v167, v63
  v_lshlrev_b32 v2, 16, v74
  v_and_b32 v74, 0xffff0000, v74
  v_add_f32 v164, v164, v2
  v_add_f32 v165, v165, v74
  v_lshlrev_b32 v2, 16, v75
  v_and_b32 v75, 0xffff0000, v75
  v_add_f32 v166, v166, v2
  v_add_f32 v167, v167, v75
  v_cvt_pk_bf16_f32 v30, v164, v165
  v_cvt_pk_bf16_f32 v31, v166, v167
  s_nop 0
  v_permlane16_swap_b32 v28, v30
  v_permlane16_swap_b32 v29, v31
  buffer_store_dwordx4 v[28:31], v16, s[20:23], 0 offen offset:64
  s_endpgm
L_q2_3185:
L_x2:
  v_lshlrev_b32 v2, 3, v1
  v_sub_u32 v3, v15, v2
  v_sub_u32 v2, v14, v2
  s_mov_b32 s35, 10240
  s_mov_b32 s36, 30720
  s_mov_b32 s31, 112640
  s_waitcnt lgkmcnt(0)
  s_barrier
  v_mfma_f32_16x16x32_bf16 v[132:135], v[80:83], v[124:127], v[132:135]
  v_mfma_f32_16x16x32_bf16 v[168:171], v[80:83], v[128:131], v[168:171]
  v_mfma_f32_16x16x32_bf16 v[136:139], v[84:87], v[124:127], v[136:139]
  v_mfma_f32_16x16x32_bf16 v[172:175], v[84:87], v[128:131], v[172:175]
  v_mfma_f32_16x16x32_bf16 v[140:143], v[88:91], v[124:127], v[140:143]
  v_mfma_f32_16x16x32_bf16 v[176:179], v[88:91], v[128:131], v[176:179]
  v_mfma_f32_16x16x32_bf16 v[144:147], v[92:95], v[124:127], v[144:147]
  v_mfma_f32_16x16x32_bf16 v[180:183], v[92:95], v[128:131], v[180:183]
  v_mfma_f32_16x16x32_bf16 v[148:151], v[96:99], v[124:127], v[148:151]
  ds_read_b64_tr_b16 v[116:117], v12 offset:0
  ds_read_b64_tr_b16 v[118:119], v12 offset:4096
  v_mfma_f32_16x16x32_bf16 v[184:187], v[96:99], v[128:131], v[184:187]
  ds_read_b128 v[44:47], v11 offset:5120
  ds_read_b64_tr_b16 v[120:121], v13 offset:0
  ds_read_b64_tr_b16 v[122:123], v13 offset:4096
  v_mfma_f32_16x16x32_bf16 v[152:155], v[100:103], v[124:127], v[152:155]
  ds_read_b128 v[48:51], v11 offset:6144
  v_mfma_f32_16x16x32_bf16 v[188:191], v[100:103], v[128:131], v[188:191]
  v_mfma_f32_16x16x32_bf16 v[156:159], v[104:107], v[124:127], v[156:159]
  ds_read_b128 v[52:55], v11 offset:7168
  v_mfma_f32_16x16x32_bf16 v[192:195], v[104:107], v[128:131], v[192:195]
  v_mfma_f32_16x16x32_bf16 v[160:163], v[108:111], v[124:127], v[160:163]
  ds_read_b128 v[56:59], v11 offset:8192
  v_mfma_f32_16x16x32_bf16 v[196:199], v[108:111], v[128:131], v[196:199]
  v_mfma_f32_16x16x32_bf16 v[164:167], v[112:115], v[124:127], v[164:167]
  ds_read_b64_tr_b16 v[212:213], v12 offset:8192
  ds_read_b64_tr_b16 v[214:215], v12 offset:12288
  v_mfma_f32_16x16x32_bf16 v[200:203], v[112:115], v[128:131], v[200:203]
  ds_read_b128 v[60:63], v11 offset:14336
  ds_read_b64_tr_b16 v[216:217], v13 offset:8192
  ds_read_b64_tr_b16 v[218:219], v13 offset:12288
  s_waitcnt lgkmcnt(10)
  v_mfma_f32_16x16x32_bf16 v[152:155], v[44:47], v[116:119], v[152:155]
  ds_read_b128 v[64:67], v11 offset:15360
  s_waitcnt lgkmcnt(9)
  v_mfma_f32_16x16x32_bf16 v[188:191], v[44:47], v[120:123], v[188:191]
  s_waitcnt lgkmcnt(8)
  v_mfma_f32_16x16x32_bf16 v[156:159], v[48:51], v[116:119], v[156:159]
  ds_read_b128 v[68:71], v11 offset:16384
  v_mfma_f32_16x16x32_bf16 v[192:195], v[48:51], v[120:123], v[192:195]
  s_waitcnt lgkmcnt(8)
  v_mfma_f32_16x16x32_bf16 v[160:163], v[52:55], v[116:119], v[160:163]
  ds_read_b128 v[72:75], v11 offset:17408
  v_mfma_f32_16x16x32_bf16 v[196:199], v[52:55], v[120:123], v[196:199]
  s_waitcnt lgkmcnt(8)
  v_mfma_f32_16x16x32_bf16 v[164:167], v[56:59], v[116:119], v[164:167]
  s_barrier
  ds_read_b64_tr_b16 v[220:221], v12 offset:34816
  ds_read_b64_tr_b16 v[222:223], v12 offset:38912
  v_mfma_f32_16x16x32_bf16 v[200:203], v[56:59], v[120:123], v[200:203]
  ds_read_b128 v[76:79], v11 offset:39936
  ds_read_b64_tr_b16 v[224:225], v13 offset:34816
  ds_read_b64_tr_b16 v[226:227], v13 offset:38912
  s_waitcnt lgkmcnt(10)
  v_mfma_f32_16x16x32_bf16 v[152:155], v[60:63], v[212:215], v[152:155]
  ds_read_b128 v[240:243], v11 offset:40960
  s_waitcnt lgkmcnt(9)
  v_mfma_f32_16x16x32_bf16 v[188:191], v[60:63], v[216:219], v[188:191]
  s_waitcnt lgkmcnt(8)
  v_mfma_f32_16x16x32_bf16 v[156:159], v[64:67], v[212:215], v[156:159]
  ds_read_b128 v[244:247], v11 offset:41984
  v_mfma_f32_16x16x32_bf16 v[192:195], v[64:67], v[216:219], v[192:195]
  s_waitcnt lgkmcnt(8)
  v_mfma_f32_16x16x32_bf16 v[160:163], v[68:71], v[212:215], v[160:163]
  ds_read_b128 v[80:83], v11 offset:43008
  v_mfma_f32_16x16x32_bf16 v[196:199], v[68:71], v[216:219], v[196:199]
  s_waitcnt lgkmcnt(8)
  v_mfma_f32_16x16x32_bf16 v[164:167], v[72:75], v[212:215], v[164:167]
  ds_read_b64_tr_b16 v[124:125], v12 offset:43008
  ds_read_b64_tr_b16 v[126:127], v12 offset:47104
  v_mfma_f32_16x16x32_bf16 v[200:203], v[72:75], v[216:219], v[200:203]
  ds_read_b128 v[84:87], v11 offset:49152
  ds_read_b64_tr_b16 v[128:129], v13 offset:43008
  ds_read_b64_tr_b16 v[130:131], v13 offset:47104
  s_waitcnt lgkmcnt(10)
  v_mfma_f32_16x16x32_bf16 v[152:155], v[76:79], v[220:223], v[152:155]
  ds_read_b128 v[88:91], v11 offset:50176
  s_waitcnt lgkmcnt(9)
  v_mfma_f32_16x16x32_bf16 v[188:191], v[76:79], v[224:227], v[188:191]
  s_waitcnt lgkmcnt(8)
  v_mfma_f32_16x16x32_bf16 v[156:159], v[240:243], v[220:223], v[156:159]
  ds_read_b128 v[92:95], v11 offset:51200
  v_mfma_f32_16x16x32_bf16 v[192:195], v[240:243], v[224:227], v[192:195]
  s_waitcnt lgkmcnt(8)
  v_mfma_f32_16x16x32_bf16 v[160:163], v[244:247], v[220:223], v[160:163]
  ds_read_b128 v[96:99], v11 offset:52224
  v_mfma_f32_16x16x32_bf16 v[196:199], v[244:247], v[224:227], v[196:199]
  s_waitcnt lgkmcnt(8)
  v_mfma_f32_16x16x32_bf16 v[164:167], v[80:83], v[220:223], v[164:167]
  s_barrier
  ds_read_b64_tr_b16 v[116:117], v9 offset:0
  ds_read_b64_tr_b16 v[118:119], v9 offset:4096
  v_mfma_f32_16x16x32_bf16 v[200:203], v[80:83], v[224:227], v[200:203]
  ds_read_b128 v[100:103], v8 offset:5120
  ds_read_b64_tr_b16 v[120:121], v10 offset:0
  ds_read_b64_tr_b16 v[122:123], v10 offset:4096
  s_waitcnt lgkmcnt(10)
  v_mfma_f32_16x16x32_bf16 v[152:155], v[84:87], v[124:127], v[152:155]
  ds_read_b128 v[104:107], v8 offset:6144
  s_waitcnt lgkmcnt(9)
  v_mfma_f32_16x16x32_bf16 v[188:191], v[84:87], v[128:131], v[188:191]
  buffer_load_dwordx4 v[24:27], v24, s[12:15], 0 offen sc1
  s_waitcnt lgkmcnt(8)
  v_mfma_f32_16x16x32_bf16 v[156:159], v[88:91], v[124:127], v[156:159]
  ds_read_b128 v[108:111], v8 offset:7168
  v_mfma_f32_16x16x32_bf16 v[192:195], v[88:91], v[128:131], v[192:195]
  s_waitcnt lgkmcnt(8)
  v_mfma_f32_16x16x32_bf16 v[160:163], v[92:95], v[124:127], v[160:163]
  buffer_load_dwordx4 v[28:31], v28, s[12:15], 0 offen sc1
  ds_read_b128 v[112:115], v8 offset:8192
  v_mfma_f32_16x16x32_bf16 v[196:199], v[92:95], v[128:131], v[196:199]
  s_waitcnt lgkmcnt(8)
  v_mfma_f32_16x16x32_bf16 v[164:167], v[96:99], v[124:127], v[164:167]
  ds_read_b64_tr_b16 v[212:213], v9 offset:8192
  ds_read_b64_tr_b16 v[214:215], v9 offset:12288
  v_mfma_f32_16x16x32_bf16 v[200:203], v[96:99], v[128:131], v[200:203]
  buffer_load_dwordx4 v[32:35], v32, s[12:15], 0 offen sc1
  ds_read_b128 v[44:47], v8 offset:14336
  ds_read_b64_tr_b16 v[216:217], v10 offset:8192
  ds_read_b64_tr_b16 v[218:219], v10 offset:12288
  s_waitcnt lgkmcnt(10)
  v_mfma_f32_16x16x32_bf16 v[152:155], v[100:103], v[116:119], v[152:155]
  ds_read_b128 v[48:51], v8 offset:15360
  s_waitcnt lgkmcnt(9)
  v_mfma_f32_16x16x32_bf16 v[188:191], v[100:103], v[120:123], v[188:191]
  s_waitcnt lgkmcnt(8)
  v_mfma_f32_16x16x32_bf16 v[156:159], v[104:107], v[116:119], v[156:159]
  buffer_load_dwordx4 v[36:39], v36, s[12:15], 0 offen sc1
  ds_read_b128 v[52:55], v8 offset:16384
  v_mfma_f32_16x16x32_bf16 v[192:195], v[104:107], v[120:123], v[192:195]
  s_waitcnt lgkmcnt(8)
  v_mfma_f32_16x16x32_bf16 v[160:163], v[108:111], v[116:119], v[160:163]
  ds_read_b128 v[56:59], v8 offset:17408
  v_mfma_f32_16x16x32_bf16 v[196:199], v[108:111], v[120:123], v[196:199]
  buffer_load_dwordx4 v[40:43], v40, s[12:15], 0 offen sc1
  s_waitcnt lgkmcnt(8)
  v_mfma_f32_16x16x32_bf16 v[164:167], v[112:115], v[116:119], v[164:167]
  ds_read_b64_tr_b16 v[220:221], v12 offset:0
  ds_read_b64_tr_b16 v[222:223], v12 offset:4096
  v_mfma_f32_16x16x32_bf16 v[200:203], v[112:115], v[120:123], v[200:203]
  ds_read_b128 v[60:63], v11 offset:0
  ds_read_b64_tr_b16 v[224:225], v13 offset:0
  ds_read_b64_tr_b16 v[226:227], v13 offset:4096
  s_waitcnt lgkmcnt(10)
  v_mfma_f32_16x16x32_bf16 v[152:155], v[44:47], v[212:215], v[152:155]
  ds_read_b128 v[64:67], v11 offset:1024
  s_waitcnt lgkmcnt(9)
  v_mfma_f32_16x16x32_bf16 v[188:191], v[44:47], v[216:219], v[188:191]
  s_waitcnt lgkmcnt(8)
  v_mfma_f32_16x16x32_bf16 v[156:159], v[48:51], v[212:215], v[156:159]
  ds_read_b128 v[68:71], v11 offset:2048
  v_mfma_f32_16x16x32_bf16 v[192:195], v[48:51], v[216:219], v[192:195]
  s_waitcnt lgkmcnt(8)
  v_mfma_f32_16x16x32_bf16 v[160:163], v[52:55], v[212:215], v[160:163]
  ds_read_b128 v[72:75], v11 offset:3072
  v_mfma_f32_16x16x32_bf16 v[196:199], v[52:55], v[216:219], v[196:199]
  s_waitcnt lgkmcnt(8)
  v_mfma_f32_16x16x32_bf16 v[164:167], v[56:59], v[212:215], v[164:167]
  ds_read_b128 v[76:79], v11 offset:4096
  v_mfma_f32_16x16x32_bf16 v[200:203], v[56:59], v[216:219], v[200:203]
  s_waitcnt lgkmcnt(6)
  v_mfma_f32_16x16x32_bf16 v[132:135], v[60:63], v[220:223], v[132:135]
  ds_read_b64_tr_b16 v[124:125], v12 offset:8192
  ds_read_b64_tr_b16 v[126:127], v12 offset:12288
  s_waitcnt lgkmcnt(6)
  v_mfma_f32_16x16x32_bf16 v[168:171], v[60:63], v[224:227], v[168:171]
  ds_read_b128 v[240:243], v11 offset:9216
  ds_read_b64_tr_b16 v[128:129], v13 offset:8192
  ds_read_b64_tr_b16 v[130:131], v13 offset:12288
  s_waitcnt lgkmcnt(8)
  v_mfma_f32_16x16x32_bf16 v[136:139], v[64:67], v[220:223], v[136:139]
  ds_read_b128 v[244:247], v11 offset:10240
  v_mfma_f32_16x16x32_bf16 v[172:175], v[64:67], v[224:227], v[172:175]
  s_waitcnt lgkmcnt(8)
  v_mfma_f32_16x16x32_bf16 v[140:143], v[68:71], v[220:223], v[140:143]
  ds_read_b128 v[80:83], v11 offset:11264
  v_mfma_f32_16x16x32_bf16 v[176:179], v[68:71], v[224:227], v[176:179]
  s_waitcnt lgkmcnt(8)
  v_mfma_f32_16x16x32_bf16 v[144:147], v[72:75], v[220:223], v[144:147]
  ds_read_b128 v[84:87], v11 offset:12288
  v_mfma_f32_16x16x32_bf16 v[180:183], v[72:75], v[224:227], v[180:183]
  s_waitcnt lgkmcnt(8)
  v_mfma_f32_16x16x32_bf16 v[148:151], v[76:79], v[220:223], v[148:151]
  ds_read_b128 v[88:91], v11 offset:13312
  v_mfma_f32_16x16x32_bf16 v[184:187], v[76:79], v[224:227], v[184:187]
  s_waitcnt lgkmcnt(6)
  v_mfma_f32_16x16x32_bf16 v[132:135], v[240:243], v[124:127], v[132:135]
  s_barrier
  ds_read_b64_tr_b16 v[116:117], v9 offset:34816
  ds_read_b64_tr_b16 v[118:119], v9 offset:38912
  s_waitcnt lgkmcnt(6)
  v_mfma_f32_16x16x32_bf16 v[168:171], v[240:243], v[128:131], v[168:171]
  ds_read_b128 v[92:95], v8 offset:39936
  ds_read_b64_tr_b16 v[120:121], v10 offset:34816
  ds_read_b64_tr_b16 v[122:123], v10 offset:38912
  s_waitcnt lgkmcnt(8)
  v_mfma_f32_16x16x32_bf16 v[136:139], v[244:247], v[124:127], v[136:139]
  ds_read_b64_tr_b16 v[212:213], v9 offset:43008
  ds_read_b64_tr_b16 v[214:215], v9 offset:47104
  v_mfma_f32_16x16x32_bf16 v[172:175], v[244:247], v[128:131], v[172:175]
  ds_read_b128 v[96:99], v8 offset:49152
  ds_read_b64_tr_b16 v[216:217], v10 offset:43008
  ds_read_b64_tr_b16 v[218:219], v10 offset:47104
  s_waitcnt lgkmcnt(12)
  v_mfma_f32_16x16x32_bf16 v[140:143], v[80:83], v[124:127], v[140:143]
  ds_read_b128 v[100:103], v8 offset:40960
  v_mfma_f32_16x16x32_bf16 v[176:179], v[80:83], v[128:131], v[176:179]
  s_waitcnt lgkmcnt(12)
  v_mfma_f32_16x16x32_bf16 v[144:147], v[84:87], v[124:127], v[144:147]
  ds_read_b128 v[104:107], v8 offset:50176
  v_mfma_f32_16x16x32_bf16 v[180:183], v[84:87], v[128:131], v[180:183]
  s_waitcnt lgkmcnt(12)
  v_mfma_f32_16x16x32_bf16 v[148:151], v[88:91], v[124:127], v[148:151]
  ds_read_b128 v[108:111], v8 offset:41984
  v_mfma_f32_16x16x32_bf16 v[184:187], v[88:91], v[128:131], v[184:187]
  s_waitcnt lgkmcnt(10)
  v_mfma_f32_16x16x32_bf16 v[152:155], v[92:95], v[116:119], v[152:155]
  ds_read_b128 v[112:115], v8 offset:51200
  s_waitcnt lgkmcnt(9)
  v_mfma_f32_16x16x32_bf16 v[188:191], v[92:95], v[120:123], v[188:191]
  s_waitcnt lgkmcnt(6)
  v_mfma_f32_16x16x32_bf16 v[152:155], v[96:99], v[212:215], v[152:155]
  ds_read_b128 v[44:47], v8 offset:43008
  s_waitcnt lgkmcnt(5)
  v_mfma_f32_16x16x32_bf16 v[188:191], v[96:99], v[216:219], v[188:191]
  s_waitcnt lgkmcnt(4)
  v_mfma_f32_16x16x32_bf16 v[156:159], v[100:103], v[116:119], v[156:159]
  ds_read_b128 v[48:51], v8 offset:52224
  v_mfma_f32_16x16x32_bf16 v[192:195], v[100:103], v[120:123], v[192:195]
  s_waitcnt lgkmcnt(4)
  v_mfma_f32_16x16x32_bf16 v[156:159], v[104:107], v[212:215], v[156:159]
  ds_read_b64_tr_b16 v[220:221], v12 offset:34816
  ds_read_b64_tr_b16 v[222:223], v12 offset:38912
  v_mfma_f32_16x16x32_bf16 v[192:195], v[104:107], v[216:219], v[192:195]
  ds_read_b128 v[52:55], v11 offset:34816
  ds_read_b64_tr_b16 v[224:225], v13 offset:34816
  ds_read_b64_tr_b16 v[226:227], v13 offset:38912
  s_waitcnt lgkmcnt(8)
  v_mfma_f32_16x16x32_bf16 v[160:163], v[108:111], v[116:119], v[160:163]
  ds_read_b128 v[56:59], v11 offset:35840
  v_cvt_pk_bf16_f32 v228, v152, v153
  v_cvt_pk_bf16_f32 v229, v154, v155
  v_mfma_f32_16x16x32_bf16 v[196:199], v[108:111], v[120:123], v[196:199]
  v_cvt_pk_bf16_f32 v230, v156, v157
  v_cvt_pk_bf16_f32 v231, v158, v159
  buffer_store_dwordx4 v[228:231], v14, s[16:19], s36 offen offset:0 sc1
  s_waitcnt lgkmcnt(8)
  v_mfma_f32_16x16x32_bf16 v[160:163], v[112:115], v[212:215], v[160:163]
  ds_read_b128 v[60:63], v11 offset:36864
  v_cvt_pk_bf16_f32 v232, v188, v189
  v_cvt_pk_bf16_f32 v233, v190, v191
  v_mfma_f32_16x16x32_bf16 v[196:199], v[112:115], v[216:219], v[196:199]
  v_cvt_pk_bf16_f32 v234, v192, v193
  v_cvt_pk_bf16_f32 v235, v194, v195
  s_waitcnt lgkmcnt(8)
  v_mfma_f32_16x16x32_bf16 v[164:167], v[44:47], v[116:119], v[164:167]
  ds_read_b128 v[64:67], v11 offset:37888
  v_mfma_f32_16x16x32_bf16 v[200:203], v[44:47], v[120:123], v[200:203]
  s_waitcnt lgkmcnt(8)
  v_mfma_f32_16x16x32_bf16 v[164:167], v[48:51], v[212:215], v[164:167]
  ds_read_b128 v[68:71], v11 offset:38912
  v_mfma_f32_16x16x32_bf16 v[200:203], v[48:51], v[216:219], v[200:203]
  buffer_store_dwordx4 v[232:235], v14, s[16:19], s31 offen offset:0 sc1
  s_waitcnt lgkmcnt(6)
  v_mfma_f32_16x16x32_bf16 v[132:135], v[52:55], v[220:223], v[132:135]
  ds_read_b64_tr_b16 v[124:125], v12 offset:43008
  ds_read_b64_tr_b16 v[126:127], v12 offset:47104
  s_waitcnt lgkmcnt(6)
  v_mfma_f32_16x16x32_bf16 v[168:171], v[52:55], v[224:227], v[168:171]
  ds_read_b128 v[72:75], v11 offset:44032
  ds_read_b64_tr_b16 v[128:129], v13 offset:43008
  ds_read_b64_tr_b16 v[130:131], v13 offset:47104
  v_cvt_pk_bf16_f32 v236, v160, v161
  v_cvt_pk_bf16_f32 v237, v162, v163
  s_waitcnt lgkmcnt(8)
  v_mfma_f32_16x16x32_bf16 v[136:139], v[56:59], v[220:223], v[136:139]
  ds_read_b128 v[76:79], v11 offset:45056
  v_cvt_pk_bf16_f32 v238, v164, v165
  v_cvt_pk_bf16_f32 v239, v166, v167
  v_mfma_f32_16x16x32_bf16 v[172:175], v[56:59], v[224:227], v[172:175]
  s_waitcnt lgkmcnt(8)
  v_mfma_f32_16x16x32_bf16 v[140:143], v[60:63], v[220:223], v[140:143]
  ds_read_b128 v[240:243], v11 offset:46080
  v_mfma_f32_16x16x32_bf16 v[176:179], v[60:63], v[224:227], v[176:179]
  buffer_store_dwordx4 v[236:239], v14, s[16:19], s36 offen offset:1024 sc1
  v_cvt_pk_bf16_f32 v228, v196, v197
  v_cvt_pk_bf16_f32 v229, v198, v199
  s_waitcnt lgkmcnt(8)
  v_mfma_f32_16x16x32_bf16 v[144:147], v[64:67], v[220:223], v[144:147]
  ds_read_b128 v[244:247], v11 offset:47104
  v_cvt_pk_bf16_f32 v230, v200, v201
  v_cvt_pk_bf16_f32 v231, v202, v203
  v_mfma_f32_16x16x32_bf16 v[180:183], v[64:67], v[224:227], v[180:183]
  s_waitcnt lgkmcnt(8)
  v_mfma_f32_16x16x32_bf16 v[148:151], v[68:71], v[220:223], v[148:151]
  ds_read_b128 v[80:83], v11 offset:48128
  v_mfma_f32_16x16x32_bf16 v[184:187], v[68:71], v[224:227], v[184:187]
  s_waitcnt lgkmcnt(6)
  v_mfma_f32_16x16x32_bf16 v[132:135], v[72:75], v[124:127], v[132:135]
  ds_read_b64_tr_b16 v[116:117], v9 offset:0
  ds_read_b64_tr_b16 v[118:119], v9 offset:4096
  s_waitcnt lgkmcnt(6)
  v_mfma_f32_16x16x32_bf16 v[168:171], v[72:75], v[128:131], v[168:171]
  ds_read_b128 v[84:87], v8 offset:0
  ds_read_b128 v[88:91], v8 offset:1024
  buffer_store_dwordx4 v[228:231], v14, s[16:19], s31 offen offset:1024 sc1
  s_waitcnt lgkmcnt(7)
  v_mfma_f32_16x16x32_bf16 v[136:139], v[76:79], v[124:127], v[136:139]
  ds_read_b64_tr_b16 v[120:121], v9 offset:8192
  ds_read_b64_tr_b16 v[122:123], v9 offset:12288
  v_mfma_f32_16x16x32_bf16 v[172:175], v[76:79], v[128:131], v[172:175]
  ds_read_b128 v[92:95], v8 offset:9216
  ds_read_b128 v[96:99], v8 offset:10240
  s_waitcnt lgkmcnt(10)
  v_mfma_f32_16x16x32_bf16 v[140:143], v[240:243], v[124:127], v[140:143]
  ds_read_b64_tr_b16 v[212:213], v9 offset:34816
  ds_read_b64_tr_b16 v[214:215], v9 offset:38912
  v_mfma_f32_16x16x32_bf16 v[176:179], v[240:243], v[128:131], v[176:179]
  ds_read_b128 v[100:103], v8 offset:34816
  ds_read_b128 v[104:107], v8 offset:35840
  s_waitcnt lgkmcnt(13)
  v_mfma_f32_16x16x32_bf16 v[144:147], v[244:247], v[124:127], v[144:147]
  ds_read_b64_tr_b16 v[216:217], v9 offset:43008
  ds_read_b64_tr_b16 v[218:219], v9 offset:47104
  v_mfma_f32_16x16x32_bf16 v[180:183], v[244:247], v[128:131], v[180:183]
  ds_read_b128 v[108:111], v8 offset:44032
  ds_read_b128 v[112:115], v8 offset:45056
  s_waitcnt lgkmcnt(15)
  v_mfma_f32_16x16x32_bf16 v[148:151], v[80:83], v[124:127], v[148:151]
  ds_read_b128 v[44:47], v8 offset:2048
  v_mfma_f32_16x16x32_bf16 v[184:187], v[80:83], v[128:131], v[184:187]
  ds_read_b128 v[48:51], v8 offset:3072
  s_waitcnt lgkmcnt(15)
  v_mfma_f32_16x16x32_bf16 v[132:135], v[84:87], v[116:119], v[132:135]
  ds_read_b128 v[52:55], v8 offset:4096
  s_waitcnt lgkmcnt(15)
  v_mfma_f32_16x16x32_bf16 v[136:139], v[88:91], v[116:119], v[136:139]
  ds_read_b128 v[56:59], v8 offset:11264
  s_waitcnt lgkmcnt(13)
  v_mfma_f32_16x16x32_bf16 v[132:135], v[92:95], v[120:123], v[132:135]
  ds_read_b128 v[60:63], v8 offset:12288
  s_waitcnt lgkmcnt(13)
  v_mfma_f32_16x16x32_bf16 v[136:139], v[96:99], v[120:123], v[136:139]
  ds_read_b128 v[64:67], v8 offset:13312
  s_waitcnt lgkmcnt(11)
  v_mfma_f32_16x16x32_bf16 v[132:135], v[100:103], v[212:215], v[132:135]
  ds_read_b128 v[68:71], v8 offset:36864
  s_waitcnt lgkmcnt(11)
  v_mfma_f32_16x16x32_bf16 v[136:139], v[104:107], v[212:215], v[136:139]
  ds_read_b128 v[72:75], v8 offset:37888
  s_waitcnt lgkmcnt(9)
  v_mfma_f32_16x16x32_bf16 v[132:135], v[108:111], v[216:219], v[132:135]
  ds_read_b128 v[76:79], v8 offset:38912
  s_waitcnt lgkmcnt(9)
  v_mfma_f32_16x16x32_bf16 v[136:139], v[112:115], v[216:219], v[136:139]
  ds_read_b128 v[240:243], v8 offset:46080
  s_waitcnt lgkmcnt(9)
  v_mfma_f32_16x16x32_bf16 v[140:143], v[44:47], v[116:119], v[140:143]
  ds_read_b128 v[244:247], v8 offset:47104
  s_waitcnt lgkmcnt(9)
  v_mfma_f32_16x16x32_bf16 v[144:147], v[48:51], v[116:119], v[144:147]
  ds_read_b128 v[80:83], v8 offset:48128
  s_waitcnt lgkmcnt(9)
  v_mfma_f32_16x16x32_bf16 v[148:151], v[52:55], v[116:119], v[148:151]
  ds_read_b64_tr_b16 v[220:221], v10 offset:0
  ds_read_b64_tr_b16 v[222:223], v10 offset:4096
  v_cvt_pk_bf16_f32 v232, v132, v133
  v_cvt_pk_bf16_f32 v233, v134, v135
  s_waitcnt lgkmcnt(10)
  v_mfma_f32_16x16x32_bf16 v[140:143], v[56:59], v[120:123], v[140:143]
  v_cvt_pk_bf16_f32 v234, v136, v137
  v_cvt_pk_bf16_f32 v235, v138, v139
  buffer_store_dwordx4 v[232:235], v14, s[16:19], s35 offen offset:0 sc1
  s_waitcnt lgkmcnt(9)
  v_mfma_f32_16x16x32_bf16 v[144:147], v[60:63], v[120:123], v[144:147]
  s_waitcnt lgkmcnt(8)
  v_mfma_f32_16x16x32_bf16 v[148:151], v[64:67], v[120:123], v[148:151]
  s_waitcnt lgkmcnt(7)
  v_mfma_f32_16x16x32_bf16 v[140:143], v[68:71], v[212:215], v[140:143]
  s_waitcnt lgkmcnt(6)
  v_mfma_f32_16x16x32_bf16 v[144:147], v[72:75], v[212:215], v[144:147]
  ds_read_b64_tr_b16 v[224:225], v10 offset:8192
  ds_read_b64_tr_b16 v[226:227], v10 offset:12288
  s_waitcnt lgkmcnt(7)
  v_mfma_f32_16x16x32_bf16 v[148:151], v[76:79], v[212:215], v[148:151]
  s_waitcnt lgkmcnt(6)
  v_mfma_f32_16x16x32_bf16 v[140:143], v[240:243], v[216:219], v[140:143]
  s_waitcnt lgkmcnt(5)
  v_mfma_f32_16x16x32_bf16 v[144:147], v[244:247], v[216:219], v[144:147]
  s_waitcnt lgkmcnt(4)
  v_mfma_f32_16x16x32_bf16 v[148:151], v[80:83], v[216:219], v[148:151]
  s_waitcnt lgkmcnt(2)
  v_mfma_f32_16x16x32_bf16 v[168:171], v[84:87], v[220:223], v[168:171]
  ds_read_b64_tr_b16 v[124:125], v10 offset:34816
  ds_read_b64_tr_b16 v[126:127], v10 offset:38912
  v_mfma_f32_16x16x32_bf16 v[172:175], v[88:91], v[220:223], v[172:175]
  v_mfma_f32_16x16x32_bf16 v[176:179], v[44:47], v[220:223], v[176:179]
  v_cvt_pk_bf16_f32 v236, v140, v141
  v_cvt_pk_bf16_f32 v237, v142, v143
  v_mfma_f32_16x16x32_bf16 v[180:183], v[48:51], v[220:223], v[180:183]
  v_cvt_pk_bf16_f32 v238, v144, v145
  v_cvt_pk_bf16_f32 v239, v146, v147
  buffer_store_dwordx4 v[236:239], v14, s[16:19], s35 offen offset:1024 sc1
  v_mfma_f32_16x16x32_bf16 v[184:187], v[52:55], v[220:223], v[184:187]
  v_cvt_pk_bf16_f32 v228, v148, v149
  v_cvt_pk_bf16_f32 v229, v150, v151
  buffer_store_dwordx2 v[228:229], v2, s[16:19], s35 offen offset:2048 sc1
  s_waitcnt lgkmcnt(2)
  v_mfma_f32_16x16x32_bf16 v[168:171], v[92:95], v[224:227], v[168:171]
  ds_read_b64_tr_b16 v[128:129], v10 offset:43008
  ds_read_b64_tr_b16 v[130:131], v10 offset:47104
  v_mfma_f32_16x16x32_bf16 v[172:175], v[96:99], v[224:227], v[172:175]
  v_mfma_f32_16x16x32_bf16 v[176:179], v[56:59], v[224:227], v[176:179]
  v_mfma_f32_16x16x32_bf16 v[180:183], v[60:63], v[224:227], v[180:183]
  v_mfma_f32_16x16x32_bf16 v[184:187], v[64:67], v[224:227], v[184:187]
  s_waitcnt lgkmcnt(2)
  v_mfma_f32_16x16x32_bf16 v[168:171], v[100:103], v[124:127], v[168:171]
  v_mfma_f32_16x16x32_bf16 v[172:175], v[104:107], v[124:127], v[172:175]
  v_mfma_f32_16x16x32_bf16 v[176:179], v[68:71], v[124:127], v[176:179]
  v_mfma_f32_16x16x32_bf16 v[180:183], v[72:75], v[124:127], v[180:183]
  v_mfma_f32_16x16x32_bf16 v[184:187], v[76:79], v[124:127], v[184:187]
  s_waitcnt lgkmcnt(0)
  v_mfma_f32_16x16x32_bf16 v[168:171], v[108:111], v[128:131], v[168:171]
  v_mfma_f32_16x16x32_bf16 v[172:175], v[112:115], v[128:131], v[172:175]
  v_mfma_f32_16x16x32_bf16 v[176:179], v[240:243], v[128:131], v[176:179]
  v_mfma_f32_16x16x32_bf16 v[180:183], v[244:247], v[128:131], v[180:183]
  v_mfma_f32_16x16x32_bf16 v[184:187], v[80:83], v[128:131], v[184:187]
  s_waitcnt vmcnt(7)
  v_mfma_f32_16x16x32_bf16 v[80:83], v[24:27], v[206:209], 0
  v_mfma_f32_16x16x32_bf16 v[84:87], v[28:31], v[206:209], 0
  v_mfma_f32_16x16x32_bf16 v[88:91], v[32:35], v[206:209], 0
  v_mfma_f32_16x16x32_bf16 v[92:95], v[36:39], v[206:209], 0
  v_mfma_f32_16x16x32_bf16 v[96:99], v[40:43], v[206:209], 0
  v_lshlrev_b32 v20, 16, v20
  v_add_f32 v20, v20, v18
  s_mov_b32 s37, 0
  v_mul_u32_u24 v4, 10224, v1
  v_add_u32 v4, v4, v15
  s_waitcnt vmcnt(0)
L_p0_3201:
  s_mov_b64 exec, 7
L_p1_3199:
  buffer_load_dword v2, v4, s[16:19], 0 offen offset:2552 sc1
  s_add_u32 s37, s37, 1
  s_waitcnt vmcnt(0)
  v_cmp_eq_u32 vcc, -1, v2
  s_cmp_gt_u32 s37, 262144
  s_cbranch_scc1 L_g1_3200
  s_cbranch_vccz L_g1_3200
  s_sleep 6
  s_branch L_p1_3199
L_g1_3200:
  s_mov_b64 exec, -1
L_poll_3197:
  s_mov_b32 s35, 0
  buffer_load_dwordx4 v[44:47], v15, s[16:19], s35 offen offset:0 sc1
  buffer_load_dwordx4 v[48:51], v15, s[16:19], s35 offen offset:1024 sc1
  buffer_load_dwordx2 v[52:53], v3, s[16:19], s35 offen offset:2048 sc1
  s_mov_b32 s35, 10240
  buffer_load_dwordx4 v[56:59], v15, s[16:19], s35 offen offset:0 sc1
  buffer_load_dwordx4 v[60:63], v15, s[16:19], s35 offen offset:1024 sc1
  buffer_load_dwordx2 v[64:65], v3, s[16:19], s35 offen offset:2048 sc1
  s_mov_b32 s35, 20480
  buffer_load_dwordx4 v[68:71], v15, s[16:19], s35 offen offset:0 sc1
  buffer_load_dwordx4 v[72:75], v15, s[16:19], s35 offen offset:1024 sc1
  buffer_load_dwordx2 v[76:77], v3, s[16:19], s35 offen offset:2048 sc1
  s_add_u32 s37, s37, 1
  s_waitcnt vmcnt(0)
  v_max3_u32 v2, v44, v45, v46
  v_max3_u32 v2, v2, v47, v48
  v_max3_u32 v2, v2, v49, v50
  v_max3_u32 v2, v2, v51, v52
  v_max3_u32 v2, v2, v53, v56
  v_max3_u32 v2, v2, v57, v58
  v_max3_u32 v2, v2, v59, v60
  v_max3_u32 v2, v2, v61, v62
  v_max3_u32 v2, v2, v63, v64
  v_max3_u32 v2, v2, v65, v68
  v_max3_u32 v2, v2, v69, v70
  v_max3_u32 v2, v2, v71, v72
  v_max3_u32 v2, v2, v73, v74
  v_max3_u32 v2, v2, v75, v76
  v_max_u32 v2, v2, v77
  v_cmp_eq_u32 vcc, -1, v2
  s_cmp_gt_u32 s37, 262144
  s_cbranch_scc1 L_got_3198
  s_cbranch_vccz L_got_3198
  s_sleep 6
  s_branch L_poll_3197
L_got_3198:
  v_fma_f32 v80, v80, v19, v20
  v_fma_f32 v81, v81, v19, v20
  v_fma_f32 v82, v82, v19, v20
  v_fma_f32 v83, v83, v19, v20
  v_add_f32 v168, v168, v80
  v_add_f32 v169, v169, v81
  v_add_f32 v170, v170, v82
  v_add_f32 v171, v171, v83
  v_lshlrev_b32 v2, 16, v44
  v_and_b32 v44, 0xffff0000, v44
  v_add_f32 v168, v168, v2
  v_add_f32 v169, v169, v44
  v_lshlrev_b32 v2, 16, v45
  v_and_b32 v45, 0xffff0000, v45
  v_add_f32 v170, v170, v2
  v_add_f32 v171, v171, v45
  v_lshlrev_b32 v2, 16, v56
  v_and_b32 v56, 0xffff0000, v56
  v_add_f32 v168, v168, v2
  v_add_f32 v169, v169, v56
  v_lshlrev_b32 v2, 16, v57
  v_and_b32 v57, 0xffff0000, v57
  v_add_f32 v170, v170, v2
  v_add_f32 v171, v171, v57
  v_lshlrev_b32 v2, 16, v68
  v_and_b32 v68, 0xffff0000, v68
  v_add_f32 v168, v168, v2
  v_add_f32 v169, v169, v68
  v_lshlrev_b32 v2, 16, v69
  v_and_b32 v69, 0xffff0000, v69
  v_add_f32 v170, v170, v2
  v_add_f32 v171, v171, v69
  v_cvt_pk_bf16_f32 v24, v168, v169
  v_cvt_pk_bf16_f32 v25, v170, v171
  v_fma_f32 v84, v84, v19, v20
  v_fma_f32 v85, v85, v19, v20
  v_fma_f32 v86, v86, v19, v20
  v_fma_f32 v87, v87, v19, v20
  v_add_f32 v172, v172, v84
  v_add_f32 v173, v173, v85
  v_add_f32 v174, v174, v86
  v_add_f32 v175, v175, v87
  v_lshlrev_b32 v2, 16, v46
  v_and_b32 v46, 0xffff0000, v46
  v_add_f32 v172, v172, v2
  v_add_f32 v173, v173, v46
  v_lshlrev_b32 v2, 16, v47
  v_and_b32 v47, 0xffff0000, v47
  v_add_f32 v174, v174, v2
  v_add_f32 v175, v175, v47
  v_lshlrev_b32 v2, 16, v58
  v_and_b32 v58, 0xffff0000, v58
  v_add_f32 v172, v172, v2
  v_add_f32 v173, v173, v58
  v_lshlrev_b32 v2, 16, v59
  v_and_b32 v59, 0xffff0000, v59
  v_add_f32 v174, v174, v2
  v_add_f32 v175, v175, v59
  v_lshlrev_b32 v2, 16, v70
  v_and_b32 v70, 0xffff0000, v70
  v_add_f32 v172, v172, v2
  v_add_f32 v173, v173, v70
  v_lshlrev_b32 v2, 16, v71
  v_and_b32 v71, 0xffff0000, v71
  v_add_f32 v174, v174, v2
  v_add_f32 v175, v175, v71
  v_cvt_pk_bf16_f32 v26, v172, v173
  v_cvt_pk_bf16_f32 v27, v174, v175
  s_nop 0
  v_permlane16_swap_b32 v24, v26
  v_permlane16_swap_b32 v25, v27
  buffer_store_dwordx4 v[24:27], v16, s[20:23], 0 offen offset:0
  v_fma_f32 v88, v88, v19, v20
  v_fma_f32 v89, v89, v19, v20
  v_fma_f32 v90, v90, v19, v20
  v_fma_f32 v91, v91, v19, v20
  v_add_f32 v176, v176, v88
  v_add_f32 v177, v177, v89
  v_add_f32 v178, v178, v90
  v_add_f32 v179, v179, v91
  v_lshlrev_b32 v2, 16, v48
  v_and_b32 v48, 0xffff0000, v48
  v_add_f32 v176, v176, v2
  v_add_f32 v177, v177, v48
  v_lshlrev_b32 v2, 16, v49
  v_and_b32 v49, 0xffff0000, v49
  v_add_f32 v178, v178, v2
  v_add_f32 v179, v179, v49
  v_lshlrev_b32 v2, 16, v60
  v_and_b32 v60, 0xffff0000, v60
  v_add_f32 v176, v176, v2
  v_add_f32 v177, v177, v60
  v_lshlrev_b32 v2, 16, v61
  v_and_b32 v61, 0xffff0000, v61
  v_add_f32 v178, v178, v2
  v_add_f32 v179, v179, v61
  v_lshlrev_b32 v2, 16, v72
  v_and_b32 v72, 0xffff0000, v72
  v_add_f32 v176, v176, v2
  v_add_f32 v177, v177, v72
  v_lshlrev_b32 v2, 16, v73
  v_and_b32 v73, 0xffff0000, v73
  v_add_f32 v178, v178, v2
  v_add_f32 v179, v179, v73
  v_cvt_pk_bf16_f32 v28, v176, v177
  v_cvt_pk_bf16_f32 v29, v178, v179
  v_fma_f32 v92, v92, v19, v20
  v_fma_f32 v93, v93, v19, v20
  v_fma_f32 v94, v94, v19, v20
  v_fma_f32 v95, v95, v19, v20
  v_add_f32 v180, v180, v92
  v_add_f32 v181, v181, v93
  v_add_f32 v182, v182, v94
  v_add_f32 v183, v183, v95
  v_lshlrev_b32 v2, 16, v50
  v_and_b32 v50, 0xffff0000, v50
  v_add_f32 v180, v180, v2
  v_add_f32 v181, v181, v50
  v_lshlrev_b32 v2, 16, v51
  v_and_b32 v51, 0xffff0000, v51
  v_add_f32 v182, v182, v2
  v_add_f32 v183, v183, v51
  v_lshlrev_b32 v2, 16, v62
  v_and_b32 v62, 0xffff0000, v62
  v_add_f32 v180, v180, v2
  v_add_f32 v181, v181, v62
  v_lshlrev_b32 v2, 16, v63
  v_and_b32 v63, 0xffff0000, v63
  v_add_f32 v182, v182, v2
  v_add_f32 v183, v183, v63
  v_lshlrev_b32 v2, 16, v74
  v_and_b32 v74, 0xffff0000, v74
  v_add_f32 v180, v180, v2
  v_add_f32 v181, v181, v74
  v_lshlrev_b32 v2, 16, v75
  v_and_b32 v75, 0xffff0000, v75
  v_add_f32 v182, v182, v2
  v_add_f32 v183, v183, v75
  v_cvt_pk_bf16_f32 v30, v180, v181
  v_cvt_pk_bf16_f32 v31, v182, v183
  s_nop 0
  v_permlane16_swap_b32 v28, v30
  v_permlane16_swap_b32 v29, v31
  buffer_store_dwordx4 v[28:31], v16, s[20:23], 0 offen offset:64
  v_fma_f32 v96, v96, v19, v20
  v_fma_f32 v97, v97, v19, v20
  v_fma_f32 v98, v98, v19, v20
  v_fma_f32 v99, v99, v19, v20
  v_add_f32 v184, v184, v96
  v_add_f32 v185, v185, v97
  v_add_f32 v186, v186, v98
  v_add_f32 v187, v187, v99
  v_lshlrev_b32 v2, 16, v52
  v_and_b32 v52, 0xffff0000, v52
  v_add_f32 v184, v184, v2
  v_add_f32 v185, v185, v52
  v_lshlrev_b32 v2, 16, v53
  v_and_b32 v53, 0xffff0000, v53
  v_add_f32 v186, v186, v2
  v_add_f32 v187, v187, v53
  v_lshlrev_b32 v2, 16, v64
  v_and_b32 v64, 0xffff0000, v64
  v_add_f32 v184, v184, v2
  v_add_f32 v185, v185, v64
  v_lshlrev_b32 v2, 16, v65
  v_and_b32 v65, 0xffff0000, v65
  v_add_f32 v186, v186, v2
  v_add_f32 v187, v187, v65
  v_lshlrev_b32 v2, 16, v76
  v_and_b32 v76, 0xffff0000, v76
  v_add_f32 v184, v184, v2
  v_add_f32 v185, v185, v76
  v_lshlrev_b32 v2, 16, v77
  v_and_b32 v77, 0xffff0000, v77
  v_add_f32 v186, v186, v2
  v_add_f32 v187, v187, v77
  v_cvt_pk_bf16_f32 v32, v184, v185
  v_cvt_pk_bf16_f32 v33, v186, v187
  buffer_store_dwordx2 v[32:33], v17, s[20:23], 0 offen offset:128
  s_endpgm
L_q3_3186:
L_x3:
  v_lshlrev_b32 v2, 3, v1
  v_sub_u32 v3, v15, v2
  v_sub_u32 v2, v14, v2
  s_mov_b32 s35, 20480
  s_mov_b32 s36, 40960
  s_mov_b32 s31, 61440
  s_waitcnt lgkmcnt(0)
  s_barrier
  v_mfma_f32_16x16x32_bf16 v[132:135], v[80:83], v[124:127], v[132:135]
  v_mfma_f32_16x16x32_bf16 v[168:171], v[80:83], v[128:131], v[168:171]
  v_mfma_f32_16x16x32_bf16 v[136:139], v[84:87], v[124:127], v[136:139]
  v_mfma_f32_16x16x32_bf16 v[172:175], v[84:87], v[128:131], v[172:175]
  v_mfma_f32_16x16x32_bf16 v[140:143], v[88:91], v[124:127], v[140:143]
  v_mfma_f32_16x16x32_bf16 v[176:179], v[88:91], v[128:131], v[176:179]
  v_mfma_f32_16x16x32_bf16 v[144:147], v[92:95], v[124:127], v[144:147]
  v_mfma_f32_16x16x32_bf16 v[180:183], v[92:95], v[128:131], v[180:183]
  v_mfma_f32_16x16x32_bf16 v[148:151], v[96:99], v[124:127], v[148:151]
  ds_read_b64_tr_b16 v[116:117], v12 offset:0
  ds_read_b64_tr_b16 v[118:119], v12 offset:4096
  v_mfma_f32_16x16x32_bf16 v[184:187], v[96:99], v[128:131], v[184:187]
  ds_read_b128 v[44:47], v11 offset:0
  ds_read_b64_tr_b16 v[120:121], v13 offset:0
  ds_read_b64_tr_b16 v[122:123], v13 offset:4096
  v_mfma_f32_16x16x32_bf16 v[152:155], v[100:103], v[124:127], v[152:155]
  ds_read_b128 v[48:51], v11 offset:1024
  v_mfma_f32_16x16x32_bf16 v[188:191], v[100:103], v[128:131], v[188:191]
  v_mfma_f32_16x16x32_bf16 v[156:159], v[104:107], v[124:127], v[156:159]
  ds_read_b128 v[52:55], v11 offset:2048
  v_mfma_f32_16x16x32_bf16 v[192:195], v[104:107], v[128:131], v[192:195]
  v_mfma_f32_16x16x32_bf16 v[160:163], v[108:111], v[124:127], v[160:163]
  ds_read_b128 v[56:59], v11 offset:3072
  v_mfma_f32_16x16x32_bf16 v[196:199], v[108:111], v[128:131], v[196:199]
  v_mfma_f32_16x16x32_bf16 v[164:167], v[112:115], v[124:127], v[164:167]
  ds_read_b128 v[60:63], v11 offset:4096
  v_mfma_f32_16x16x32_bf16 v[200:203], v[112:115], v[128:131], v[200:203]
  s_waitcnt lgkmcnt(6)
  v_mfma_f32_16x16x32_bf16 v[132:135], v[44:47], v[116:119], v[132:135]
  ds_read_b64_tr_b16 v[212:213], v12 offset:8192
  ds_read_b64_tr_b16 v[214:215], v12 offset:12288
  s_waitcnt lgkmcnt(6)
  v_mfma_f32_16x16x32_bf16 v[168:171], v[44:47], v[120:123], v[168:171]
  ds_read_b128 v[64:67], v11 offset:9216
  ds_read_b64_tr_b16 v[216:217], v13 offset:8192
  ds_read_b64_tr_b16 v[218:219], v13 offset:12288
  s_waitcnt lgkmcnt(8)
  v_mfma_f32_16x16x32_bf16 v[136:139], v[48:51], v[116:119], v[136:139]
  ds_read_b128 v[68:71], v11 offset:10240
  v_mfma_f32_16x16x32_bf16 v[172:175], v[48:51], v[120:123], v[172:175]
  s_waitcnt lgkmcnt(8)
  v_mfma_f32_16x16x32_bf16 v[140:143], v[52:55], v[116:119], v[140:143]
  ds_read_b128 v[72:75], v11 offset:11264
  v_mfma_f32_16x16x32_bf16 v[176:179], v[52:55], v[120:123], v[176:179]
  s_waitcnt lgkmcnt(8)
  v_mfma_f32_16x16x32_bf16 v[144:147], v[56:59], v[116:119], v[144:147]
  ds_read_b128 v[76:79], v11 offset:12288
  v_mfma_f32_16x16x32_bf16 v[180:183], v[56:59], v[120:123], v[180:183]
  s_waitcnt lgkmcnt(8)
  v_mfma_f32_16x16x32_bf16 v[148:151], v[60:63], v[116:119], v[148:151]
  ds_read_b128 v[240:243], v11 offset:13312
  v_mfma_f32_16x16x32_bf16 v[184:187], v[60:63], v[120:123], v[184:187]
  s_waitcnt lgkmcnt(6)
  v_mfma_f32_16x16x32_bf16 v[132:135], v[64:67], v[212:215], v[132:135]
  s_barrier
  ds_read_b64_tr_b16 v[220:221], v12 offset:34816
  ds_read_b64_tr_b16 v[222:223], v12 offset:38912
  s_waitcnt lgkmcnt(6)
  v_mfma_f32_16x16x32_bf16 v[168:171], v[64:67], v[216:219], v[168:171]
  ds_read_b128 v[244:247], v11 offset:34816
  ds_read_b64_tr_b16 v[224:225], v13 offset:34816
  ds_read_b64_tr_b16 v[226:227], v13 offset:38912
  s_waitcnt lgkmcnt(8)
  v_mfma_f32_16x16x32_bf16 v[136:139], v[68:71], v[212:215], v[136:139]
  ds_read_b128 v[80:83], v11 offset:35840
  v_mfma_f32_16x16x32_bf16 v[172:175], v[68:71], v[216:219], v[172:175]
  s_waitcnt lgkmcnt(8)
  v_mfma_f32_16x16x32_bf16 v[140:143], v[72:75], v[212:215], v[140:143]
  ds_read_b128 v[84:87], v11 offset:36864
  v_mfma_f32_16x16x32_bf16 v[176:179], v[72:75], v[216:219], v[176:179]
  s_waitcnt lgkmcnt(8)
  v_mfma_f32_16x16x32_bf16 v[144:147], v[76:79], v[212:215], v[144:147]
  ds_read_b128 v[88:91], v11 offset:37888
  v_mfma_f32_16x16x32_bf16 v[180:183], v[76:79], v[216:219], v[180:183]
  s_waitcnt lgkmcnt(8)
  v_mfma_f32_16x16x32_bf16 v[148:151], v[240:243], v[212:215], v[148:151]
  ds_read_b128 v[92:95], v11 offset:38912
  v_mfma_f32_16x16x32_bf16 v[184:187], v[240:243], v[216:219], v[184:187]
  s_waitcnt lgkmcnt(6)
  v_mfma_f32_16x16x32_bf16 v[132:135], v[244:247], v[220:223], v[132:135]
  ds_read_b64_tr_b16 v[124:125], v12 offset:43008
  ds_read_b64_tr_b16 v[126:127], v12 offset:47104
  s_waitcnt lgkmcnt(6)
  v_mfma_f32_16x16x32_bf16 v[168:171], v[244:247], v[224:227], v[168:171]
  ds_read_b128 v[96:99], v11 offset:44032
  ds_read_b64_tr_b16 v[128:129], v13 offset:43008
  ds_read_b64_tr_b16 v[130:131], v13 offset:47104
  s_waitcnt lgkmcnt(8)
  v_mfma_f32_16x16x32_bf16 v[136:139], v[80:83], v[220:223], v[136:139]
  ds_read_b128 v[100:103], v11 offset:45056
  v_mfma_f32_16x16x32_bf16 v[172:175], v[80:83], v[224:227], v[172:175]
  s_waitcnt lgkmcnt(8)
  v_mfma_f32_16x16x32_bf16 v[140:143], v[84:87], v[220:223], v[140:143]
  ds_read_b128 v[104:107], v11 offset:46080
  v_mfma_f32_16x16x32_bf16 v[176:179], v[84:87], v[224:227], v[176:179]
  s_waitcnt lgkmcnt(8)
  v_mfma_f32_16x16x32_bf16 v[144:147], v[88:91], v[220:223], v[144:147]
  ds_read_b128 v[108:111], v11 offset:47104
  v_mfma_f32_16x16x32_bf16 v[180:183], v[88:91], v[224:227], v[180:183]
  s_waitcnt lgkmcnt(8)
  v_mfma_f32_16x16x32_bf16 v[148:151], v[92:95], v[220:223], v[148:151]
  ds_read_b128 v[112:115], v11 offset:48128
  v_mfma_f32_16x16x32_bf16 v[184:187], v[92:95], v[224:227], v[184:187]
  s_waitcnt lgkmcnt(6)
  v_mfma_f32_16x16x32_bf16 v[132:135], v[96:99], v[124:127], v[132:135]
  s_barrier
  ds_read_b64_tr_b16 v[116:117], v9 offset:0
  ds_read_b64_tr_b16 v[118:119], v9 offset:4096
  s_waitcnt lgkmcnt(6)
  v_mfma_f32_16x16x32_bf16 v[168:171], v[96:99], v[128:131], v[168:171]
  ds_read_b128 v[44:47], v8 offset:0
  ds_read_b64_tr_b16 v[120:121], v10 offset:0
  ds_read_b64_tr_b16 v[122:123], v10 offset:4096
  s_waitcnt lgkmcnt(8)
  v_mfma_f32_16x16x32_bf16 v[136:139], v[100:103], v[124:127], v[136:139]
  ds_read_b128 v[48:51], v8 offset:1024
  v_mfma_f32_16x16x32_bf16 v[172:175], v[100:103], v[128:131], v[172:175]
  buffer_load_dwordx4 v[24:27], v24, s[12:15], 0 offen sc1
  s_waitcnt lgkmcnt(8)
  v_mfma_f32_16x16x32_bf16 v[140:143], v[104:107], v[124:127], v[140:143]
  ds_read_b128 v[52:55], v8 offset:2048
  v_mfma_f32_16x16x32_bf16 v[176:179], v[104:107], v[128:131], v[176:179]
  s_waitcnt lgkmcnt(8)
  v_mfma_f32_16x16x32_bf16 v[144:147], v[108:111], v[124:127], v[144:147]
  buffer_load_dwordx4 v[28:31], v28, s[12:15], 0 offen sc1
  ds_read_b128 v[56:59], v8 offset:3072
  v_mfma_f32_16x16x32_bf16 v[180:183], v[108:111], v[128:131], v[180:183]
  s_waitcnt lgkmcnt(8)
  v_mfma_f32_16x16x32_bf16 v[148:151], v[112:115], v[124:127], v[148:151]
  ds_read_b128 v[60:63], v8 offset:4096
  v_mfma_f32_16x16x32_bf16 v[184:187], v[112:115], v[128:131], v[184:187]
  buffer_load_dwordx4 v[32:35], v32, s[12:15], 0 offen sc1
  s_waitcnt lgkmcnt(6)
  v_mfma_f32_16x16x32_bf16 v[132:135], v[44:47], v[116:119], v[132:135]
  ds_read_b64_tr_b16 v[212:213], v9 offset:8192
  ds_read_b64_tr_b16 v[214:215], v9 offset:12288
  s_waitcnt lgkmcnt(6)
  v_mfma_f32_16x16x32_bf16 v[168:171], v[44:47], v[120:123], v[168:171]
  ds_read_b128 v[64:67], v8 offset:9216
  ds_read_b64_tr_b16 v[216:217], v10 offset:8192
  ds_read_b64_tr_b16 v[218:219], v10 offset:12288
  s_waitcnt lgkmcnt(8)
  v_mfma_f32_16x16x32_bf16 v[136:139], v[48:51], v[116:119], v[136:139]
  buffer_load_dwordx4 v[36:39], v36, s[12:15], 0 offen sc1
  ds_read_b128 v[68:71], v8 offset:10240
  v_mfma_f32_16x16x32_bf16 v[172:175], v[48:51], v[120:123], v[172:175]
  s_waitcnt lgkmcnt(8)
  v_mfma_f32_16x16x32_bf16 v[140:143], v[52:55], v[116:119], v[140:143]
  ds_read_b128 v[72:75], v8 offset:11264
  v_mfma_f32_16x16x32_bf16 v[176:179], v[52:55], v[120:123], v[176:179]
  buffer_load_dwordx4 v[40:43], v40, s[12:15], 0 offen sc1
  s_waitcnt lgkmcnt(8)
  v_mfma_f32_16x16x32_bf16 v[144:147], v[56:59], v[116:119], v[144:147]
  ds_read_b128 v[76:79], v8 offset:12288
  v_mfma_f32_16x16x32_bf16 v[180:183], v[56:59], v[120:123], v[180:183]
  s_waitcnt lgkmcnt(8)
  v_mfma_f32_16x16x32_bf16 v[148:151], v[60:63], v[116:119], v[148:151]
  ds_read_b128 v[240:243], v8 offset:13312
  v_mfma_f32_16x16x32_bf16 v[184:187], v[60:63], v[120:123], v[184:187]
  s_waitcnt lgkmcnt(6)
  v_mfma_f32_16x16x32_bf16 v[132:135], v[64:67], v[212:215], v[132:135]
  ds_read_b64_tr_b16 v[220:221], v12 offset:0
  ds_read_b64_tr_b16 v[222:223], v12 offset:4096
  s_waitcnt lgkmcnt(6)
  v_mfma_f32_16x16x32_bf16 v[168:171], v[64:67], v[216:219], v[168:171]
  ds_read_b128 v[244:247], v11 offset:5120
  ds_read_b64_tr_b16 v[224:225], v13 offset:0
  ds_read_b64_tr_b16 v[226:227], v13 offset:4096
  s_waitcnt lgkmcnt(8)
  v_mfma_f32_16x16x32_bf16 v[136:139], v[68:71], v[212:215], v[136:139]
  ds_read_b128 v[80:83], v11 offset:6144
  v_mfma_f32_16x16x32_bf16 v[172:175], v[68:71], v[216:219], v[172:175]
  s_waitcnt lgkmcnt(8)
  v_mfma_f32_16x16x32_bf16 v[140:143], v[72:75], v[212:215], v[140:143]
  ds_read_b128 v[84:87], v11 offset:7168
  v_mfma_f32_16x16x32_bf16 v[176:179], v[72:75], v[216:219], v[176:179]
  s_waitcnt lgkmcnt(8)
  v_mfma_f32_16x16x32_bf16 v[144:147], v[76:79], v[212:215], v[144:147]
  ds_read_b128 v[88:91], v11 offset:8192
  v_mfma_f32_16x16x32_bf16 v[180:183], v[76:79], v[216:219], v[180:183]
  s_waitcnt lgkmcnt(8)
  v_mfma_f32_16x16x32_bf16 v[148:151], v[240:243], v[212:215], v[148:151]
  ds_read_b64_tr_b16 v[124:125], v12 offset:8192
  ds_read_b64_tr_b16 v[126:127], v12 offset:12288
  v_mfma_f32_16x16x32_bf16 v[184:187], v[240:243], v[216:219], v[184:187]
  ds_read_b128 v[92:95], v11 offset:14336
  ds_read_b64_tr_b16 v[128:129], v13 offset:8192
  ds_read_b64_tr_b16 v[130:131], v13 offset:12288
  s_waitcnt lgkmcnt(10)
  v_mfma_f32_16x16x32_bf16 v[152:155], v[244:247], v[220:223], v[152:155]
  ds_read_b128 v[96:99], v11 offset:15360
  s_waitcnt lgkmcnt(9)
  v_mfma_f32_16x16x32_bf16 v[188:191], v[244:247], v[224:227], v[188:191]
  s_waitcnt lgkmcnt(8)
  v_mfma_f32_16x16x32_bf16 v[156:159], v[80:83], v[220:223], v[156:159]
  ds_read_b128 v[100:103], v11 offset:16384
  v_mfma_f32_16x16x32_bf16 v[192:195], v[80:83], v[224:227], v[192:195]
  s_waitcnt lgkmcnt(8)
  v_mfma_f32_16x16x32_bf16 v[160:163], v[84:87], v[220:223], v[160:163]
  ds_read_b128 v[104:107], v11 offset:17408
  v_mfma_f32_16x16x32_bf16 v[196:199], v[84:87], v[224:227], v[196:199]
  s_waitcnt lgkmcnt(8)
  v_mfma_f32_16x16x32_bf16 v[164:167], v[88:91], v[220:223], v[164:167]
  s_barrier
  ds_read_b64_tr_b16 v[116:117], v9 offset:34816
  ds_read_b64_tr_b16 v[118:119], v9 offset:38912
  v_mfma_f32_16x16x32_bf16 v[200:203], v[88:91], v[224:227], v[200:203]
  ds_read_b128 v[108:111], v8 offset:34816
  ds_read_b64_tr_b16 v[120:121], v10 offset:34816
  ds_read_b64_tr_b16 v[122:123], v10 offset:38912
  s_waitcnt lgkmcnt(10)
  v_mfma_f32_16x16x32_bf16 v[152:155], v[92:95], v[124:127], v[152:155]
  ds_read_b64_tr_b16 v[212:213], v9 offset:43008
  ds_read_b64_tr_b16 v[214:215], v9 offset:47104
  s_waitcnt lgkmcnt(10)
  v_mfma_f32_16x16x32_bf16 v[188:191], v[92:95], v[128:131], v[188:191]
  ds_read_b128 v[112:115], v8 offset:44032
  ds_read_b64_tr_b16 v[216:217], v10 offset:43008
  ds_read_b64_tr_b16 v[218:219], v10 offset:47104
  s_waitcnt lgkmcnt(12)
  v_mfma_f32_16x16x32_bf16 v[156:159], v[96:99], v[124:127], v[156:159]
  ds_read_b128 v[44:47], v8 offset:35840
  v_mfma_f32_16x16x32_bf16 v[192:195], v[96:99], v[128:131], v[192:195]
  s_waitcnt lgkmcnt(12)
  v_mfma_f32_16x16x32_bf16 v[160:163], v[100:103], v[124:127], v[160:163]
  ds_read_b128 v[48:51], v8 offset:45056
  v_mfma_f32_16x16x32_bf16 v[196:199], v[100:103], v[128:131], v[196:199]
  s_waitcnt lgkmcnt(12)
  v_mfma_f32_16x16x32_bf16 v[164:167], v[104:107], v[124:127], v[164:167]
  ds_read_b128 v[52:55], v8 offset:36864
  v_mfma_f32_16x16x32_bf16 v[200:203], v[104:107], v[128:131], v[200:203]
  s_waitcnt lgkmcnt(10)
  v_mfma_f32_16x16x32_bf16 v[132:135], v[108:111], v[116:119], v[132:135]
  ds_read_b128 v[56:59], v8 offset:46080
  s_waitcnt lgkmcnt(9)
  v_mfma_f32_16x16x32_bf16 v[168:171], v[108:111], v[120:123], v[168:171]
  s_waitcnt lgkmcnt(6)
  v_mfma_f32_16x16x32_bf16 v[132:135], v[112:115], v[212:215], v[132:135]
  ds_read_b128 v[60:63], v8 offset:37888
  s_waitcnt lgkmcnt(5)
  v_mfma_f32_16x16x32_bf16 v[168:171], v[112:115], v[216:219], v[168:171]
  s_waitcnt lgkmcnt(4)
  v_mfma_f32_16x16x32_bf16 v[136:139], v[44:47], v[116:119], v[136:139]
  ds_read_b128 v[64:67], v8 offset:47104
  v_mfma_f32_16x16x32_bf16 v[172:175], v[44:47], v[120:123], v[172:175]
  s_waitcnt lgkmcnt(4)
  v_mfma_f32_16x16x32_bf16 v[136:139], v[48:51], v[212:215], v[136:139]
  ds_read_b128 v[68:71], v8 offset:38912
  v_mfma_f32_16x16x32_bf16 v[172:175], v[48:51], v[216:219], v[172:175]
  s_waitcnt lgkmcnt(4)
  v_mfma_f32_16x16x32_bf16 v[140:143], v[52:55], v[116:119], v[140:143]
  ds_read_b128 v[72:75], v8 offset:48128
  v_mfma_f32_16x16x32_bf16 v[176:179], v[52:55], v[120:123], v[176:179]
  s_waitcnt lgkmcnt(4)
  v_mfma_f32_16x16x32_bf16 v[140:143], v[56:59], v[212:215], v[140:143]
  ds_read_b64_tr_b16 v[220:221], v12 offset:34816
  ds_read_b64_tr_b16 v[222:223], v12 offset:38912
  v_cvt_pk_bf16_f32 v228, v132, v133
  v_cvt_pk_bf16_f32 v229, v134, v135
  v_mfma_f32_16x16x32_bf16 v[176:179], v[56:59], v[216:219], v[176:179]
  ds_read_b128 v[76:79], v11 offset:39936
  ds_read_b64_tr_b16 v[224:225], v13 offset:34816
  ds_read_b64_tr_b16 v[226:227], v13 offset:38912
  v_cvt_pk_bf16_f32 v230, v136, v137
  v_cvt_pk_bf16_f32 v231, v138, v139
  buffer_store_dwordx4 v[228:231], v14, s[16:19], s35 offen offset:0 sc1
  s_waitcnt lgkmcnt(8)
  v_mfma_f32_16x16x32_bf16 v[144:147], v[60:63], v[116:119], v[144:147]
  ds_read_b128 v[240:243], v11 offset:40960
  v_cvt_pk_bf16_f32 v232, v168, v169
  v_cvt_pk_bf16_f32 v233, v170, v171
  v_mfma_f32_16x16x32_bf16 v[180:183], v[60:63], v[120:123], v[180:183]
  v_cvt_pk_bf16_f32 v234, v172, v173
  v_cvt_pk_bf16_f32 v235, v174, v175
  s_waitcnt lgkmcnt(8)
  v_mfma_f32_16x16x32_bf16 v[144:147], v[64:67], v[212:215], v[144:147]
  ds_read_b128 v[244:247], v11 offset:41984
  v_mfma_f32_16x16x32_bf16 v[180:183], v[64:67], v[216:219], v[180:183]
  s_waitcnt lgkmcnt(8)
  v_mfma_f32_16x16x32_bf16 v[148:151], v[68:71], v[116:119], v[148:151]
  ds_read_b128 v[80:83], v11 offset:43008
  v_mfma_f32_16x16x32_bf16 v[184:187], v[68:71], v[120:123], v[184:187]
  buffer_store_dwordx4 v[232:235], v14, s[16:19], s31 offen offset:0 sc1
  s_waitcnt lgkmcnt(8)
  v_mfma_f32_16x16x32_bf16 v[148:151], v[72:75], v[212:215], v[148:151]
  ds_read_b64_tr_b16 v[124:125], v12 offset:43008
  ds_read_b64_tr_b16 v[126:127], v12 offset:47104
  v_cvt_pk_bf16_f32 v236, v140, v141
  v_cvt_pk_bf16_f32 v237, v142, v143
  v_mfma_f32_16x16x32_bf16 v[184:187], v[72:75], v[216:219], v[184:187]
  ds_read_b128 v[84:87], v11 offset:49152
  ds_read_b64_tr_b16 v[128:129], v13 offset:43008
  ds_read_b64_tr_b16 v[130:131], v13 offset:47104
  v_cvt_pk_bf16_f32 v238, v144, v145
  v_cvt_pk_bf16_f32 v239, v146, v147
  s_waitcnt lgkmcnt(10)
  v_mfma_f32_16x16x32_bf16 v[152:155], v[76:79], v[220:223], v[152:155]
  ds_read_b128 v[88:91], v11 offset:50176
  s_waitcnt lgkmcnt(9)
  v_mfma_f32_16x16x32_bf16 v[188:191], v[76:79], v[224:227], v[188:191]
  s_waitcnt lgkmcnt(8)
  v_mfma_f32_16x16x32_bf16 v[156:159], v[240:243], v[220:223], v[156:159]
  ds_read_b128 v[92:95], v11 offset:51200
  v_mfma_f32_16x16x32_bf16 v[192:195], v[240:243], v[224:227], v[192:195]
  buffer_store_dwordx4 v[236:239], v14, s[16:19], s35 offen offset:1024 sc1
  v_cvt_pk_bf16_f32 v228, v176, v177
  v_cvt_pk_bf16_f32 v229, v178, v179
  s_waitcnt lgkmcnt(8)
  v_mfma_f32_16x16x32_bf16 v[160:163], v[244:247], v[220:223], v[160:163]
  ds_read_b128 v[96:99], v11 offset:52224
  v_cvt_pk_bf16_f32 v230, v180, v181
  v_cvt_pk_bf16_f32 v231, v182, v183
  v_mfma_f32_16x16x32_bf16 v[196:199], v[244:247], v[224:227], v[196:199]
  s_waitcnt lgkmcnt(8)
  v_mfma_f32_16x16x32_bf16 v[164:167], v[80:83], v[220:223], v[164:167]
  ds_read_b64_tr_b16 v[116:117], v9 offset:0
  ds_read_b64_tr_b16 v[118:119], v9 offset:4096
  v_mfma_f32_16x16x32_bf16 v[200:203], v[80:83], v[224:227], v[200:203]
  ds_read_b128 v[100:103], v8 offset:5120
  ds_read_b128 v[104:107], v8 offset:6144
  s_waitcnt lgkmcnt(9)
  v_mfma_f32_16x16x32_bf16 v[152:155], v[84:87], v[124:127], v[152:155]
  ds_read_b64_tr_b16 v[120:121], v9 offset:8192
  ds_read_b64_tr_b16 v[122:123], v9 offset:12288
  s_waitcnt lgkmcnt(9)
  v_mfma_f32_16x16x32_bf16 v[188:191], v[84:87], v[128:131], v[188:191]
  ds_read_b128 v[108:111], v8 offset:14336
  ds_read_b128 v[112:115], v8 offset:15360
  buffer_store_dwordx4 v[228:231], v14, s[16:19], s31 offen offset:1024 sc1
  v_cvt_pk_bf16_f32 v232, v148, v149
  v_cvt_pk_bf16_f32 v233, v150, v151
  s_waitcnt lgkmcnt(10)
  v_mfma_f32_16x16x32_bf16 v[156:159], v[88:91], v[124:127], v[156:159]
  ds_read_b64_tr_b16 v[212:213], v9 offset:34816
  ds_read_b64_tr_b16 v[214:215], v9 offset:38912
  v_mfma_f32_16x16x32_bf16 v[192:195], v[88:91], v[128:131], v[192:195]
  ds_read_b128 v[44:47], v8 offset:39936
  ds_read_b128 v[48:51], v8 offset:40960
  s_waitcnt lgkmcnt(13)
  v_mfma_f32_16x16x32_bf16 v[160:163], v[92:95], v[124:127], v[160:163]
  ds_read_b64_tr_b16 v[216:217], v9 offset:43008
  ds_read_b64_tr_b16 v[218:219], v9 offset:47104
  v_mfma_f32_16x16x32_bf16 v[196:199], v[92:95], v[128:131], v[196:199]
  ds_read_b128 v[52:55], v8 offset:49152
  ds_read_b128 v[56:59], v8 offset:50176
  s_waitcnt lgkmcnt(15)
  v_mfma_f32_16x16x32_bf16 v[164:167], v[96:99], v[124:127], v[164:167]
  ds_read_b128 v[60:63], v8 offset:7168
  v_mfma_f32_16x16x32_bf16 v[200:203], v[96:99], v[128:131], v[200:203]
  ds_read_b128 v[64:67], v8 offset:8192
  buffer_store_dwordx2 v[232:233], v2, s[16:19], s35 offen offset:2048 sc1
  v_cvt_pk_bf16_f32 v236, v184, v185
  v_cvt_pk_bf16_f32 v237, v186, v187
  s_waitcnt lgkmcnt(15)
  v_mfma_f32_16x16x32_bf16 v[152:155], v[100:103], v[116:119], v[152:155]
  ds_read_b128 v[68:71], v8 offset:16384
  s_waitcnt lgkmcnt(15)
  v_mfma_f32_16x16x32_bf16 v[156:159], v[104:107], v[116:119], v[156:159]
  ds_read_b128 v[72:75], v8 offset:17408
  s_waitcnt lgkmcnt(13)
  v_mfma_f32_16x16x32_bf16 v[152:155], v[108:111], v[120:123], v[152:155]
  ds_read_b128 v[76:79], v8 offset:41984
  s_waitcnt lgkmcnt(13)
  v_mfma_f32_16x16x32_bf16 v[156:159], v[112:115], v[120:123], v[156:159]
  ds_read_b128 v[240:243], v8 offset:43008
  s_waitcnt lgkmcnt(11)
  v_mfma_f32_16x16x32_bf16 v[152:155], v[44:47], v[212:215], v[152:155]
  ds_read_b128 v[244:247], v8 offset:51200
  s_waitcnt lgkmcnt(11)
  v_mfma_f32_16x16x32_bf16 v[156:159], v[48:51], v[212:215], v[156:159]
  ds_read_b128 v[80:83], v8 offset:52224
  buffer_store_dwordx2 v[236:237], v2, s[16:19], s31 offen offset:2048 sc1
  s_waitcnt lgkmcnt(9)
  v_mfma_f32_16x16x32_bf16 v[152:155], v[52:55], v[216:219], v[152:155]
  ds_read_b64_tr_b16 v[220:221], v10 offset:0
  ds_read_b64_tr_b16 v[222:223], v10 offset:4096
  s_waitcnt lgkmcnt(10)
  v_mfma_f32_16x16x32_bf16 v[156:159], v[56:59], v[216:219], v[156:159]
  s_waitcnt lgkmcnt(9)
  v_mfma_f32_16x16x32_bf16 v[160:163], v[60:63], v[116:119], v[160:163]
  s_waitcnt lgkmcnt(8)
  v_mfma_f32_16x16x32_bf16 v[164:167], v[64:67], v[116:119], v[164:167]
  s_waitcnt lgkmcnt(7)
  v_mfma_f32_16x16x32_bf16 v[160:163], v[68:71], v[120:123], v[160:163]
  ds_read_b64_tr_b16 v[224:225], v10 offset:8192
  ds_read_b64_tr_b16 v[226:227], v10 offset:12288
  v_cvt_pk_bf16_f32 v228, v152, v153
  v_cvt_pk_bf16_f32 v229, v154, v155
  s_waitcnt lgkmcnt(8)
  v_mfma_f32_16x16x32_bf16 v[164:167], v[72:75], v[120:123], v[164:167]
  v_cvt_pk_bf16_f32 v230, v156, v157
  v_cvt_pk_bf16_f32 v231, v158, v159
  buffer_store_dwordx4 v[228:231], v14, s[16:19], s36 offen offset:0 sc1
  s_waitcnt lgkmcnt(7)
  v_mfma_f32_16x16x32_bf16 v[160:163], v[76:79], v[212:215], v[160:163]
  s_waitcnt lgkmcnt(6)
  v_mfma_f32_16x16x32_bf16 v[164:167], v[240:243], v[212:215], v[164:167]
  s_waitcnt lgkmcnt(5)
  v_mfma_f32_16x16x32_bf16 v[160:163], v[244:247], v[216:219], v[160:163]
  ds_read_b64_tr_b16 v[124:125], v10 offset:34816
  ds_read_b64_tr_b16 v[126:127], v10 offset:38912
  s_waitcnt lgkmcnt(6)
  v_mfma_f32_16x16x32_bf16 v[164:167], v[80:83], v[216:219], v[164:167]
  s_waitcnt lgkmcnt(4)
  v_mfma_f32_16x16x32_bf16 v[188:191], v[100:103], v[220:223], v[188:191]
  v_mfma_f32_16x16x32_bf16 v[192:195], v[104:107], v[220:223], v[192:195]
  v_mfma_f32_16x16x32_bf16 v[196:199], v[60:63], v[220:223], v[196:199]
  ds_read_b64_tr_b16 v[128:129], v10 offset:43008
  ds_read_b64_tr_b16 v[130:131], v10 offset:47104
  v_mfma_f32_16x16x32_bf16 v[200:203], v[64:67], v[220:223], v[200:203]
  s_waitcnt lgkmcnt(4)
  v_mfma_f32_16x16x32_bf16 v[188:191], v[108:111], v[224:227], v[188:191]
  v_cvt_pk_bf16_f32 v232, v160, v161
  v_cvt_pk_bf16_f32 v233, v162, v163
  v_mfma_f32_16x16x32_bf16 v[192:195], v[112:115], v[224:227], v[192:195]
  v_cvt_pk_bf16_f32 v234, v164, v165
  v_cvt_pk_bf16_f32 v235, v166, v167
  buffer_store_dwordx4 v[232:235], v14, s[16:19], s36 offen offset:1024 sc1
  v_mfma_f32_16x16x32_bf16 v[196:199], v[68:71], v[224:227], v[196:199]
  v_mfma_f32_16x16x32_bf16 v[200:203], v[72:75], v[224:227], v[200:203]
  s_waitcnt lgkmcnt(2)
  v_mfma_f32_16x16x32_bf16 v[188:191], v[44:47], v[124:127], v[188:191]
  v_mfma_f32_16x16x32_bf16 v[192:195], v[48:51], v[124:127], v[192:195]
  v_mfma_f32_16x16x32_bf16 v[196:199], v[76:79], v[124:127], v[196:199]
  v_mfma_f32_16x16x32_bf16 v[200:203], v[240:243], v[124:127], v[200:203]
  s_waitcnt lgkmcnt(0)
  v_mfma_f32_16x16x32_bf16 v[188:191], v[52:55], v[128:131], v[188:191]
  v_mfma_f32_16x16x32_bf16 v[192:195], v[56:59], v[128:131], v[192:195]
  v_mfma_f32_16x16x32_bf16 v[196:199], v[244:247], v[128:131], v[196:199]
  v_mfma_f32_16x16x32_bf16 v[200:203], v[80:83], v[128:131], v[200:203]
  s_waitcnt vmcnt(8)
  v_mfma_f32_16x16x32_bf16 v[80:83], v[24:27], v[206:209], 0
  v_mfma_f32_16x16x32_bf16 v[84:87], v[28:31], v[206:209], 0
  v_mfma_f32_16x16x32_bf16 v[88:91], v[32:35], v[206:209], 0
  v_mfma_f32_16x16x32_bf16 v[92:95], v[36:39], v[206:209], 0
  v_lshlrev_b32 v20, 16, v20
  v_add_f32 v20, v20, v18
  s_mov_b32 s37, 0
  v_mul_u32_u24 v4, 10224, v1
  v_add_u32 v4, v4, v15
  s_waitcnt vmcnt(0)
L_p0_3206:
  s_mov_b64 exec, 7
L_p1_3204:
  buffer_load_dword v2, v4, s[16:19], 0 offen offset:2044 sc1
  s_add_u32 s37, s37, 1
  s_waitcnt vmcnt(0)
  v_cmp_eq_u32 vcc, -1, v2
  s_cmp_gt_u32 s37, 262144
  s_cbranch_scc1 L_g1_3205
  s_cbranch_vccz L_g1_3205
  s_sleep 6
  s_branch L_p1_3204
L_g1_3205:
  s_mov_b64 exec, -1
L_poll_3202:
  s_mov_b32 s35, 0
  buffer_load_dwordx4 v[44:47], v15, s[16:19], s35 offen offset:0 sc1
  buffer_load_dwordx4 v[48:51], v15, s[16:19], s35 offen offset:1024 sc1
  s_mov_b32 s35, 10240
  buffer_load_dwordx4 v[56:59], v15, s[16:19], s35 offen offset:0 sc1
  buffer_load_dwordx4 v[60:63], v15, s[16:19], s35 offen offset:1024 sc1
  s_mov_b32 s35, 20480
  buffer_load_dwordx4 v[68:71], v15, s[16:19], s35 offen offset:0 sc1
  buffer_load_dwordx4 v[72:75], v15, s[16:19], s35 offen offset:1024 sc1
  s_add_u32 s37, s37, 1
  s_waitcnt vmcnt(0)
  v_max3_u32 v2, v44, v45, v46
  v_max3_u32 v2, v2, v47, v48
  v_max3_u32 v2, v2, v49, v50
  v_max3_u32 v2, v2, v51, v56
  v_max3_u32 v2, v2, v57, v58
  v_max3_u32 v2, v2, v59, v60
  v_max3_u32 v2, v2, v61, v62
  v_max3_u32 v2, v2, v63, v68
  v_max3_u32 v2, v2, v69, v70
  v_max3_u32 v2, v2, v71, v72
  v_max3_u32 v2, v2, v73, v74
  v_max_u32 v2, v2, v75
  v_cmp_eq_u32 vcc, -1, v2
  s_cmp_gt_u32 s37, 262144
  s_cbranch_scc1 L_got_3203
  s_cbranch_vccz L_got_3203
  s_sleep 6
  s_branch L_poll_3202
L_got_3203:
  v_fma_f32 v80, v80, v19, v20
  v_fma_f32 v81, v81, v19, v20
  v_fma_f32 v82, v82, v19, v20
  v_fma_f32 v83, v83, v19, v20
  v_add_f32 v188, v188, v80
  v_add_f32 v189, v189, v81
  v_add_f32 v190, v190, v82
  v_add_f32 v191, v191, v83
  v_lshlrev_b32 v2, 16, v44
  v_and_b32 v44, 0xffff0000, v44
  v_add_f32 v188, v188, v2
  v_add_f32 v189, v189, v44
  v_lshlrev_b32 v2, 16, v45
  v_and_b32 v45, 0xffff0000, v45
  v_add_f32 v190, v190, v2
  v_add_f32 v191, v191, v45
  v_lshlrev_b32 v2, 16, v56
  v_and_b32 v56, 0xffff0000, v56
  v_add_f32 v188, v188, v2
  v_add_f32 v189, v189, v56
  v_lshlrev_b32 v2, 16, v57
  v_and_b32 v57, 0xffff0000, v57
  v_add_f32 v190, v190, v2
  v_add_f32 v191, v191, v57
  v_lshlrev_b32 v2, 16, v68
  v_and_b32 v68, 0xffff0000, v68
  v_add_f32 v188, v188, v2
  v_add_f32 v189, v189, v68
  v_lshlrev_b32 v2, 16, v69
  v_and_b32 v69, 0xffff0000, v69
  v_add_f32 v190, v190, v2
  v_add_f32 v191, v191, v69
  v_cvt_pk_bf16_f32 v24, v188, v189
  v_cvt_pk_bf16_f32 v25, v190, v191
  v_fma_f32 v84, v84, v19, v20
  v_fma_f32 v85, v85, v19, v20
  v_fma_f32 v86, v86, v19, v20
  v_fma_f32 v87, v87, v19, v20
  v_add_f32 v192, v192, v84
  v_add_f32 v193, v193, v85
  v_add_f32 v194, v194, v86
  v_add_f32 v195, v195, v87
  v_lshlrev_b32 v2, 16, v46
  v_and_b32 v46, 0xffff0000, v46
  v_add_f32 v192, v192, v2
  v_add_f32 v193, v193, v46
  v_lshlrev_b32 v2, 16, v47
  v_and_b32 v47, 0xffff0000, v47
  v_add_f32 v194, v194, v2
  v_add_f32 v195, v195, v47
  v_lshlrev_b32 v2, 16, v58
  v_and_b32 v58, 0xffff0000, v58
  v_add_f32 v192, v192, v2
  v_add_f32 v193, v193, v58
  v_lshlrev_b32 v2, 16, v59
  v_and_b32 v59, 0xffff0000, v59
  v_add_f32 v194, v194, v2
  v_add_f32 v195, v195, v59
  v_lshlrev_b32 v2, 16, v70
  v_and_b32 v70, 0xffff0000, v70
  v_add_f32 v192, v192, v2
  v_add_f32 v193, v193, v70
  v_lshlrev_b32 v2, 16, v71
  v_and_b32 v71, 0xffff0000, v71
  v_add_f32 v194, v194, v2
  v_add_f32 v195, v195, v71
  v_cvt_pk_bf16_f32 v26, v192, v193
  v_cvt_pk_bf16_f32 v27, v194, v195
  s_nop 0
  v_permlane16_swap_b32 v24, v26
  v_permlane16_swap_b32 v25, v27
  buffer_store_dwordx4 v[24:27], v16, s[20:23], 0 offen offset:0
  v_fma_f32 v88, v88, v19, v20
  v_fma_f32 v89, v89, v19, v20
  v_fma_f32 v90, v90, v19, v20
  v_fma_f32 v91, v91, v19, v20
  v_add_f32 v196, v196, v88
  v_add_f32 v197, v197, v89
  v_add_f32 v198, v198, v90
  v_add_f32 v199, v199, v91
  v_lshlrev_b32 v2, 16, v48
  v_and_b32 v48, 0xffff0000, v48
  v_add_f32 v196, v196, v2
  v_add_f32 v197, v197, v48
  v_lshlrev_b32 v2, 16, v49
  v_and_b32 v49, 0xffff0000, v49
  v_add_f32 v198, v198, v2
  v_add_f32 v199, v199, v49
  v_lshlrev_b32 v2, 16, v60
  v_and_b32 v60, 0xffff0000, v60
  v_add_f32 v196, v196, v2
  v_add_f32 v197, v197, v60
  v_lshlrev_b32 v2, 16, v61
  v_and_b32 v61, 0xffff0000, v61
  v_add_f32 v198, v198, v2
  v_add_f32 v199, v199, v61
  v_lshlrev_b32 v2, 16, v72
  v_and_b32 v72, 0xffff0000, v72
  v_add_f32 v196, v196, v2
  v_add_f32 v197, v197, v72
  v_lshlrev_b32 v2, 16, v73
  v_and_b32 v73, 0xffff0000, v73
  v_add_f32 v198, v198, v2
  v_add_f32 v199, v199, v73
  v_cvt_pk_bf16_f32 v28, v196, v197
  v_cvt_pk_bf16_f32 v29, v198, v199
  v_fma_f32 v92, v92, v19, v20
  v_fma_f32 v93, v93, v19, v20
  v_fma_f32 v94, v94, v19, v20
  v_fma_f32 v95, v95, v19, v20
  v_add_f32 v200, v200, v92
  v_add_f32 v201, v201, v93
  v_add_f32 v202, v202, v94
  v_add_f32 v203, v203, v95
  v_lshlrev_b32 v2, 16, v50
  v_and_b32 v50, 0xffff0000, v50
  v_add_f32 v200, v200, v2
  v_add_f32 v201, v201, v50
  v_lshlrev_b32 v2, 16, v51
  v_and_b32 v51, 0xffff0000, v51
  v_add_f32 v202, v202, v2
  v_add_f32 v203, v203, v51
  v_lshlrev_b32 v2, 16, v62
  v_and_b32 v62, 0xffff0000, v62
  v_add_f32 v200, v200, v2
  v_add_f32 v201, v201, v62
  v_lshlrev_b32 v2, 16, v63
  v_and_b32 v63, 0xffff0000, v63
  v_add_f32 v202, v202, v2
  v_add_f32 v203, v203, v63
  v_lshlrev_b32 v2, 16, v74
  v_and_b32 v74, 0xffff0000, v74
  v_add_f32 v200, v200, v2
  v_add_f32 v201, v201, v74
  v_lshlrev_b32 v2, 16, v75
  v_and_b32 v75, 0xffff0000, v75
  v_add_f32 v202, v202, v2
  v_add_f32 v203, v203, v75
  v_cvt_pk_bf16_f32 v30, v200, v201
  v_cvt_pk_bf16_f32 v31, v202, v203
  s_nop 0
  v_permlane16_swap_b32 v28, v30
  v_permlane16_swap_b32 v29, v31
  buffer_store_dwordx4 v[28:31], v16, s[20:23], 0 offen offset:64
  s_endpgm
L_end_3001:
  s_endpgm
L_cend_3005:
L_cend:
.section .rodata,"a"
.p2align 6
.amdhsa_kernel sequential_preLN__linear_attn_block__mixer_token_mlp__prompt_kernel
  .amdhsa_next_free_vgpr 256
  .amdhsa_next_free_sgpr 102
  .amdhsa_accum_offset 256
  .amdhsa_group_segment_fixed_size 0
  .amdhsa_kernarg_size 88
  .amdhsa_user_sgpr_count 2
  .amdhsa_user_sgpr_kernarg_segment_ptr 1
  .amdhsa_system_sgpr_workgroup_id_x 1
  .amdhsa_float_denorm_mode_32 3
.end_amdhsa_kernel
```
